```python
import torch

def _softmax(x, axis=-1):
    return torch.softmax(x, dim=axis)

def _gelu(x):
    return torch.nn.functional.gelu(x, approximate='tanh')

def _silu(x):
    return torch.nn.functional.silu(x)

def _sigmoid(x):
    return torch.sigmoid(x)

def _layernorm(x, axis=-1, eps=1e-05):
    m = x.mean(dim=axis, keepdim=True)
    v = x.var(dim=axis, keepdim=True, unbiased=False)
    return (x - m) / torch.sqrt(v + eps)

def _scatter_add(tgt, idx, src, axis=0):
    return tgt.clone().index_add_(axis, idx, src)

def _segment_sum(src, seg, n):
    out = torch.zeros((n,) + src.shape[1:], dtype=src.dtype)
    return out.index_add_(0, seg, src)

def _pad(x, pw):
    flat = tuple((v for pair in reversed(pw) for v in pair))
    return torch.nn.functional.pad(x, flat)
kernel_name = 'concat_heads__memory_aug_recurrent_mem_tr__linear_attn_block__prompt'

def setup_inputs():

    _w = lambda a: (lambda t: t.to(torch.bfloat16) if t.is_floating_point() else t)(torch.as_tensor(a))

    def _A_setup():
        B, S, Dm = (1, 2048, 576)
        H, Dh = (32, 128)
        M, seg = (8, 32)
        seg = min(seg, S)
        S = S // seg * seg
        return {'x': _w((lambda *s: torch.randn(*s, dtype=torch.bfloat16) * 0.05)(B, S, Dm)), 'mem0': _w((lambda *s: torch.randn(*s, dtype=torch.bfloat16) * 0.8)(B, M, Dm)), 'Wq': _w((lambda *s: torch.randn(*s, dtype=torch.bfloat16) * 1.6)(Dm, H, Dh) * Dm ** (-0.5)), 'Wk': _w((lambda *s: torch.randn(*s, dtype=torch.bfloat16) * 1.6)(Dm, H, Dh) * Dm ** (-0.5)), 'Wv': _w((lambda *s: torch.randn(*s, dtype=torch.bfloat16) * 0.8)(Dm, H, Dh) * Dm ** (-0.5)), 'Wo': _w((lambda *s: torch.randn(*s, dtype=torch.bfloat16) * 0.8)(H, Dh, Dm) * (H * Dh) ** (-0.5)), 'seg_len': seg}
    _A_in = _A_setup()

    def _B_setup():
        B, S, D = (1, 2048, 576)
        return {'x': _w((lambda *s: torch.randn(*s, dtype=torch.bfloat16) * 0.05)(B, S, D)), 'wqkv': _w((lambda *s: torch.randn(*s, dtype=torch.bfloat16) * 1.6)(D, 3 * D)), 'wo': _w((lambda *s: torch.randn(*s, dtype=torch.bfloat16) * 0.1)(D, D))}
    _B_in = _B_setup()
    return {'A_x': _A_in['x'], 'A_mem0': _A_in['mem0'], 'A_Wq': _A_in['Wq'], 'A_Wk': _A_in['Wk'], 'A_Wv': _A_in['Wv'], 'A_Wo': _A_in['Wo'], 'A_seg_len': _A_in['seg_len'], 'B_x': _B_in['x'], 'B_wqkv': _B_in['wqkv'], 'B_wo': _B_in['wo']}

def reference(A_x, A_mem0, A_Wq, A_Wk, A_Wv, A_Wo, A_seg_len, B_x, B_wqkv, B_wo):

    def _A_ref(x, mem0, Wq, Wk, Wv, Wo, seg_len):
        B, S, Dm = x.shape
        H, Dh = (Wq.shape[1], Wq.shape[2])
        M = mem0.shape[1]
        scale = Dh ** (-0.5)
        n_seg = S // seg_len
        L = M + seg_len
        idx = torch.arange(L)
        mask = (idx[:, None] < M) | (idx[:, None] >= idx[None, :])
        mem = mem0
        outs = []
        for s in range(n_seg):
            xs = x[:, s * seg_len:(s + 1) * seg_len, :].clone()
            h = torch.concatenate([mem, xs], axis=1)
            q = torch.einsum('btd,dhe->bhte', h, Wq)
            k = torch.einsum('btd,dhe->bhte', h, Wk)
            v = torch.einsum('btd,dhe->bhte', h, Wv)
            scores = torch.einsum('bhqe,bhke->bhqk', q, k) * scale
            scores = torch.where(mask[None, None], scores, -1000000000.0)
            p = _softmax(scores, axis=-1)
            o = torch.einsum('bhqk,bhke->bhqe', p, v)
            o = torch.einsum('bhte,hed->btd', o, Wo)
            mem = o[:, :M, :].clone()
            outs.append(o[:, M:, :])
        return torch.concatenate(outs, axis=1)

    def _B_ref(x, wqkv, wo):
        B, S, D = x.shape
        H = 32
        Dh = D // H
        qkv = (lambda x, *d: x.permute(*d))((x @ wqkv).reshape(B, S, 3, H, Dh), 2, 0, 3, 1, 4)
        q, k, v = (qkv[0], qkv[1], qkv[2])
        phi = lambda t: torch.where(t > 0, t + 1, torch.exp(t)) + 1e-06
        pq, pk = (phi(q), phi(k))
        kv = torch.einsum('bhsd,bhse->bhde', pk, v)
        z = torch.einsum('bhsd->bhd', pk)
        num = torch.einsum('bhqd,bhde->bhqe', pq, kv)
        den = torch.einsum('bhqd,bhd->bhq', pq, z)[..., None] + 1e-06
        o = num / den
        return (lambda x, *d: x.permute(*d))(o, 0, 2, 1, 3).reshape(B, S, D) @ wo
    a = _A_ref(A_x, A_mem0, A_Wq, A_Wk, A_Wv, A_Wo, A_seg_len)
    b = _B_ref(B_x, B_wqkv, B_wo)
    return torch.concatenate([a, b], axis=-1)
```

```asm
; @launch grid=(256,1,1) block=(256,1,1) lds=163840
.amdgcn_target "amdgcn-amd-amdhsa--gfx950"
.text
.globl concat_heads__memory_aug_recurrent_mem_tr__linear_attn_block__prompt_kernel
.p2align 8
.type concat_heads__memory_aug_recurrent_mem_tr__linear_attn_block__prompt_kernel,@function
concat_heads__memory_aug_recurrent_mem_tr__linear_attn_block__prompt_kernel:
  s_mov_b32 s70, s0
  s_mov_b32 s71, s1
  s_cmp_ge_u32 s2, 256
  s_cbranch_scc1 L_END2
  s_and_b32 s3, s2, 7
  s_cmp_eq_u32 s3, 0
  s_cbranch_scc0 L_WORKER
  s_lshr_b32 s16, s2, 3
  s_mov_b32 s59, 0
  v_lshrrev_b32 v1, 6, v0
  s_nop 0
  v_readfirstlane_b32 s17, v1
  v_mov_b32 v79, v0
  v_and_b32 v0, 63, v0
  s_load_dwordx8 s[76:83], s[70:71], 8
  s_load_dwordx2 s[84:85], s[70:71], 40
  s_load_dwordx4 s[88:91], s[70:71], 88
  s_waitcnt lgkmcnt(0)
  s_mov_b32 s8, s90
  s_mov_b32 s9, s91
  s_mov_b32 s10, 268435456
  s_mov_b32 s11, 0x00020000
  s_mov_b32 s64, s88
  s_mov_b32 s65, s89
  s_mov_b32 s66, 256
  s_mov_b32 s67, 0x00020000
  s_mov_b32 s30, 0x00ff00ff
  s_mov_b32 s31, 0x00ff00ff
  s_mov_b32 s32, -1
  s_mov_b32 s33, 0
  s_mov_b32 s34, 0x00ff00ff
  s_mov_b32 s35, 0
  s_mov_b32 s36, 0x00030003
  s_mov_b32 s37, 0x00030003
  s_mov_b32 s38, 0x000c000c
  s_mov_b32 s39, 0x000c000c
  s_mov_b32 s40, 0x00300030
  s_mov_b32 s41, 0x00300030
  s_mov_b32 s42, 0x00c000c0
  s_mov_b32 s43, 0x00c000c0
  s_mov_b32 s44, 0xaaaaaaaa
  s_mov_b32 s45, 0xaaaaaaaa
  s_mov_b32 s50, 0x3e0293ee
  s_mov_b32 s51, 0x3e0293ee
  s_mov_b32 s62, 0x10000
  s_lshl_b32 s52, s17, 10
  s_add_u32 s52, s52, 156672
  s_lshl_b32 s53, s17, 2
  s_add_u32 s53, s53, 160768
  s_lshl_b32 s54, s17, 9
  s_add_u32 s54, s54, 161792
  s_lshl_b32 s55, s17, 10
  s_add_u32 s28, s55, 80216064
  s_add_u32 s55, s55, 147456
  s_mul_i32 s25, s16, 9216
  s_mul_i32 s19, s17, 2304
  s_add_u32 s25, s25, s19
  s_add_u32 s25, s25, 79691776
  s_lshl_b32 s19, s16, 2
  s_add_u32 s19, s19, s17
  s_lshl_b32 s26, s19, 11
  s_lshl_b32 s27, s19, 10
  s_lshl_b32 s24, s16, 1
  s_add_u32 s24, s24, s17
  s_cmp_lt_u32 s17, 2
  s_cbranch_scc1 Ltask_1
  s_mov_b32 s24, -1
  s_cmp_eq_u32 s17, 2
  s_cbranch_scc0 Ltask_1
  s_cmp_lt_u32 s16, 8
  s_cbranch_scc0 Ltask_1
  s_add_u32 s24, s16, 64
Ltask_1:
  s_cmp_eq_u32 s24, -1
  s_cbranch_scc1 Ltask_1x
  s_lshl_b32 s24, s24, 7
Ltask_1x:
  s_add_u32 s49, s24, 79691776
  s_add_u32 s46, s49, 73728
  s_add_u32 s47, s49, 147456
  s_add_u32 s48, s49, 221184
  v_and_b32 v20, 15, v0
  v_lshrrev_b32 v21, 4, v0
  v_and_b32 v22, 7, v0
  v_and_b32 v23, 1, v21
  v_lshlrev_b32 v23, 2, v23
  v_sub_u32 v23, v22, v23
  v_mov_b32 v24, 0x3f80
  v_mov_b32 v25, 0x3f800000
  v_mov_b32 v2, 0
  v_mov_b32 v3, 0
  v_cmp_eq_u32 vcc, 0, v23
  s_nop 1
  v_cndmask_b32 v2, v2, v24, vcc
  v_cmp_eq_u32 vcc, 1, v23
  s_nop 1
  v_cndmask_b32 v2, v2, v25, vcc
  v_cmp_eq_u32 vcc, 2, v23
  s_nop 1
  v_cndmask_b32 v3, v3, v24, vcc
  v_cmp_eq_u32 vcc, 3, v23
  s_nop 1
  v_cndmask_b32 v3, v3, v25, vcc
  v_lshlrev_b32 v1, 4, v0
  v_add_u32 v4, 147456, v1
  s_mul_i32 s19, s17, 36864
  v_add_u32 v5, s19, v1
  v_lshlrev_b32 v23, 3, v21
  v_add_u32 v23, v23, v22
  v_lshlrev_b32 v7, 4, v23
  v_lshrrev_b32 v23, 3, v20
  v_lshlrev_b32 v23, 9, v23
  v_add_u32 v23, v23, v7
  v_add_u32 v6, 161792, v23
  v_lshrrev_b32 v23, 1, v21
  v_lshlrev_b32 v23, 8, v23
  v_lshlrev_b32 v24, 4, v20
  v_add_u32 v23, v23, v24
  v_and_b32 v24, 1, v21
  v_lshlrev_b32 v24, 3, v24
  v_add_u32 v8, v23, v24
  v_lshrrev_b32 v23, 3, v0
  v_mul_u32_u24 v23, 9216, v23
  v_lshlrev_b32 v24, 4, v22
  v_add_u32 v9, v23, v24
  v_lshlrev_b32 v23, 2, v21
  v_add_u32 v10, v24, v23
  v_mov_b32 v24, 0x4444
  v_mov_b32 v25, 0xeeee
  v_cmp_lt_u32 vcc, 7, v20
  s_nop 1
  v_cndmask_b32 v0, v24, v25, vcc
  v_mov_b32 v20, -1
  v_mov_b32 v21, -1
  v_mov_b32 v22, -1
  v_mov_b32 v23, -1
  buffer_store_dwordx4 v[20:23], v1, s[8:11], s25 offen sc1
  buffer_store_dwordx4 v[20:23], v1, s[8:11], s25 offen offset:1024 sc1
  s_mov_b64 exec, 0xffff
  buffer_store_dwordx4 v[20:23], v1, s[8:11], s25 offen offset:2048 sc1
  s_mov_b64 exec, 0x3ffff
  s_lshl_b32 s19, s17, 14
  s_mul_i32 s20, s16, 288
  s_add_u32 s19, s19, s20
  s_add_u32 s19, s19, 80216064
  buffer_store_dwordx4 v[20:23], v1, s[8:11], s19 offen sc1
  s_mov_b64 exec, -1
  s_lshl_b32 s95, s16, 9
  s_add_u32 s95, s95, 80510976
  v_mov_b32 v20, 0
  v_mov_b32 v21, 0
  v_lshrrev_b32 v22, 1, v1
  buffer_store_dwordx2 v[20:21], v22, s[8:11], s95 offen sc1
  s_mov_b64 exec, 1
  s_lshl_b32 s19, s16, 7
  s_add_u32 s19, s19, 80486400
  buffer_store_dword v20, off, s[8:11], s19 sc1
  s_add_u32 s19, s19, 8192
  buffer_store_dword v20, off, s[8:11], s19 sc1
  s_add_u32 s19, s19, 4096
  buffer_store_dword v20, off, s[8:11], s19 sc1
  s_mov_b64 exec, -1
  s_mov_b32 s12, s84
  s_mov_b32 s13, s85
  s_mov_b32 s14, 4718592
  s_mov_b32 s15, 0x00020000
  s_mul_i32 s19, s16, 147456
  s_mul_i32 s20, s17, 36864
  s_add_u32 s19, s19, s20
  s_mov_b32 m0, s20
  s_nop 0
  buffer_load_dwordx4 v1, s[12:15], s19 offen lds
  s_add_u32 s19, s19, 1024
  s_add_u32 m0, m0, 1024
  s_nop 0
  buffer_load_dwordx4 v1, s[12:15], s19 offen lds
  s_add_u32 s19, s19, 1024
  s_add_u32 m0, m0, 1024
  s_nop 0
  buffer_load_dwordx4 v1, s[12:15], s19 offen lds
  s_add_u32 s19, s19, 1024
  s_add_u32 m0, m0, 1024
  s_nop 0
  buffer_load_dwordx4 v1, s[12:15], s19 offen lds
  s_add_u32 s19, s19, 1024
  s_add_u32 m0, m0, 1024
  s_nop 0
  buffer_load_dwordx4 v1, s[12:15], s19 offen lds
  s_add_u32 s19, s19, 1024
  s_add_u32 m0, m0, 1024
  s_nop 0
  buffer_load_dwordx4 v1, s[12:15], s19 offen lds
  s_add_u32 s19, s19, 1024
  s_add_u32 m0, m0, 1024
  s_nop 0
  buffer_load_dwordx4 v1, s[12:15], s19 offen lds
  s_add_u32 s19, s19, 1024
  s_add_u32 m0, m0, 1024
  s_nop 0
  buffer_load_dwordx4 v1, s[12:15], s19 offen lds
  s_add_u32 s19, s19, 1024
  s_add_u32 m0, m0, 1024
  s_nop 0
  buffer_load_dwordx4 v1, s[12:15], s19 offen lds
  s_add_u32 s19, s19, 1024
  s_add_u32 m0, m0, 1024
  s_nop 0
  buffer_load_dwordx4 v1, s[12:15], s19 offen lds
  s_add_u32 s19, s19, 1024
  s_add_u32 m0, m0, 1024
  s_nop 0
  buffer_load_dwordx4 v1, s[12:15], s19 offen lds
  s_add_u32 s19, s19, 1024
  s_add_u32 m0, m0, 1024
  s_nop 0
  buffer_load_dwordx4 v1, s[12:15], s19 offen lds
  s_add_u32 s19, s19, 1024
  s_add_u32 m0, m0, 1024
  s_nop 0
  buffer_load_dwordx4 v1, s[12:15], s19 offen lds
  s_add_u32 s19, s19, 1024
  s_add_u32 m0, m0, 1024
  s_nop 0
  buffer_load_dwordx4 v1, s[12:15], s19 offen lds
  s_add_u32 s19, s19, 1024
  s_add_u32 m0, m0, 1024
  s_nop 0
  buffer_load_dwordx4 v1, s[12:15], s19 offen lds
  s_add_u32 s19, s19, 1024
  s_add_u32 m0, m0, 1024
  s_nop 0
  buffer_load_dwordx4 v1, s[12:15], s19 offen lds
  s_add_u32 s19, s19, 1024
  s_add_u32 m0, m0, 1024
  s_nop 0
  buffer_load_dwordx4 v1, s[12:15], s19 offen lds
  s_add_u32 s19, s19, 1024
  s_add_u32 m0, m0, 1024
  s_nop 0
  buffer_load_dwordx4 v1, s[12:15], s19 offen lds
  s_add_u32 s19, s19, 1024
  s_add_u32 m0, m0, 1024
  s_nop 0
  buffer_load_dwordx4 v1, s[12:15], s19 offen lds
  s_add_u32 s19, s19, 1024
  s_add_u32 m0, m0, 1024
  s_nop 0
  buffer_load_dwordx4 v1, s[12:15], s19 offen lds
  s_add_u32 s19, s19, 1024
  s_add_u32 m0, m0, 1024
  s_nop 0
  buffer_load_dwordx4 v1, s[12:15], s19 offen lds
  s_add_u32 s19, s19, 1024
  s_add_u32 m0, m0, 1024
  s_nop 0
  buffer_load_dwordx4 v1, s[12:15], s19 offen lds
  s_add_u32 s19, s19, 1024
  s_add_u32 m0, m0, 1024
  s_nop 0
  buffer_load_dwordx4 v1, s[12:15], s19 offen lds
  s_add_u32 s19, s19, 1024
  s_add_u32 m0, m0, 1024
  s_nop 0
  buffer_load_dwordx4 v1, s[12:15], s19 offen lds
  s_add_u32 s19, s19, 1024
  s_add_u32 m0, m0, 1024
  s_nop 0
  buffer_load_dwordx4 v1, s[12:15], s19 offen lds
  s_add_u32 s19, s19, 1024
  s_add_u32 m0, m0, 1024
  s_nop 0
  buffer_load_dwordx4 v1, s[12:15], s19 offen lds
  s_add_u32 s19, s19, 1024
  s_add_u32 m0, m0, 1024
  s_nop 0
  buffer_load_dwordx4 v1, s[12:15], s19 offen lds
  s_add_u32 s19, s19, 1024
  s_add_u32 m0, m0, 1024
  s_nop 0
  buffer_load_dwordx4 v1, s[12:15], s19 offen lds
  s_add_u32 s19, s19, 1024
  s_add_u32 m0, m0, 1024
  s_nop 0
  buffer_load_dwordx4 v1, s[12:15], s19 offen lds
  s_add_u32 s19, s19, 1024
  s_add_u32 m0, m0, 1024
  s_nop 0
  buffer_load_dwordx4 v1, s[12:15], s19 offen lds
  s_add_u32 s19, s19, 1024
  s_add_u32 m0, m0, 1024
  s_nop 0
  buffer_load_dwordx4 v1, s[12:15], s19 offen lds
  s_add_u32 s19, s19, 1024
  s_add_u32 m0, m0, 1024
  s_nop 0
  buffer_load_dwordx4 v1, s[12:15], s19 offen lds
  s_add_u32 s19, s19, 1024
  s_add_u32 m0, m0, 1024
  s_nop 0
  buffer_load_dwordx4 v1, s[12:15], s19 offen lds
  s_add_u32 s19, s19, 1024
  s_add_u32 m0, m0, 1024
  s_nop 0
  buffer_load_dwordx4 v1, s[12:15], s19 offen lds
  s_add_u32 s19, s19, 1024
  s_add_u32 m0, m0, 1024
  s_nop 0
  buffer_load_dwordx4 v1, s[12:15], s19 offen lds
  s_add_u32 s19, s19, 1024
  s_add_u32 m0, m0, 1024
  s_nop 0
  buffer_load_dwordx4 v1, s[12:15], s19 offen lds
  s_waitcnt vmcnt(36)
  s_barrier
  s_cmp_eq_u32 s17, 0
  s_cbranch_scc0 Lsig_2
  s_getreg_b32 s19, hwreg(HW_REG_XCC_ID, 0, 4)
  s_mul_i32 s20, s19, s19
  s_lshl_b32 s20, s20, 14
  s_lshl_b32 s19, s19, 6
  s_add_u32 s19, s19, s20
  s_add_u32 s19, s19, 1
  v_mov_b32 v22, s19
  v_mov_b32 v23, 64
  s_mov_b64 exec, 1
  buffer_atomic_add v22, v23, s[64:67], 0 offen sc1
  s_mov_b64 exec, -1
Lsig_2:
  v_lshrrev_b32 v26, 4, v1
  v_lshrrev_b32 v21, 4, v26
  v_bfe_u32 v27, v26, 2, 2
  v_and_b32 v28, 3, v26
  v_lshrrev_b32 v29, 1, v27
  v_lshlrev_b32 v29, 5, v29
  v_and_b32 v30, 1, v21
  v_lshlrev_b32 v30, 4, v30
  v_lshrrev_b32 v35, 1, v21
  v_lshlrev_b32 v35, 2, v35
  v_add_u32 v30, v30, v35
  v_and_b32 v35, 1, v27
  v_add_u32 v30, v30, v35
  v_add_u32 v29, v29, v30
  v_mul_u32_u24 v29, 1152, v29
  v_lshlrev_b32 v35, 3, v28
  s_mul_i32 s21, s17, 288
  v_add_u32 v35, s21, v35
  v_mul_u32_u24 v70, 1152, v30
  v_add_u32 v70, v70, v35
  v_lshrrev_b32 v71, 1, v27
  v_lshlrev_b32 v71, 5, v71
  v_add_u32 v70, v70, v71
  v_add_u32 v71, 36864, v70
  v_add_u32 v72, 73728, v70
  v_add_u32 v73, 110592, v70
  v_add_u32 v30, v29, v35
  v_add_u32 v31, 73728, v30
  v_lshrrev_b32 v32, 1, v21
  v_lshlrev_b32 v32, 4, v32
  v_and_b32 v33, 1, v21
  v_add_u32 v32, v32, v33
  v_lshrrev_b32 v75, 1, v27
  v_lshlrev_b32 v74, 3, v75
  v_add_u32 v32, v32, v74
  v_and_b32 v74, 1, v27
  v_lshlrev_b32 v74, 1, v74
  v_add_u32 v32, v32, v74
  v_lshlrev_b32 v32, 8, v32
  v_or_b32 v74, v74, v33
  v_lshlrev_b32 v75, 2, v75
  v_or_b32 v74, v74, v75
  s_lshl_b32 s21, s17, 1
  v_xor_b32 v74, s21, v74
  v_lshlrev_b32 v74, 5, v74
  v_lshlrev_b32 v33, 3, v28
  v_add3_u32 v32, v32, v74, v33
  v_add_u32 v32, 147456, v32
  v_xor_b32 v76, 32, v32
  v_lshlrev_b32 v33, 13, v21
  v_and_b32 v34, 15, v26
  v_lshlrev_b32 v34, 4, v34
  v_add_u32 v33, v33, v34
  v_bfe_u32 v75, v26, 1, 3
  v_xor_b32 v74, v21, v75
  v_lshlrev_b32 v74, 5, v74
  v_and_b32 v75, 1, v26
  v_lshlrev_b32 v75, 4, v75
  v_add_u32 v74, v74, v75
  v_lshlrev_b32 v75, 8, v21
  v_add_u32 v74, v74, v75
  s_lshl_b32 s21, s17, 12
  s_add_u32 s21, s21, 147456
  v_add_u32 v34, s21, v74
  v_xor_b32 v77, 128, v34
  s_mov_b32 s12, s78
  s_mov_b32 s13, s79
  s_mov_b32 s14, 4718592
  s_mov_b32 s15, 0x00020000
  s_lshl_b32 s19, s17, 4
  s_add_u32 s19, s19, 0
  s_lshl_b32 s19, s19, 13
  s_lshl_b32 s20, s16, 8
  s_add_u32 s19, s19, s20
  buffer_load_dwordx4 v[36:39], v33, s[12:15], s19 offen
  s_add_u32 s19, s19, 32768
  buffer_load_dwordx4 v[40:43], v33, s[12:15], s19 offen
  s_add_u32 s19, s19, 32768
  buffer_load_dwordx4 v[44:47], v33, s[12:15], s19 offen
  s_add_u32 s19, s19, 32768
  buffer_load_dwordx4 v[48:51], v33, s[12:15], s19 offen
  s_lshl_b32 s19, s17, 4
  s_add_u32 s19, s19, 64
  s_lshl_b32 s19, s19, 13
  s_lshl_b32 s20, s16, 8
  s_add_u32 s19, s19, s20
  buffer_load_dwordx4 v[52:55], v33, s[12:15], s19 offen
  s_add_u32 s19, s19, 32768
  buffer_load_dwordx4 v[56:59], v33, s[12:15], s19 offen
  s_add_u32 s19, s19, 32768
  buffer_load_dwordx4 v[60:63], v33, s[12:15], s19 offen
  s_add_u32 s19, s19, 32768
  buffer_load_dwordx4 v[64:67], v33, s[12:15], s19 offen
  s_waitcnt vmcnt(8)
  s_barrier
  ds_read_b64_tr_b16 a[0:1], v30 offset:0
  ds_read_b64_tr_b16 a[2:3], v30 offset:2304
  ds_read_b64_tr_b16 a[4:5], v30 offset:9216
  ds_read_b64_tr_b16 a[6:7], v30 offset:11520
  ds_read_b64_tr_b16 a[8:9], v31 offset:0
  ds_read_b64_tr_b16 a[10:11], v31 offset:2304
  ds_read_b64_tr_b16 a[12:13], v31 offset:9216
  ds_read_b64_tr_b16 a[14:15], v31 offset:11520
  ds_read_b64_tr_b16 a[16:17], v70 offset:32
  ds_read_b64_tr_b16 a[18:19], v70 offset:2336
  ds_read_b64_tr_b16 a[20:21], v70 offset:9248
  ds_read_b64_tr_b16 a[22:23], v70 offset:11552
  ds_read_b64_tr_b16 a[24:25], v71 offset:32
  ds_read_b64_tr_b16 a[26:27], v71 offset:2336
  ds_read_b64_tr_b16 a[28:29], v71 offset:9248
  ds_read_b64_tr_b16 a[30:31], v71 offset:11552
  ds_read_b64_tr_b16 a[32:33], v72 offset:32
  ds_read_b64_tr_b16 a[34:35], v72 offset:2336
  ds_read_b64_tr_b16 a[36:37], v72 offset:9248
  ds_read_b64_tr_b16 a[38:39], v72 offset:11552
  ds_read_b64_tr_b16 a[40:41], v73 offset:32
  ds_read_b64_tr_b16 a[42:43], v73 offset:2336
  ds_read_b64_tr_b16 a[44:45], v73 offset:9248
  ds_read_b64_tr_b16 a[46:47], v73 offset:11552
  ds_read_b64_tr_b16 a[48:49], v70 offset:96
  ds_read_b64_tr_b16 a[50:51], v70 offset:2400
  ds_read_b64_tr_b16 a[52:53], v70 offset:9312
  ds_read_b64_tr_b16 a[54:55], v70 offset:11616
  ds_read_b64_tr_b16 a[56:57], v71 offset:96
  ds_read_b64_tr_b16 a[58:59], v71 offset:2400
  ds_read_b64_tr_b16 a[60:61], v71 offset:9312
  ds_read_b64_tr_b16 a[62:63], v71 offset:11616
  ds_read_b64_tr_b16 a[64:65], v72 offset:96
  ds_read_b64_tr_b16 a[66:67], v72 offset:2400
  ds_read_b64_tr_b16 a[68:69], v72 offset:9312
  ds_read_b64_tr_b16 a[70:71], v72 offset:11616
  ds_read_b64_tr_b16 a[72:73], v73 offset:96
  ds_read_b64_tr_b16 a[74:75], v73 offset:2400
  ds_read_b64_tr_b16 a[76:77], v73 offset:9312
  ds_read_b64_tr_b16 a[78:79], v73 offset:11616
  ds_read_b64_tr_b16 a[80:81], v70 offset:160
  ds_read_b64_tr_b16 a[82:83], v70 offset:2464
  ds_read_b64_tr_b16 a[84:85], v70 offset:9376
  ds_read_b64_tr_b16 a[86:87], v70 offset:11680
  ds_read_b64_tr_b16 a[88:89], v71 offset:160
  ds_read_b64_tr_b16 a[90:91], v71 offset:2464
  ds_read_b64_tr_b16 a[92:93], v71 offset:9376
  ds_read_b64_tr_b16 a[94:95], v71 offset:11680
  ds_read_b64_tr_b16 a[96:97], v72 offset:160
  ds_read_b64_tr_b16 a[98:99], v72 offset:2464
  ds_read_b64_tr_b16 a[100:101], v72 offset:9376
  ds_read_b64_tr_b16 a[102:103], v72 offset:11680
  ds_read_b64_tr_b16 a[104:105], v73 offset:160
  ds_read_b64_tr_b16 a[106:107], v73 offset:2464
  ds_read_b64_tr_b16 a[108:109], v73 offset:9376
  ds_read_b64_tr_b16 a[110:111], v73 offset:11680
  ds_read_b64_tr_b16 a[112:113], v70 offset:224
  ds_read_b64_tr_b16 a[114:115], v70 offset:2528
  ds_read_b64_tr_b16 a[116:117], v70 offset:9440
  ds_read_b64_tr_b16 a[118:119], v70 offset:11744
  ds_read_b64_tr_b16 a[120:121], v71 offset:224
  ds_read_b64_tr_b16 a[122:123], v71 offset:2528
  ds_read_b64_tr_b16 a[124:125], v71 offset:9440
  ds_read_b64_tr_b16 a[126:127], v71 offset:11744
  ds_read_b64_tr_b16 a[128:129], v72 offset:224
  ds_read_b64_tr_b16 a[130:131], v72 offset:2528
  ds_read_b64_tr_b16 a[132:133], v72 offset:9440
  ds_read_b64_tr_b16 a[134:135], v72 offset:11744
  ds_read_b64_tr_b16 a[136:137], v73 offset:224
  ds_read_b64_tr_b16 a[138:139], v73 offset:2528
  ds_read_b64_tr_b16 a[140:141], v73 offset:9440
  ds_read_b64_tr_b16 a[142:143], v73 offset:11744
  s_waitcnt lgkmcnt(0)
  s_barrier
  s_lshl_b32 s19, s17, 4
  s_add_u32 s19, s19, 128
  s_lshl_b32 s19, s19, 13
  s_lshl_b32 s20, s16, 8
  s_add_u32 s19, s19, s20
  buffer_load_dwordx4 v[240:243], v33, s[12:15], s19 offen
  s_add_u32 s19, s19, 32768
  buffer_load_dwordx4 v[244:247], v33, s[12:15], s19 offen
  s_add_u32 s19, s19, 32768
  buffer_load_dwordx4 v[248:251], v33, s[12:15], s19 offen
  s_add_u32 s19, s19, 32768
  buffer_load_dwordx4 v[252:255], v33, s[12:15], s19 offen
  s_waitcnt vmcnt(8)
  ds_write_b128 v34, v[36:39] offset:0
  ds_write_b128 v34, v[40:43] offset:1024
  ds_write_b128 v77, v[44:47] offset:2048
  ds_write_b128 v77, v[48:51] offset:3072
  s_waitcnt lgkmcnt(0)
  s_barrier
  ds_read_b64_tr_b16 a[144:145], v32 offset:0
  ds_read_b64_tr_b16 a[146:147], v32 offset:1024
  ds_read_b64_tr_b16 a[148:149], v32 offset:8192
  ds_read_b64_tr_b16 a[150:151], v32 offset:9216
  ds_read_b64_tr_b16 a[152:153], v76 offset:0
  ds_read_b64_tr_b16 a[154:155], v76 offset:1024
  ds_read_b64_tr_b16 a[156:157], v76 offset:8192
  ds_read_b64_tr_b16 a[158:159], v76 offset:9216
  s_waitcnt lgkmcnt(0)
  s_barrier
  s_lshl_b32 s19, s17, 4
  s_add_u32 s19, s19, 192
  s_lshl_b32 s19, s19, 13
  s_lshl_b32 s20, s16, 8
  s_add_u32 s19, s19, s20
  buffer_load_dwordx4 v[36:39], v33, s[12:15], s19 offen
  s_add_u32 s19, s19, 32768
  buffer_load_dwordx4 v[40:43], v33, s[12:15], s19 offen
  s_add_u32 s19, s19, 32768
  buffer_load_dwordx4 v[44:47], v33, s[12:15], s19 offen
  s_add_u32 s19, s19, 32768
  buffer_load_dwordx4 v[48:51], v33, s[12:15], s19 offen
  s_waitcnt vmcnt(8)
  ds_write_b128 v34, v[52:55] offset:0
  ds_write_b128 v34, v[56:59] offset:1024
  ds_write_b128 v77, v[60:63] offset:2048
  ds_write_b128 v77, v[64:67] offset:3072
  s_waitcnt lgkmcnt(0)
  s_barrier
  ds_read_b64_tr_b16 a[176:177], v32 offset:0
  ds_read_b64_tr_b16 a[178:179], v32 offset:1024
  ds_read_b64_tr_b16 a[180:181], v32 offset:8192
  ds_read_b64_tr_b16 a[182:183], v32 offset:9216
  ds_read_b64_tr_b16 a[184:185], v76 offset:0
  ds_read_b64_tr_b16 a[186:187], v76 offset:1024
  ds_read_b64_tr_b16 a[188:189], v76 offset:8192
  ds_read_b64_tr_b16 a[190:191], v76 offset:9216
  s_waitcnt lgkmcnt(0)
  s_barrier
  s_lshl_b32 s19, s17, 4
  s_add_u32 s19, s19, 256
  s_lshl_b32 s19, s19, 13
  s_lshl_b32 s20, s16, 8
  s_add_u32 s19, s19, s20
  buffer_load_dwordx4 v[52:55], v33, s[12:15], s19 offen
  s_add_u32 s19, s19, 32768
  buffer_load_dwordx4 v[56:59], v33, s[12:15], s19 offen
  s_add_u32 s19, s19, 32768
  buffer_load_dwordx4 v[60:63], v33, s[12:15], s19 offen
  s_add_u32 s19, s19, 32768
  buffer_load_dwordx4 v[64:67], v33, s[12:15], s19 offen
  s_waitcnt vmcnt(8)
  ds_write_b128 v34, v[240:243] offset:0
  ds_write_b128 v34, v[244:247] offset:1024
  ds_write_b128 v77, v[248:251] offset:2048
  ds_write_b128 v77, v[252:255] offset:3072
  s_waitcnt lgkmcnt(0)
  s_barrier
  ds_read_b64_tr_b16 a[208:209], v32 offset:0
  ds_read_b64_tr_b16 a[210:211], v32 offset:1024
  ds_read_b64_tr_b16 a[212:213], v32 offset:8192
  ds_read_b64_tr_b16 a[214:215], v32 offset:9216
  ds_read_b64_tr_b16 a[216:217], v76 offset:0
  ds_read_b64_tr_b16 a[218:219], v76 offset:1024
  ds_read_b64_tr_b16 a[220:221], v76 offset:8192
  ds_read_b64_tr_b16 a[222:223], v76 offset:9216
  s_waitcnt lgkmcnt(0)
  s_barrier
  s_lshl_b32 s19, s17, 4
  s_add_u32 s19, s19, 320
  s_lshl_b32 s19, s19, 13
  s_lshl_b32 s20, s16, 8
  s_add_u32 s19, s19, s20
  buffer_load_dwordx4 v[240:243], v33, s[12:15], s19 offen
  s_add_u32 s19, s19, 32768
  buffer_load_dwordx4 v[244:247], v33, s[12:15], s19 offen
  s_add_u32 s19, s19, 32768
  buffer_load_dwordx4 v[248:251], v33, s[12:15], s19 offen
  s_add_u32 s19, s19, 32768
  buffer_load_dwordx4 v[252:255], v33, s[12:15], s19 offen
  s_waitcnt vmcnt(8)
  ds_write_b128 v34, v[36:39] offset:0
  ds_write_b128 v34, v[40:43] offset:1024
  ds_write_b128 v77, v[44:47] offset:2048
  ds_write_b128 v77, v[48:51] offset:3072
  s_waitcnt lgkmcnt(0)
  s_barrier
  ds_read_b64_tr_b16 a[240:241], v32 offset:0
  ds_read_b64_tr_b16 a[242:243], v32 offset:1024
  ds_read_b64_tr_b16 a[244:245], v32 offset:8192
  ds_read_b64_tr_b16 a[246:247], v32 offset:9216
  ds_read_b64_tr_b16 a[248:249], v76 offset:0
  ds_read_b64_tr_b16 a[250:251], v76 offset:1024
  ds_read_b64_tr_b16 a[252:253], v76 offset:8192
  ds_read_b64_tr_b16 a[254:255], v76 offset:9216
  s_waitcnt lgkmcnt(0)
  s_barrier
  s_lshl_b32 s19, s17, 4
  s_add_u32 s19, s19, 384
  s_lshl_b32 s19, s19, 13
  s_lshl_b32 s20, s16, 8
  s_add_u32 s19, s19, s20
  buffer_load_dwordx4 v[36:39], v33, s[12:15], s19 offen
  s_add_u32 s19, s19, 32768
  buffer_load_dwordx4 v[40:43], v33, s[12:15], s19 offen
  s_add_u32 s19, s19, 32768
  buffer_load_dwordx4 v[44:47], v33, s[12:15], s19 offen
  s_add_u32 s19, s19, 32768
  buffer_load_dwordx4 v[48:51], v33, s[12:15], s19 offen
  s_waitcnt vmcnt(8)
  ds_write_b128 v34, v[52:55] offset:0
  ds_write_b128 v34, v[56:59] offset:1024
  ds_write_b128 v77, v[60:63] offset:2048
  ds_write_b128 v77, v[64:67] offset:3072
  s_waitcnt lgkmcnt(0)
  s_barrier
  ds_read_b64_tr_b16 v[96:97], v32 offset:0
  ds_read_b64_tr_b16 v[98:99], v32 offset:1024
  ds_read_b64_tr_b16 v[100:101], v32 offset:8192
  ds_read_b64_tr_b16 v[102:103], v32 offset:9216
  ds_read_b64_tr_b16 v[104:105], v76 offset:0
  ds_read_b64_tr_b16 v[106:107], v76 offset:1024
  ds_read_b64_tr_b16 v[108:109], v76 offset:8192
  ds_read_b64_tr_b16 v[110:111], v76 offset:9216
  s_waitcnt lgkmcnt(0)
  s_barrier
  s_lshl_b32 s19, s17, 4
  s_add_u32 s19, s19, 448
  s_lshl_b32 s19, s19, 13
  s_lshl_b32 s20, s16, 8
  s_add_u32 s19, s19, s20
  buffer_load_dwordx4 v[52:55], v33, s[12:15], s19 offen
  s_add_u32 s19, s19, 32768
  buffer_load_dwordx4 v[56:59], v33, s[12:15], s19 offen
  s_add_u32 s19, s19, 32768
  buffer_load_dwordx4 v[60:63], v33, s[12:15], s19 offen
  s_add_u32 s19, s19, 32768
  buffer_load_dwordx4 v[64:67], v33, s[12:15], s19 offen
  s_waitcnt vmcnt(8)
  ds_write_b128 v34, v[240:243] offset:0
  ds_write_b128 v34, v[244:247] offset:1024
  ds_write_b128 v77, v[248:251] offset:2048
  ds_write_b128 v77, v[252:255] offset:3072
  s_waitcnt lgkmcnt(0)
  s_barrier
  ds_read_b64_tr_b16 v[128:129], v32 offset:0
  ds_read_b64_tr_b16 v[130:131], v32 offset:1024
  ds_read_b64_tr_b16 v[132:133], v32 offset:8192
  ds_read_b64_tr_b16 v[134:135], v32 offset:9216
  ds_read_b64_tr_b16 v[136:137], v76 offset:0
  ds_read_b64_tr_b16 v[138:139], v76 offset:1024
  ds_read_b64_tr_b16 v[140:141], v76 offset:8192
  ds_read_b64_tr_b16 v[142:143], v76 offset:9216
  s_waitcnt lgkmcnt(0)
  s_barrier
  s_lshl_b32 s19, s17, 4
  s_add_u32 s19, s19, 512
  s_lshl_b32 s19, s19, 13
  s_lshl_b32 s20, s16, 8
  s_add_u32 s19, s19, s20
  buffer_load_dwordx4 v[240:243], v33, s[12:15], s19 offen
  s_add_u32 s19, s19, 32768
  buffer_load_dwordx4 v[244:247], v33, s[12:15], s19 offen
  s_add_u32 s19, s19, 32768
  buffer_load_dwordx4 v[248:251], v33, s[12:15], s19 offen
  s_add_u32 s19, s19, 32768
  buffer_load_dwordx4 v[252:255], v33, s[12:15], s19 offen
  s_waitcnt vmcnt(8)
  ds_write_b128 v34, v[36:39] offset:0
  ds_write_b128 v34, v[40:43] offset:1024
  ds_write_b128 v77, v[44:47] offset:2048
  ds_write_b128 v77, v[48:51] offset:3072
  s_waitcnt lgkmcnt(0)
  s_barrier
  ds_read_b64_tr_b16 v[160:161], v32 offset:0
  ds_read_b64_tr_b16 v[162:163], v32 offset:1024
  ds_read_b64_tr_b16 v[164:165], v32 offset:8192
  ds_read_b64_tr_b16 v[166:167], v32 offset:9216
  ds_read_b64_tr_b16 v[168:169], v76 offset:0
  ds_read_b64_tr_b16 v[170:171], v76 offset:1024
  ds_read_b64_tr_b16 v[172:173], v76 offset:8192
  ds_read_b64_tr_b16 v[174:175], v76 offset:9216
  s_waitcnt lgkmcnt(0)
  s_barrier
  s_mov_b32 s12, s80
  s_mov_b32 s13, s81
  s_mov_b32 s14, 4718592
  s_mov_b32 s15, 0x00020000
  s_lshl_b32 s19, s17, 4
  s_add_u32 s19, s19, 0
  s_lshl_b32 s19, s19, 13
  s_lshl_b32 s20, s16, 8
  s_add_u32 s19, s19, s20
  buffer_load_dwordx4 v[36:39], v33, s[12:15], s19 offen
  s_add_u32 s19, s19, 32768
  buffer_load_dwordx4 v[40:43], v33, s[12:15], s19 offen
  s_add_u32 s19, s19, 32768
  buffer_load_dwordx4 v[44:47], v33, s[12:15], s19 offen
  s_add_u32 s19, s19, 32768
  buffer_load_dwordx4 v[48:51], v33, s[12:15], s19 offen
  s_waitcnt vmcnt(8)
  ds_write_b128 v34, v[52:55] offset:0
  ds_write_b128 v34, v[56:59] offset:1024
  ds_write_b128 v77, v[60:63] offset:2048
  ds_write_b128 v77, v[64:67] offset:3072
  s_waitcnt lgkmcnt(0)
  s_barrier
  ds_read_b64_tr_b16 v[192:193], v32 offset:0
  ds_read_b64_tr_b16 v[194:195], v32 offset:1024
  ds_read_b64_tr_b16 v[196:197], v32 offset:8192
  ds_read_b64_tr_b16 v[198:199], v32 offset:9216
  ds_read_b64_tr_b16 v[200:201], v76 offset:0
  ds_read_b64_tr_b16 v[202:203], v76 offset:1024
  ds_read_b64_tr_b16 v[204:205], v76 offset:8192
  ds_read_b64_tr_b16 v[206:207], v76 offset:9216
  s_waitcnt lgkmcnt(0)
  s_barrier
  s_lshl_b32 s19, s17, 4
  s_add_u32 s19, s19, 64
  s_lshl_b32 s19, s19, 13
  s_lshl_b32 s20, s16, 8
  s_add_u32 s19, s19, s20
  buffer_load_dwordx4 v[52:55], v33, s[12:15], s19 offen
  s_add_u32 s19, s19, 32768
  buffer_load_dwordx4 v[56:59], v33, s[12:15], s19 offen
  s_add_u32 s19, s19, 32768
  buffer_load_dwordx4 v[60:63], v33, s[12:15], s19 offen
  s_add_u32 s19, s19, 32768
  buffer_load_dwordx4 v[64:67], v33, s[12:15], s19 offen
  s_waitcnt vmcnt(8)
  ds_write_b128 v34, v[240:243] offset:0
  ds_write_b128 v34, v[244:247] offset:1024
  ds_write_b128 v77, v[248:251] offset:2048
  ds_write_b128 v77, v[252:255] offset:3072
  s_waitcnt lgkmcnt(0)
  s_barrier
  ds_read_b64_tr_b16 v[224:225], v32 offset:0
  ds_read_b64_tr_b16 v[226:227], v32 offset:1024
  ds_read_b64_tr_b16 v[228:229], v32 offset:8192
  ds_read_b64_tr_b16 v[230:231], v32 offset:9216
  ds_read_b64_tr_b16 v[232:233], v76 offset:0
  ds_read_b64_tr_b16 v[234:235], v76 offset:1024
  ds_read_b64_tr_b16 v[236:237], v76 offset:8192
  ds_read_b64_tr_b16 v[238:239], v76 offset:9216
  s_waitcnt lgkmcnt(0)
  s_barrier
  s_lshl_b32 s19, s17, 4
  s_add_u32 s19, s19, 128
  s_lshl_b32 s19, s19, 13
  s_lshl_b32 s20, s16, 8
  s_add_u32 s19, s19, s20
  buffer_load_dwordx4 v[240:243], v33, s[12:15], s19 offen
  s_add_u32 s19, s19, 32768
  buffer_load_dwordx4 v[244:247], v33, s[12:15], s19 offen
  s_add_u32 s19, s19, 32768
  buffer_load_dwordx4 v[248:251], v33, s[12:15], s19 offen
  s_add_u32 s19, s19, 32768
  buffer_load_dwordx4 v[252:255], v33, s[12:15], s19 offen
  s_waitcnt vmcnt(8)
  ds_write_b128 v34, v[36:39] offset:0
  ds_write_b128 v34, v[40:43] offset:1024
  ds_write_b128 v77, v[44:47] offset:2048
  ds_write_b128 v77, v[48:51] offset:3072
  s_waitcnt lgkmcnt(0)
  s_barrier
  ds_read_b64_tr_b16 a[160:161], v32 offset:0
  ds_read_b64_tr_b16 a[162:163], v32 offset:1024
  ds_read_b64_tr_b16 a[164:165], v32 offset:8192
  ds_read_b64_tr_b16 a[166:167], v32 offset:9216
  ds_read_b64_tr_b16 v[68:69], v76 offset:0
  ds_read_b64_tr_b16 v[70:71], v76 offset:1024
  ds_read_b64_tr_b16 v[72:73], v76 offset:8192
  ds_read_b64_tr_b16 v[74:75], v76 offset:9216
  s_waitcnt lgkmcnt(0)
  ds_write_b128 v5, v[68:71] offset:0
  ds_write_b128 v5, v[72:75] offset:1024
  s_waitcnt lgkmcnt(0)
  s_barrier
  s_lshl_b32 s19, s17, 4
  s_add_u32 s19, s19, 192
  s_lshl_b32 s19, s19, 13
  s_lshl_b32 s20, s16, 8
  s_add_u32 s19, s19, s20
  buffer_load_dwordx4 v[36:39], v33, s[12:15], s19 offen
  s_add_u32 s19, s19, 32768
  buffer_load_dwordx4 v[40:43], v33, s[12:15], s19 offen
  s_add_u32 s19, s19, 32768
  buffer_load_dwordx4 v[44:47], v33, s[12:15], s19 offen
  s_add_u32 s19, s19, 32768
  buffer_load_dwordx4 v[48:51], v33, s[12:15], s19 offen
  s_waitcnt vmcnt(8)
  ds_write_b128 v34, v[52:55] offset:0
  ds_write_b128 v34, v[56:59] offset:1024
  ds_write_b128 v77, v[60:63] offset:2048
  ds_write_b128 v77, v[64:67] offset:3072
  s_waitcnt lgkmcnt(0)
  s_barrier
  ds_read_b64_tr_b16 a[192:193], v32 offset:0
  ds_read_b64_tr_b16 a[194:195], v32 offset:1024
  ds_read_b64_tr_b16 a[196:197], v32 offset:8192
  ds_read_b64_tr_b16 a[198:199], v32 offset:9216
  ds_read_b64_tr_b16 v[68:69], v76 offset:0
  ds_read_b64_tr_b16 v[70:71], v76 offset:1024
  ds_read_b64_tr_b16 v[72:73], v76 offset:8192
  ds_read_b64_tr_b16 v[74:75], v76 offset:9216
  s_waitcnt lgkmcnt(0)
  ds_write_b128 v5, v[68:71] offset:4096
  ds_write_b128 v5, v[72:75] offset:5120
  s_waitcnt lgkmcnt(0)
  s_barrier
  s_lshl_b32 s19, s17, 4
  s_add_u32 s19, s19, 256
  s_lshl_b32 s19, s19, 13
  s_lshl_b32 s20, s16, 8
  s_add_u32 s19, s19, s20
  buffer_load_dwordx4 v[52:55], v33, s[12:15], s19 offen
  s_add_u32 s19, s19, 32768
  buffer_load_dwordx4 v[56:59], v33, s[12:15], s19 offen
  s_add_u32 s19, s19, 32768
  buffer_load_dwordx4 v[60:63], v33, s[12:15], s19 offen
  s_add_u32 s19, s19, 32768
  buffer_load_dwordx4 v[64:67], v33, s[12:15], s19 offen
  s_waitcnt vmcnt(8)
  ds_write_b128 v34, v[240:243] offset:0
  ds_write_b128 v34, v[244:247] offset:1024
  ds_write_b128 v77, v[248:251] offset:2048
  ds_write_b128 v77, v[252:255] offset:3072
  s_waitcnt lgkmcnt(0)
  s_barrier
  ds_read_b64_tr_b16 a[224:225], v32 offset:0
  ds_read_b64_tr_b16 a[226:227], v32 offset:1024
  ds_read_b64_tr_b16 a[228:229], v32 offset:8192
  ds_read_b64_tr_b16 a[230:231], v32 offset:9216
  ds_read_b64_tr_b16 v[68:69], v76 offset:0
  ds_read_b64_tr_b16 v[70:71], v76 offset:1024
  ds_read_b64_tr_b16 v[72:73], v76 offset:8192
  ds_read_b64_tr_b16 v[74:75], v76 offset:9216
  s_waitcnt lgkmcnt(0)
  ds_write_b128 v5, v[68:71] offset:8192
  ds_write_b128 v5, v[72:75] offset:9216
  s_waitcnt lgkmcnt(0)
  s_barrier
  s_lshl_b32 s19, s17, 4
  s_add_u32 s19, s19, 320
  s_lshl_b32 s19, s19, 13
  s_lshl_b32 s20, s16, 8
  s_add_u32 s19, s19, s20
  buffer_load_dwordx4 v[240:243], v33, s[12:15], s19 offen
  s_add_u32 s19, s19, 32768
  buffer_load_dwordx4 v[244:247], v33, s[12:15], s19 offen
  s_add_u32 s19, s19, 32768
  buffer_load_dwordx4 v[248:251], v33, s[12:15], s19 offen
  s_add_u32 s19, s19, 32768
  buffer_load_dwordx4 v[252:255], v33, s[12:15], s19 offen
  s_waitcnt vmcnt(8)
  ds_write_b128 v34, v[36:39] offset:0
  ds_write_b128 v34, v[40:43] offset:1024
  ds_write_b128 v77, v[44:47] offset:2048
  ds_write_b128 v77, v[48:51] offset:3072
  s_waitcnt lgkmcnt(0)
  s_barrier
  ds_read_b64_tr_b16 v[80:81], v32 offset:0
  ds_read_b64_tr_b16 v[82:83], v32 offset:1024
  ds_read_b64_tr_b16 v[84:85], v32 offset:8192
  ds_read_b64_tr_b16 v[86:87], v32 offset:9216
  ds_read_b64_tr_b16 v[68:69], v76 offset:0
  ds_read_b64_tr_b16 v[70:71], v76 offset:1024
  ds_read_b64_tr_b16 v[72:73], v76 offset:8192
  ds_read_b64_tr_b16 v[74:75], v76 offset:9216
  s_waitcnt lgkmcnt(0)
  ds_write_b128 v5, v[68:71] offset:12288
  ds_write_b128 v5, v[72:75] offset:13312
  s_waitcnt lgkmcnt(0)
  s_barrier
  s_lshl_b32 s19, s17, 4
  s_add_u32 s19, s19, 384
  s_lshl_b32 s19, s19, 13
  s_lshl_b32 s20, s16, 8
  s_add_u32 s19, s19, s20
  buffer_load_dwordx4 v[36:39], v33, s[12:15], s19 offen
  s_add_u32 s19, s19, 32768
  buffer_load_dwordx4 v[40:43], v33, s[12:15], s19 offen
  s_add_u32 s19, s19, 32768
  buffer_load_dwordx4 v[44:47], v33, s[12:15], s19 offen
  s_add_u32 s19, s19, 32768
  buffer_load_dwordx4 v[48:51], v33, s[12:15], s19 offen
  s_waitcnt vmcnt(8)
  ds_write_b128 v34, v[52:55] offset:0
  ds_write_b128 v34, v[56:59] offset:1024
  ds_write_b128 v77, v[60:63] offset:2048
  ds_write_b128 v77, v[64:67] offset:3072
  s_waitcnt lgkmcnt(0)
  s_barrier
  ds_read_b64_tr_b16 v[112:113], v32 offset:0
  ds_read_b64_tr_b16 v[114:115], v32 offset:1024
  ds_read_b64_tr_b16 v[116:117], v32 offset:8192
  ds_read_b64_tr_b16 v[118:119], v32 offset:9216
  ds_read_b64_tr_b16 v[68:69], v76 offset:0
  ds_read_b64_tr_b16 v[70:71], v76 offset:1024
  ds_read_b64_tr_b16 v[72:73], v76 offset:8192
  ds_read_b64_tr_b16 v[74:75], v76 offset:9216
  s_waitcnt lgkmcnt(0)
  ds_write_b128 v5, v[68:71] offset:16384
  ds_write_b128 v5, v[72:75] offset:17408
  s_waitcnt lgkmcnt(0)
  s_barrier
  s_lshl_b32 s19, s17, 4
  s_add_u32 s19, s19, 448
  s_lshl_b32 s19, s19, 13
  s_lshl_b32 s20, s16, 8
  s_add_u32 s19, s19, s20
  buffer_load_dwordx4 v[52:55], v33, s[12:15], s19 offen
  s_add_u32 s19, s19, 32768
  buffer_load_dwordx4 v[56:59], v33, s[12:15], s19 offen
  s_add_u32 s19, s19, 32768
  buffer_load_dwordx4 v[60:63], v33, s[12:15], s19 offen
  s_add_u32 s19, s19, 32768
  buffer_load_dwordx4 v[64:67], v33, s[12:15], s19 offen
  s_waitcnt vmcnt(8)
  ds_write_b128 v34, v[240:243] offset:0
  ds_write_b128 v34, v[244:247] offset:1024
  ds_write_b128 v77, v[248:251] offset:2048
  ds_write_b128 v77, v[252:255] offset:3072
  s_waitcnt lgkmcnt(0)
  s_barrier
  ds_read_b64_tr_b16 v[144:145], v32 offset:0
  ds_read_b64_tr_b16 v[146:147], v32 offset:1024
  ds_read_b64_tr_b16 v[148:149], v32 offset:8192
  ds_read_b64_tr_b16 v[150:151], v32 offset:9216
  ds_read_b64_tr_b16 v[68:69], v76 offset:0
  ds_read_b64_tr_b16 v[70:71], v76 offset:1024
  ds_read_b64_tr_b16 v[72:73], v76 offset:8192
  ds_read_b64_tr_b16 v[74:75], v76 offset:9216
  s_waitcnt lgkmcnt(0)
  ds_write_b128 v5, v[68:71] offset:20480
  ds_write_b128 v5, v[72:75] offset:21504
  s_waitcnt lgkmcnt(0)
  s_barrier
  s_mov_b32 s12, s82
  s_mov_b32 s13, s83
  s_mov_b32 s14, 4718592
  s_mov_b32 s15, 0x00020000
  s_lshl_b32 s19, s17, 4
  s_add_u32 s19, s19, 0
  s_lshl_b32 s19, s19, 13
  s_lshl_b32 s20, s16, 8
  s_add_u32 s19, s19, s20
  buffer_load_dwordx4 v[240:243], v33, s[12:15], s19 offen
  s_add_u32 s19, s19, 32768
  buffer_load_dwordx4 v[244:247], v33, s[12:15], s19 offen
  s_add_u32 s19, s19, 32768
  buffer_load_dwordx4 v[248:251], v33, s[12:15], s19 offen
  s_add_u32 s19, s19, 32768
  buffer_load_dwordx4 v[252:255], v33, s[12:15], s19 offen
  s_waitcnt vmcnt(8)
  ds_write_b128 v34, v[36:39] offset:0
  ds_write_b128 v34, v[40:43] offset:1024
  ds_write_b128 v77, v[44:47] offset:2048
  ds_write_b128 v77, v[48:51] offset:3072
  s_waitcnt lgkmcnt(0)
  s_barrier
  ds_read_b64_tr_b16 v[176:177], v32 offset:0
  ds_read_b64_tr_b16 v[178:179], v32 offset:1024
  ds_read_b64_tr_b16 v[180:181], v32 offset:8192
  ds_read_b64_tr_b16 v[182:183], v32 offset:9216
  ds_read_b64_tr_b16 v[68:69], v76 offset:0
  ds_read_b64_tr_b16 v[70:71], v76 offset:1024
  ds_read_b64_tr_b16 v[72:73], v76 offset:8192
  ds_read_b64_tr_b16 v[74:75], v76 offset:9216
  s_waitcnt lgkmcnt(0)
  ds_write_b128 v5, v[68:71] offset:24576
  ds_write_b128 v5, v[72:75] offset:25600
  s_waitcnt lgkmcnt(0)
  s_barrier
  s_lshl_b32 s19, s17, 4
  s_add_u32 s19, s19, 64
  s_lshl_b32 s19, s19, 13
  s_lshl_b32 s20, s16, 8
  s_add_u32 s19, s19, s20
  buffer_load_dwordx4 v[36:39], v33, s[12:15], s19 offen
  s_add_u32 s19, s19, 32768
  buffer_load_dwordx4 v[40:43], v33, s[12:15], s19 offen
  s_add_u32 s19, s19, 32768
  buffer_load_dwordx4 v[44:47], v33, s[12:15], s19 offen
  s_add_u32 s19, s19, 32768
  buffer_load_dwordx4 v[48:51], v33, s[12:15], s19 offen
  s_waitcnt vmcnt(8)
  ds_write_b128 v34, v[52:55] offset:0
  ds_write_b128 v34, v[56:59] offset:1024
  ds_write_b128 v77, v[60:63] offset:2048
  ds_write_b128 v77, v[64:67] offset:3072
  s_waitcnt lgkmcnt(0)
  s_barrier
  ds_read_b64_tr_b16 v[208:209], v32 offset:0
  ds_read_b64_tr_b16 v[210:211], v32 offset:1024
  ds_read_b64_tr_b16 v[212:213], v32 offset:8192
  ds_read_b64_tr_b16 v[214:215], v32 offset:9216
  ds_read_b64_tr_b16 v[68:69], v76 offset:0
  ds_read_b64_tr_b16 v[70:71], v76 offset:1024
  ds_read_b64_tr_b16 v[72:73], v76 offset:8192
  ds_read_b64_tr_b16 v[74:75], v76 offset:9216
  s_waitcnt lgkmcnt(0)
  ds_write_b128 v5, v[68:71] offset:28672
  ds_write_b128 v5, v[72:75] offset:29696
  s_waitcnt lgkmcnt(0)
  s_barrier
  s_lshl_b32 s19, s17, 4
  s_add_u32 s19, s19, 128
  s_lshl_b32 s19, s19, 13
  s_lshl_b32 s20, s16, 8
  s_add_u32 s19, s19, s20
  buffer_load_dwordx4 v[52:55], v33, s[12:15], s19 offen
  s_add_u32 s19, s19, 32768
  buffer_load_dwordx4 v[56:59], v33, s[12:15], s19 offen
  s_add_u32 s19, s19, 32768
  buffer_load_dwordx4 v[60:63], v33, s[12:15], s19 offen
  s_add_u32 s19, s19, 32768
  buffer_load_dwordx4 v[64:67], v33, s[12:15], s19 offen
  s_waitcnt vmcnt(8)
  ds_write_b128 v34, v[240:243] offset:0
  ds_write_b128 v34, v[244:247] offset:1024
  ds_write_b128 v77, v[248:251] offset:2048
  ds_write_b128 v77, v[252:255] offset:3072
  s_waitcnt lgkmcnt(0)
  s_barrier
  ds_read_b64_tr_b16 a[168:169], v32 offset:0
  ds_read_b64_tr_b16 a[170:171], v32 offset:1024
  ds_read_b64_tr_b16 a[172:173], v32 offset:8192
  ds_read_b64_tr_b16 a[174:175], v32 offset:9216
  ds_read_b64_tr_b16 v[68:69], v76 offset:0
  ds_read_b64_tr_b16 v[70:71], v76 offset:1024
  ds_read_b64_tr_b16 v[72:73], v76 offset:8192
  ds_read_b64_tr_b16 v[74:75], v76 offset:9216
  s_waitcnt lgkmcnt(0)
  ds_write_b128 v5, v[68:71] offset:2048
  ds_write_b128 v5, v[72:75] offset:3072
  s_waitcnt lgkmcnt(0)
  s_barrier
  s_lshl_b32 s19, s17, 4
  s_add_u32 s19, s19, 192
  s_lshl_b32 s19, s19, 13
  s_lshl_b32 s20, s16, 8
  s_add_u32 s19, s19, s20
  buffer_load_dwordx4 v[240:243], v33, s[12:15], s19 offen
  s_add_u32 s19, s19, 32768
  buffer_load_dwordx4 v[244:247], v33, s[12:15], s19 offen
  s_add_u32 s19, s19, 32768
  buffer_load_dwordx4 v[248:251], v33, s[12:15], s19 offen
  s_add_u32 s19, s19, 32768
  buffer_load_dwordx4 v[252:255], v33, s[12:15], s19 offen
  s_waitcnt vmcnt(8)
  ds_write_b128 v34, v[36:39] offset:0
  ds_write_b128 v34, v[40:43] offset:1024
  ds_write_b128 v77, v[44:47] offset:2048
  ds_write_b128 v77, v[48:51] offset:3072
  s_waitcnt lgkmcnt(0)
  s_barrier
  ds_read_b64_tr_b16 a[200:201], v32 offset:0
  ds_read_b64_tr_b16 a[202:203], v32 offset:1024
  ds_read_b64_tr_b16 a[204:205], v32 offset:8192
  ds_read_b64_tr_b16 a[206:207], v32 offset:9216
  ds_read_b64_tr_b16 v[68:69], v76 offset:0
  ds_read_b64_tr_b16 v[70:71], v76 offset:1024
  ds_read_b64_tr_b16 v[72:73], v76 offset:8192
  ds_read_b64_tr_b16 v[74:75], v76 offset:9216
  s_waitcnt lgkmcnt(0)
  ds_write_b128 v5, v[68:71] offset:6144
  ds_write_b128 v5, v[72:75] offset:7168
  s_waitcnt lgkmcnt(0)
  s_barrier
  s_lshl_b32 s19, s17, 4
  s_add_u32 s19, s19, 256
  s_lshl_b32 s19, s19, 13
  s_lshl_b32 s20, s16, 8
  s_add_u32 s19, s19, s20
  buffer_load_dwordx4 v[36:39], v33, s[12:15], s19 offen
  s_add_u32 s19, s19, 32768
  buffer_load_dwordx4 v[40:43], v33, s[12:15], s19 offen
  s_add_u32 s19, s19, 32768
  buffer_load_dwordx4 v[44:47], v33, s[12:15], s19 offen
  s_add_u32 s19, s19, 32768
  buffer_load_dwordx4 v[48:51], v33, s[12:15], s19 offen
  s_waitcnt vmcnt(8)
  ds_write_b128 v34, v[52:55] offset:0
  ds_write_b128 v34, v[56:59] offset:1024
  ds_write_b128 v77, v[60:63] offset:2048
  ds_write_b128 v77, v[64:67] offset:3072
  s_waitcnt lgkmcnt(0)
  s_barrier
  ds_read_b64_tr_b16 a[232:233], v32 offset:0
  ds_read_b64_tr_b16 a[234:235], v32 offset:1024
  ds_read_b64_tr_b16 a[236:237], v32 offset:8192
  ds_read_b64_tr_b16 a[238:239], v32 offset:9216
  ds_read_b64_tr_b16 v[68:69], v76 offset:0
  ds_read_b64_tr_b16 v[70:71], v76 offset:1024
  ds_read_b64_tr_b16 v[72:73], v76 offset:8192
  ds_read_b64_tr_b16 v[74:75], v76 offset:9216
  s_waitcnt lgkmcnt(0)
  ds_write_b128 v5, v[68:71] offset:10240
  ds_write_b128 v5, v[72:75] offset:11264
  s_waitcnt lgkmcnt(0)
  s_barrier
  s_lshl_b32 s19, s17, 4
  s_add_u32 s19, s19, 320
  s_lshl_b32 s19, s19, 13
  s_lshl_b32 s20, s16, 8
  s_add_u32 s19, s19, s20
  buffer_load_dwordx4 v[52:55], v33, s[12:15], s19 offen
  s_add_u32 s19, s19, 32768
  buffer_load_dwordx4 v[56:59], v33, s[12:15], s19 offen
  s_add_u32 s19, s19, 32768
  buffer_load_dwordx4 v[60:63], v33, s[12:15], s19 offen
  s_add_u32 s19, s19, 32768
  buffer_load_dwordx4 v[64:67], v33, s[12:15], s19 offen
  s_waitcnt vmcnt(8)
  ds_write_b128 v34, v[240:243] offset:0
  ds_write_b128 v34, v[244:247] offset:1024
  ds_write_b128 v77, v[248:251] offset:2048
  ds_write_b128 v77, v[252:255] offset:3072
  s_waitcnt lgkmcnt(0)
  s_barrier
  ds_read_b64_tr_b16 v[88:89], v32 offset:0
  ds_read_b64_tr_b16 v[90:91], v32 offset:1024
  ds_read_b64_tr_b16 v[92:93], v32 offset:8192
  ds_read_b64_tr_b16 v[94:95], v32 offset:9216
  ds_read_b64_tr_b16 v[68:69], v76 offset:0
  ds_read_b64_tr_b16 v[70:71], v76 offset:1024
  ds_read_b64_tr_b16 v[72:73], v76 offset:8192
  ds_read_b64_tr_b16 v[74:75], v76 offset:9216
  s_waitcnt lgkmcnt(0)
  ds_write_b128 v5, v[68:71] offset:14336
  ds_write_b128 v5, v[72:75] offset:15360
  s_waitcnt lgkmcnt(0)
  s_barrier
  s_lshl_b32 s19, s17, 4
  s_add_u32 s19, s19, 384
  s_lshl_b32 s19, s19, 13
  s_lshl_b32 s20, s16, 8
  s_add_u32 s19, s19, s20
  buffer_load_dwordx4 v[240:243], v33, s[12:15], s19 offen
  s_add_u32 s19, s19, 32768
  buffer_load_dwordx4 v[244:247], v33, s[12:15], s19 offen
  s_add_u32 s19, s19, 32768
  buffer_load_dwordx4 v[248:251], v33, s[12:15], s19 offen
  s_add_u32 s19, s19, 32768
  buffer_load_dwordx4 v[252:255], v33, s[12:15], s19 offen
  s_waitcnt vmcnt(8)
  ds_write_b128 v34, v[36:39] offset:0
  ds_write_b128 v34, v[40:43] offset:1024
  ds_write_b128 v77, v[44:47] offset:2048
  ds_write_b128 v77, v[48:51] offset:3072
  s_waitcnt lgkmcnt(0)
  s_barrier
  ds_read_b64_tr_b16 v[120:121], v32 offset:0
  ds_read_b64_tr_b16 v[122:123], v32 offset:1024
  ds_read_b64_tr_b16 v[124:125], v32 offset:8192
  ds_read_b64_tr_b16 v[126:127], v32 offset:9216
  ds_read_b64_tr_b16 v[68:69], v76 offset:0
  ds_read_b64_tr_b16 v[70:71], v76 offset:1024
  ds_read_b64_tr_b16 v[72:73], v76 offset:8192
  ds_read_b64_tr_b16 v[74:75], v76 offset:9216
  s_waitcnt lgkmcnt(0)
  ds_write_b128 v5, v[68:71] offset:18432
  ds_write_b128 v5, v[72:75] offset:19456
  s_waitcnt lgkmcnt(0)
  s_barrier
  s_lshl_b32 s19, s17, 4
  s_add_u32 s19, s19, 448
  s_lshl_b32 s19, s19, 13
  s_lshl_b32 s20, s16, 8
  s_add_u32 s19, s19, s20
  buffer_load_dwordx4 v[36:39], v33, s[12:15], s19 offen
  s_add_u32 s19, s19, 32768
  buffer_load_dwordx4 v[40:43], v33, s[12:15], s19 offen
  s_add_u32 s19, s19, 32768
  buffer_load_dwordx4 v[44:47], v33, s[12:15], s19 offen
  s_add_u32 s19, s19, 32768
  buffer_load_dwordx4 v[48:51], v33, s[12:15], s19 offen
  s_waitcnt vmcnt(8)
  ds_write_b128 v34, v[52:55] offset:0
  ds_write_b128 v34, v[56:59] offset:1024
  ds_write_b128 v77, v[60:63] offset:2048
  ds_write_b128 v77, v[64:67] offset:3072
  s_waitcnt lgkmcnt(0)
  s_barrier
  ds_read_b64_tr_b16 v[152:153], v32 offset:0
  ds_read_b64_tr_b16 v[154:155], v32 offset:1024
  ds_read_b64_tr_b16 v[156:157], v32 offset:8192
  ds_read_b64_tr_b16 v[158:159], v32 offset:9216
  ds_read_b64_tr_b16 v[68:69], v76 offset:0
  ds_read_b64_tr_b16 v[70:71], v76 offset:1024
  ds_read_b64_tr_b16 v[72:73], v76 offset:8192
  ds_read_b64_tr_b16 v[74:75], v76 offset:9216
  s_waitcnt lgkmcnt(0)
  ds_write_b128 v5, v[68:71] offset:22528
  ds_write_b128 v5, v[72:75] offset:23552
  s_waitcnt lgkmcnt(0)
  s_barrier
  s_waitcnt vmcnt(4)
  ds_write_b128 v34, v[240:243] offset:0
  ds_write_b128 v34, v[244:247] offset:1024
  ds_write_b128 v77, v[248:251] offset:2048
  ds_write_b128 v77, v[252:255] offset:3072
  s_waitcnt lgkmcnt(0)
  s_barrier
  ds_read_b64_tr_b16 v[184:185], v32 offset:0
  ds_read_b64_tr_b16 v[186:187], v32 offset:1024
  ds_read_b64_tr_b16 v[188:189], v32 offset:8192
  ds_read_b64_tr_b16 v[190:191], v32 offset:9216
  ds_read_b64_tr_b16 v[68:69], v76 offset:0
  ds_read_b64_tr_b16 v[70:71], v76 offset:1024
  ds_read_b64_tr_b16 v[72:73], v76 offset:8192
  ds_read_b64_tr_b16 v[74:75], v76 offset:9216
  s_waitcnt lgkmcnt(0)
  ds_write_b128 v5, v[68:71] offset:26624
  ds_write_b128 v5, v[72:75] offset:27648
  s_waitcnt lgkmcnt(0)
  s_barrier
  s_mov_b32 s12, s80
  s_mov_b32 s13, s81
  s_mov_b32 s14, 4718592
  s_mov_b32 s15, 0x00020000
  s_lshl_b32 s19, s17, 4
  s_add_u32 s19, s19, 512
  s_lshl_b32 s19, s19, 13
  s_lshl_b32 s20, s16, 8
  s_add_u32 s19, s19, s20
  buffer_load_dwordx4 v[52:55], v33, s[12:15], s19 offen
  s_add_u32 s19, s19, 32768
  buffer_load_dwordx4 v[56:59], v33, s[12:15], s19 offen
  s_add_u32 s19, s19, 32768
  buffer_load_dwordx4 v[60:63], v33, s[12:15], s19 offen
  s_add_u32 s19, s19, 32768
  buffer_load_dwordx4 v[64:67], v33, s[12:15], s19 offen
  s_waitcnt vmcnt(4)
  ds_write_b128 v34, v[36:39] offset:0
  ds_write_b128 v34, v[40:43] offset:1024
  ds_write_b128 v77, v[44:47] offset:2048
  ds_write_b128 v77, v[48:51] offset:3072
  s_waitcnt lgkmcnt(0)
  s_barrier
  ds_read_b64_tr_b16 v[216:217], v32 offset:0
  ds_read_b64_tr_b16 v[218:219], v32 offset:1024
  ds_read_b64_tr_b16 v[220:221], v32 offset:8192
  ds_read_b64_tr_b16 v[222:223], v32 offset:9216
  ds_read_b64_tr_b16 v[68:69], v76 offset:0
  ds_read_b64_tr_b16 v[70:71], v76 offset:1024
  ds_read_b64_tr_b16 v[72:73], v76 offset:8192
  ds_read_b64_tr_b16 v[74:75], v76 offset:9216
  s_waitcnt lgkmcnt(0)
  ds_write_b128 v5, v[68:71] offset:30720
  ds_write_b128 v5, v[72:75] offset:31744
  s_waitcnt lgkmcnt(0)
  s_barrier
  s_mov_b32 s12, s82
  s_mov_b32 s13, s83
  s_mov_b32 s14, 4718592
  s_mov_b32 s15, 0x00020000
  s_lshl_b32 s19, s17, 4
  s_add_u32 s19, s19, 512
  s_lshl_b32 s19, s19, 13
  s_lshl_b32 s20, s16, 8
  s_add_u32 s19, s19, s20
  buffer_load_dwordx4 v[36:39], v33, s[12:15], s19 offen
  s_add_u32 s19, s19, 32768
  buffer_load_dwordx4 v[40:43], v33, s[12:15], s19 offen
  s_add_u32 s19, s19, 32768
  buffer_load_dwordx4 v[44:47], v33, s[12:15], s19 offen
  s_add_u32 s19, s19, 32768
  buffer_load_dwordx4 v[48:51], v33, s[12:15], s19 offen
  s_waitcnt vmcnt(4)
  ds_write_b128 v34, v[52:55] offset:0
  ds_write_b128 v34, v[56:59] offset:1024
  ds_write_b128 v77, v[60:63] offset:2048
  ds_write_b128 v77, v[64:67] offset:3072
  s_waitcnt lgkmcnt(0)
  s_barrier
  ds_read_b64_tr_b16 v[240:241], v32 offset:0
  ds_read_b64_tr_b16 v[242:243], v32 offset:1024
  ds_read_b64_tr_b16 v[244:245], v32 offset:8192
  ds_read_b64_tr_b16 v[246:247], v32 offset:9216
  ds_read_b64_tr_b16 v[68:69], v76 offset:0
  ds_read_b64_tr_b16 v[70:71], v76 offset:1024
  ds_read_b64_tr_b16 v[72:73], v76 offset:8192
  ds_read_b64_tr_b16 v[74:75], v76 offset:9216
  s_waitcnt lgkmcnt(0)
  ds_write_b128 v5, v[68:71] offset:32768
  ds_write_b128 v5, v[72:75] offset:33792
  s_waitcnt lgkmcnt(0)
  s_barrier
  s_waitcnt vmcnt(0)
  ds_write_b128 v34, v[36:39] offset:0
  ds_write_b128 v34, v[40:43] offset:1024
  ds_write_b128 v77, v[44:47] offset:2048
  ds_write_b128 v77, v[48:51] offset:3072
  s_waitcnt lgkmcnt(0)
  s_barrier
  ds_read_b64_tr_b16 v[248:249], v32 offset:0
  ds_read_b64_tr_b16 v[250:251], v32 offset:1024
  ds_read_b64_tr_b16 v[252:253], v32 offset:8192
  ds_read_b64_tr_b16 v[254:255], v32 offset:9216
  ds_read_b64_tr_b16 v[68:69], v76 offset:0
  ds_read_b64_tr_b16 v[70:71], v76 offset:1024
  ds_read_b64_tr_b16 v[72:73], v76 offset:8192
  ds_read_b64_tr_b16 v[74:75], v76 offset:9216
  s_waitcnt lgkmcnt(0)
  ds_write_b128 v5, v[68:71] offset:34816
  ds_write_b128 v5, v[72:75] offset:35840
  s_waitcnt lgkmcnt(0)
  s_barrier
  s_mov_b32 s12, s76
  s_mov_b32 s13, s77
  s_mov_b32 s14, 9216
  s_mov_b32 s15, 0x00020000
  v_and_b32 v20, 7, v79
  v_mul_u32_u24 v20, 1152, v20
  v_lshrrev_b32 v21, 3, v79
  v_lshlrev_b32 v21, 4, v21
  v_add_u32 v20, v20, v21
  v_lshlrev_b32 v21, 4, v79
  v_add_u32 v21, 147456, v21
  s_mov_b32 s19, 0x05040100
  s_mov_b32 s20, 0x07060302
  buffer_load_dwordx4 v[36:39], v20, s[12:15], 0 offen offset:0
  buffer_load_dwordx4 v[40:43], v20, s[12:15], 0 offen offset:512
  buffer_load_dwordx4 v[44:47], v20, s[12:15], 0 offen offset:1024
Lbar_3:
  buffer_load_dword v22, off, s[64:67], 0 offset:64 sc1
  buffer_load_dword v23, off, s[64:67], 0 sc1
  s_waitcnt vmcnt(0)
  v_readfirstlane_b32 s21, v22
  v_readfirstlane_b32 s22, v23
  s_and_b32 s23, s21, 63
  s_add_u32 s59, s59, 1
  s_cmp_ge_u32 s59, 200000
  s_cbranch_scc1 L_CHAIN_DONE
  s_min_u32 s23, s23, s22
  s_cmp_ge_u32 s23, 32
  s_cbranch_scc0 Lbar_3
  buffer_load_dwordx4 v[64:67], v1, s[8:11], s26 offen sc1
  buffer_load_dwordx4 v[68:71], v1, s[8:11], s26 offen offset:1024 sc1
  s_bfe_u32 s22, s21, 0x80006
  s_lshr_b32 s21, s21, 14
  s_lshl_b32 s21, s21, 5
  s_mul_i32 s22, s22, s22
  s_cmp_eq_u32 s21, s22
  s_cselect_b32 s68, 1, 0
  v_perm_b32 v48, v37, v36, s19
  v_perm_b32 v49, v39, v38, s19
  v_perm_b32 v50, v37, v36, s20
  v_perm_b32 v51, v39, v38, s20
  ds_write_b128 v21, v[48:51] offset:0
  v_perm_b32 v52, v41, v40, s19
  v_perm_b32 v53, v43, v42, s19
  v_perm_b32 v54, v41, v40, s20
  v_perm_b32 v55, v43, v42, s20
  ds_write_b128 v21, v[52:55] offset:4096
  v_perm_b32 v56, v45, v44, s19
  v_perm_b32 v57, v47, v46, s19
  v_perm_b32 v58, v45, v44, s20
  v_perm_b32 v59, v47, v46, s20
  v_cmp_gt_u32 vcc, 64, v79
  s_and_saveexec_b64 s[60:61], vcc
  s_cbranch_execz Lm0_4
  ds_write_b128 v21, v[56:59] offset:8192
Lm0_4:
  s_mov_b64 exec, -1
  s_mov_b32 s18, 0
  s_mov_b32 s69, 0
  s_mov_b32 s99, 3
  s_mov_b32 s98, s95
  v_mov_b64 v[12:13], 0
  v_mov_b64 v[14:15], 0
  v_mov_b64 v[16:17], 0
  v_mov_b64 v[18:19], 0
  v_mov_b64 v[20:21], 0
  v_mov_b64 v[22:23], 0
  v_mov_b64 v[24:25], 0
  v_mov_b64 v[26:27], 0
  v_mov_b64 v[28:29], 0
  v_mov_b64 v[30:31], 0
  v_mov_b64 v[32:33], 0
  v_mov_b64 v[34:35], 0
  ds_read_b128 v[48:51], v5 offset:0
  ds_read_b128 v[52:55], v5 offset:1024
  ds_read_b128 v[56:59], v5 offset:2048
  ds_read_b128 v[60:63], v5 offset:3072
  s_waitcnt vmcnt(0) lgkmcnt(0)
  s_barrier
  s_cmp_eq_u32 s68, 1
  s_cbranch_scc0 SLOW_STEP
FAST_PRE:
  s_waitcnt lgkmcnt(0)
  s_barrier
FAST_STEP:
  ds_read_b128 v[36:39], v4 offset:0
  ds_read_b128 v[40:43], v4 offset:1024
  ds_read_b128 v[44:47], v4 offset:2048
  s_cmp_eq_u32 s18, s99
  s_cbranch_scc1 FAST_KC_5o
FAST_KC_5:
  s_add_u32 s19, s26, 16777216
  buffer_load_dwordx4 v[72:75], v1, s[8:11], s19 offen sc1
  buffer_load_dwordx4 v[76:79], v1, s[8:11], s19 offen offset:1024 sc1
  s_waitcnt lgkmcnt(2)
  v_smfmac_f32_16x16x64_bf16 v[12:15], v[36:39], a[144:151], v0
  v_smfmac_f32_16x16x64_bf16 v[24:27], v[36:39], v[48:55], v0
  ds_read_b128 v[48:51], v5 offset:4096
  ds_read_b128 v[52:55], v5 offset:5120
  v_smfmac_f32_16x16x64_bf16 v[16:19], v[36:39], a[152:159], v0
  v_smfmac_f32_16x16x64_bf16 v[20:23], v[36:39], a[160:167], v0
  v_smfmac_f32_16x16x64_bf16 v[32:35], v[36:39], v[56:63], v0
  ds_read_b128 v[56:59], v5 offset:6144
  ds_read_b128 v[60:63], v5 offset:7168
  v_smfmac_f32_16x16x64_bf16 v[28:31], v[36:39], a[168:175], v0
  ds_read_b128 v[36:39], v4 offset:3072
  s_waitcnt lgkmcnt(6)
  v_smfmac_f32_16x16x64_bf16 v[12:15], v[40:43], a[176:183], v0
  s_waitcnt lgkmcnt(3)
  v_smfmac_f32_16x16x64_bf16 v[24:27], v[40:43], v[48:55], v0
  ds_read_b128 v[48:51], v5 offset:8192
  ds_read_b128 v[52:55], v5 offset:9216
  v_smfmac_f32_16x16x64_bf16 v[16:19], v[40:43], a[184:191], v0
  v_smfmac_f32_16x16x64_bf16 v[20:23], v[40:43], a[192:199], v0
  s_waitcnt lgkmcnt(3)
  v_smfmac_f32_16x16x64_bf16 v[32:35], v[40:43], v[56:63], v0
  ds_read_b128 v[56:59], v5 offset:10240
  ds_read_b128 v[60:63], v5 offset:11264
  v_smfmac_f32_16x16x64_bf16 v[28:31], v[40:43], a[200:207], v0
  ds_read_b128 v[40:43], v4 offset:4096
  v_smfmac_f32_16x16x64_bf16 v[12:15], v[44:47], a[208:215], v0
  s_waitcnt lgkmcnt(3)
  v_smfmac_f32_16x16x64_bf16 v[24:27], v[44:47], v[48:55], v0
  ds_read_b128 v[48:51], v5 offset:12288
  ds_read_b128 v[52:55], v5 offset:13312
  v_smfmac_f32_16x16x64_bf16 v[16:19], v[44:47], a[216:223], v0
  v_smfmac_f32_16x16x64_bf16 v[20:23], v[44:47], a[224:231], v0
  s_waitcnt lgkmcnt(3)
  v_smfmac_f32_16x16x64_bf16 v[32:35], v[44:47], v[56:63], v0
  ds_read_b128 v[56:59], v5 offset:14336
  ds_read_b128 v[60:63], v5 offset:15360
  v_smfmac_f32_16x16x64_bf16 v[28:31], v[44:47], a[232:239], v0
  ds_read_b128 v[44:47], v4 offset:5120
  v_smfmac_f32_16x16x64_bf16 v[12:15], v[36:39], a[240:247], v0
  s_waitcnt lgkmcnt(3)
  v_smfmac_f32_16x16x64_bf16 v[24:27], v[36:39], v[48:55], v0
  ds_read_b128 v[48:51], v5 offset:16384
  ds_read_b128 v[52:55], v5 offset:17408
  v_smfmac_f32_16x16x64_bf16 v[16:19], v[36:39], a[248:255], v0
  v_smfmac_f32_16x16x64_bf16 v[20:23], v[36:39], v[80:87], v0
  s_waitcnt lgkmcnt(3)
  v_smfmac_f32_16x16x64_bf16 v[32:35], v[36:39], v[56:63], v0
  ds_read_b128 v[56:59], v5 offset:18432
  ds_read_b128 v[60:63], v5 offset:19456
  v_smfmac_f32_16x16x64_bf16 v[28:31], v[36:39], v[88:95], v0
  ds_read_b128 v[36:39], v4 offset:6144
  v_smfmac_f32_16x16x64_bf16 v[12:15], v[40:43], v[96:103], v0
  s_waitcnt lgkmcnt(3)
  v_smfmac_f32_16x16x64_bf16 v[24:27], v[40:43], v[48:55], v0
  ds_read_b128 v[48:51], v5 offset:20480
  ds_read_b128 v[52:55], v5 offset:21504
  v_smfmac_f32_16x16x64_bf16 v[16:19], v[40:43], v[104:111], v0
  v_smfmac_f32_16x16x64_bf16 v[20:23], v[40:43], v[112:119], v0
  s_waitcnt lgkmcnt(3)
  v_smfmac_f32_16x16x64_bf16 v[32:35], v[40:43], v[56:63], v0
  ds_read_b128 v[56:59], v5 offset:22528
  ds_read_b128 v[60:63], v5 offset:23552
  v_smfmac_f32_16x16x64_bf16 v[28:31], v[40:43], v[120:127], v0
  ds_read_b128 v[40:43], v4 offset:7168
  v_smfmac_f32_16x16x64_bf16 v[12:15], v[44:47], v[128:135], v0
  s_waitcnt lgkmcnt(3)
  v_smfmac_f32_16x16x64_bf16 v[24:27], v[44:47], v[48:55], v0
  ds_read_b128 v[48:51], v5 offset:24576
  ds_read_b128 v[52:55], v5 offset:25600
  v_smfmac_f32_16x16x64_bf16 v[16:19], v[44:47], v[136:143], v0
  v_smfmac_f32_16x16x64_bf16 v[20:23], v[44:47], v[144:151], v0
  s_waitcnt lgkmcnt(3)
  v_smfmac_f32_16x16x64_bf16 v[32:35], v[44:47], v[56:63], v0
  ds_read_b128 v[56:59], v5 offset:26624
  ds_read_b128 v[60:63], v5 offset:27648
  v_smfmac_f32_16x16x64_bf16 v[28:31], v[44:47], v[152:159], v0
  ds_read_b128 v[44:47], v4 offset:8192
  v_smfmac_f32_16x16x64_bf16 v[12:15], v[36:39], v[160:167], v0
  s_waitcnt lgkmcnt(3)
  v_smfmac_f32_16x16x64_bf16 v[24:27], v[36:39], v[48:55], v0
  ds_read_b128 v[48:51], v5 offset:28672
  ds_read_b128 v[52:55], v5 offset:29696
  v_smfmac_f32_16x16x64_bf16 v[16:19], v[36:39], v[168:175], v0
  v_smfmac_f32_16x16x64_bf16 v[20:23], v[36:39], v[176:183], v0
  s_waitcnt lgkmcnt(3)
  v_smfmac_f32_16x16x64_bf16 v[32:35], v[36:39], v[56:63], v0
  ds_read_b128 v[56:59], v5 offset:32768
  ds_read_b128 v[60:63], v5 offset:33792
  v_smfmac_f32_16x16x64_bf16 v[28:31], v[36:39], v[184:191], v0
  v_smfmac_f32_16x16x64_bf16 v[12:15], v[40:43], v[192:199], v0
  v_smfmac_f32_16x16x64_bf16 v[16:19], v[40:43], v[200:207], v0
  s_waitcnt lgkmcnt(4)
  v_smfmac_f32_16x16x64_bf16 v[12:15], v[44:47], v[224:231], v0
  v_smfmac_f32_16x16x64_bf16 v[16:19], v[44:47], v[232:239], v0
  v_smfmac_f32_16x16x64_bf16 v[20:23], v[40:43], v[208:215], v0
  s_waitcnt lgkmcnt(2)
  v_smfmac_f32_16x16x64_bf16 v[24:27], v[40:43], v[48:55], v0
  ds_read_b128 v[48:51], v5 offset:30720
  ds_read_b128 v[52:55], v5 offset:31744
  v_cvt_pk_bf16_f32 v12, v12, v13
  v_cvt_pk_bf16_f32 v13, v14, v15
  v_smfmac_f32_16x16x64_bf16 v[20:23], v[44:47], v[240:247], v0
  v_cvt_pk_bf16_f32 v14, v16, v17
  v_cvt_pk_bf16_f32 v15, v18, v19
  s_waitcnt lgkmcnt(2)
  v_smfmac_f32_16x16x64_bf16 v[24:27], v[44:47], v[56:63], v0
  ds_read_b128 v[56:59], v5 offset:34816
  ds_read_b128 v[60:63], v5 offset:35840
  s_cmp_eq_u32 s18, s99
  s_cbranch_scc1 FAST_KD_6o
FAST_KD_6:
  v_mfma_f32_16x16x16_bf16 v[16:19], v[12:13], v[2:3], 0
  v_mfma_f32_16x16x16_bf16 v[36:39], v[14:15], v[2:3], 0
  v_smfmac_f32_16x16x64_bf16 v[28:31], v[40:43], v[216:223], v0
  s_waitcnt lgkmcnt(2)
  v_smfmac_f32_16x16x64_bf16 v[32:35], v[40:43], v[48:55], v0
  v_cvt_pk_bf16_f32 v20, v20, v21
  v_cvt_pk_bf16_f32 v21, v22, v23
  v_cvt_pk_bf16_f32 v22, v24, v25
  v_cvt_pk_bf16_f32 v23, v26, v27
  v_mfma_f32_16x16x16_bf16 v[24:27], v[20:21], v[2:3], 0
  v_cvt_pk_bf16_f32 v12, v16, v17
  v_cvt_pk_bf16_f32 v13, v18, v19
  v_mfma_f32_16x16x16_bf16 v[16:19], v[22:23], v[2:3], 0
  v_cvt_pk_bf16_f32 v14, v36, v37
  v_cvt_pk_bf16_f32 v15, v38, v39
  s_add_u32 s19, s27, 67108864
  v_smfmac_f32_16x16x64_bf16 v[28:31], v[44:47], v[248:255], v0
  v_mfma_f32_16x16x32_bf16 v[36:39], v[64:67], v[12:15], 0
  v_cvt_pk_bf16_f32 v20, v24, v25
  v_mfma_f32_16x16x32_bf16 v[40:43], v[68:71], v[12:15], 0
  v_cvt_pk_bf16_f32 v21, v26, v27
  v_cvt_pk_bf16_f32 v22, v16, v17
  v_cvt_pk_bf16_f32 v23, v18, v19
  v_add_u32 v11, s52, v1
  s_add_u32 s26, s26, 262144
  v_mfma_f32_16x16x32_bf16 v[24:27], v[20:23], v[12:15], 0
  s_waitcnt lgkmcnt(0)
  v_smfmac_f32_16x16x64_bf16 v[32:35], v[44:47], v[56:63], v0
  v_cndmask_b32 v36, v40, v36, s[30:31]
  v_cndmask_b32 v37, v41, v37, s[30:31]
  v_cndmask_b32 v38, v42, v38, s[30:31]
  v_cndmask_b32 v39, v43, v39, s[30:31]
  ds_write_b128 v11, v[36:39]
  v_cndmask_b32 v24, v25, v24, s[30:31]
  v_cndmask_b32 v26, v27, v26, s[30:31]
  v_add_u32 v11, s53, v1
  v_cndmask_b32 v24, v26, v24, s[32:33]
  ds_write_b32 v11, v24
  buffer_store_dwordx4 v[20:23], v1, s[8:11], s19 offen sc1
  buffer_load_dwordx4 v[64:67], v1, s[8:11], s26 offen sc1
  buffer_load_dwordx4 v[68:71], v1, s[8:11], s26 offen offset:1024 sc1
  s_mov_b64 exec, 1
  buffer_store_dword v0, off, s[8:11], s98 sc1
  s_mov_b64 exec, -1
  s_add_u32 s98, s98, 4
  v_add_u32 v11, 156672, v1
  s_waitcnt lgkmcnt(0)
  s_barrier
  ds_read_b128 v[36:39], v11 offset:0
  ds_read_b128 v[40:43], v11 offset:1024
  ds_read_b128 v[44:47], v11 offset:2048
  ds_read_b128 v[16:19], v11 offset:3072
  ds_read_b128 v[24:27], v11 offset:4096
  v_permlane32_swap_b32 v28, v32
  v_permlane32_swap_b32 v29, v33
  v_permlane32_swap_b32 v30, v34
  v_permlane32_swap_b32 v31, v35
  v_pk_add_f32 v[28:29], v[28:29], v[32:33]
  v_pk_add_f32 v[30:31], v[30:31], v[34:35]
  v_cvt_pk_bf16_f32 v32, v28, v29
  v_cvt_pk_bf16_f32 v33, v30, v31
  s_cmp_eq_u32 s18, 63
  s_cbranch_scc1 L_CHAIN_FIN
  v_cndmask_b32 v34, v32, 0, s[32:33]
  v_cndmask_b32 v35, v33, 0, s[32:33]
  v_cndmask_b32 v30, 0, v32, s[32:33]
  v_cndmask_b32 v31, 0, v33, s[32:33]
  s_waitcnt lgkmcnt(3)
  v_pk_add_f32 v[36:37], v[36:37], v[40:41]
  v_pk_add_f32 v[38:39], v[38:39], v[42:43]
  s_waitcnt lgkmcnt(1)
  v_pk_add_f32 v[44:45], v[44:45], v[16:17]
  v_pk_add_f32 v[46:47], v[46:47], v[18:19]
  v_pk_add_f32 v[36:37], v[36:37], v[44:45]
  v_pk_add_f32 v[38:39], v[38:39], v[46:47]
  s_waitcnt lgkmcnt(0)
  v_pk_add_f32 v[24:25], v[24:25], v[26:27]
  v_max3_f32 v40, v36, v37, v38
  v_add_f32 v24, v24, v25
  v_mov_b32 v20, 0x3f803f80
  v_max3_f32 v40, v40, v39, v24
  v_mov_b32 v21, 0x3f803f80
  v_mov_b32 v22, 0x3f803f80
  v_max_f32_dpp v40, v40, v40 row_ror:8 row_mask:0xf bank_mask:0xf
  v_mov_b32 v41, v40
  v_mov_b32 v23, 0x3f803f80
  v_cndmask_b32 v28, 0, v20, s[32:33]
  v_permlane16_swap_b32 v40, v41
  v_max_f32 v40, v40, v41
  v_mov_b32 v41, v40
  v_cndmask_b32 v29, 0, v20, s[32:33]
  v_add_u32 v11, s54, v7
  v_permlane32_swap_b32 v40, v41
  v_max_f32 v40, v40, v41
  v_mul_f32 v40, s50, v40
  v_fma_f32 v24, v24, s50, -v40
  v_pk_fma_f32 v[36:37], v[36:37], s[50:51], v[40:41] op_sel_hi:[1,0,0] neg_lo:[0,0,1] neg_hi:[0,0,1]
  v_pk_fma_f32 v[38:39], v[38:39], s[50:51], v[40:41] op_sel_hi:[1,0,0] neg_lo:[0,0,1] neg_hi:[0,0,1]
  v_exp_f32 v24, v24
  v_exp_f32 v36, v36
  v_exp_f32 v37, v37
  v_exp_f32 v38, v38
  v_exp_f32 v39, v39
  v_mov_b32_dpp v25, v24 row_ror:8 row_mask:0xf bank_mask:0xf
  v_cvt_pk_bf16_f32 v12, v36, v37
  v_cvt_pk_bf16_f32 v13, v38, v39
  v_cvt_pk_bf16_f32 v42, v24, v25
  v_mov_b32_dpp v14, v12 row_ror:8 row_mask:0xf bank_mask:0xf
  v_mov_b32_dpp v15, v13 row_ror:8 row_mask:0xf bank_mask:0xf
  v_mov_b32 v43, v42
  s_waitcnt vmcnt(4)
  v_mfma_f32_16x16x32_bf16 v[48:51], v[20:23], v[12:15], 0
  v_permlane32_swap_b32 v42, v43
  v_mfma_f32_16x16x32_bf16 v[44:47], v[72:75], v[12:15], 0
  v_mfma_f32_16x16x32_bf16 v[16:19], v[76:79], v[12:15], 0
  v_mfma_f32_16x16x16_bf16 v[48:51], v[28:29], v[42:43], v[48:51]
  v_mfma_f32_16x16x16_bf16 v[44:47], v[30:31], v[42:43], v[44:47]
  v_mfma_f32_16x16x16_bf16 v[16:19], v[34:35], v[42:43], v[16:19]
  v_lshrrev_b32 v24, 1, v1
  s_lshr_b32 s19, s27, 1
  s_add_u32 s19, s19, 75497472
  buffer_store_dwordx2 v[32:33], v24, s[8:11], s19 offen sc1
  v_mov_b64 v[24:25], 0
  v_mov_b64 v[26:27], 0
  v_mov_b64 v[36:37], 0
  v_mov_b64 v[38:39], 0
  v_rcp_f32 v49, v48
  v_mov_b64 v[20:21], 0
  v_mov_b64 v[22:23], 0
  v_pk_mul_f32 v[44:45], v[44:45], v[48:49] op_sel:[0,1] op_sel_hi:[1,1]
  v_pk_mul_f32 v[46:47], v[46:47], v[48:49] op_sel:[0,1] op_sel_hi:[1,1]
  v_pk_mul_f32 v[16:17], v[16:17], v[48:49] op_sel:[0,1] op_sel_hi:[1,1]
  v_pk_mul_f32 v[18:19], v[18:19], v[48:49] op_sel:[0,1] op_sel_hi:[1,1]
  v_cvt_pk_bf16_f32 v12, v44, v45
  v_cvt_pk_bf16_f32 v13, v46, v47
  v_cvt_pk_bf16_f32 v14, v16, v17
  v_cvt_pk_bf16_f32 v15, v18, v19
  s_mov_b64 exec, s[30:31]
  ds_write_b128 v11, v[12:15]
  s_mov_b64 exec, -1
  v_add_u32 v45, 161792, v7
  v_mov_b64 v[40:41], 0
  v_mov_b64 v[42:43], 0
  v_mov_b64 v[28:29], 0
  v_mov_b64 v[30:31], 0
  s_and_b32 s29, s18, 1
  s_lshl_b32 s29, s29, 16
  v_mov_b32 v11, s29
  s_waitcnt lgkmcnt(0)
  s_barrier
  ds_read_b128 v[16:19], v6
  ds_read_b128 v[32:35], v6 offset:1024
  ds_read_b128 v[48:51], v45 offset:0
  ds_read_b128 v[52:55], v45 offset:512
  ds_read_b128 v[56:59], v45 offset:1024
  ds_read_b128 v[60:63], v45 offset:1536
  s_waitcnt lgkmcnt(5)
  v_smfmac_f32_16x16x64_bf16 v[24:27], v[16:19], a[0:7], v0
  s_waitcnt lgkmcnt(4)
  v_smfmac_f32_16x16x64_bf16 v[24:27], v[32:35], a[8:15], v0
  s_waitcnt lgkmcnt(3)
  v_smfmac_f32_16x16x64_bf16 v[20:23], v[48:51], a[16:23], v0
  s_waitcnt lgkmcnt(2)
  v_smfmac_f32_16x16x64_bf16 v[20:23], v[52:55], a[24:31], v0
  v_cvt_pk_bf16_f32 v24, v24, v25
  v_cvt_pk_bf16_f32 v25, v26, v27
  s_waitcnt lgkmcnt(1)
  v_smfmac_f32_16x16x64_bf16 v[20:23], v[56:59], a[32:39], v0
  v_mfma_f32_16x16x16_bf16 v[44:47], v[2:3], v[24:25], 0
  s_waitcnt lgkmcnt(0)
  v_smfmac_f32_16x16x64_bf16 v[20:23], v[60:63], a[40:47], v0
  v_smfmac_f32_16x16x64_bf16 v[36:39], v[48:51], a[48:55], v0
  v_cvt_pk_bf16_f32 v44, v44, v45
  v_cvt_pk_bf16_f32 v45, v46, v47
  v_bfi_b32 v45, s62, v11, v45
  v_smfmac_f32_16x16x64_bf16 v[36:39], v[52:55], a[56:63], v0
  s_mov_b64 exec, s[32:33]
  buffer_store_dwordx2 v[44:45], v8, s[8:11], s25 offen
  s_mov_b64 exec, -1
  v_cvt_pk_bf16_f32 v20, v20, v21
  v_cvt_pk_bf16_f32 v21, v22, v23
  v_smfmac_f32_16x16x64_bf16 v[36:39], v[56:59], a[64:71], v0
  v_bfi_b32 v21, s62, v11, v21
  buffer_store_dwordx2 v[20:21], v8, s[8:11], s25 offen offset:256
  v_smfmac_f32_16x16x64_bf16 v[36:39], v[60:63], a[72:79], v0
  v_smfmac_f32_16x16x64_bf16 v[40:43], v[48:51], a[80:87], v0
  v_smfmac_f32_16x16x64_bf16 v[40:43], v[52:55], a[88:95], v0
  v_cvt_pk_bf16_f32 v36, v36, v37
  v_cvt_pk_bf16_f32 v37, v38, v39
  v_bfi_b32 v37, s62, v11, v37
  v_smfmac_f32_16x16x64_bf16 v[40:43], v[56:59], a[96:103], v0
  buffer_store_dwordx2 v[36:37], v8, s[8:11], s25 offen offset:768
  v_smfmac_f32_16x16x64_bf16 v[40:43], v[60:63], a[104:111], v0
  v_smfmac_f32_16x16x64_bf16 v[28:31], v[48:51], a[112:119], v0
  v_smfmac_f32_16x16x64_bf16 v[28:31], v[52:55], a[120:127], v0
  v_cvt_pk_bf16_f32 v40, v40, v41
  v_cvt_pk_bf16_f32 v41, v42, v43
  v_bfi_b32 v41, s62, v11, v41
  v_smfmac_f32_16x16x64_bf16 v[28:31], v[56:59], a[128:135], v0
  buffer_store_dwordx2 v[40:41], v8, s[8:11], s25 offen offset:1280
  v_smfmac_f32_16x16x64_bf16 v[28:31], v[60:63], a[136:143], v0
  s_nop 7
  v_cvt_pk_bf16_f32 v28, v28, v29
  v_cvt_pk_bf16_f32 v29, v30, v31
  v_bfi_b32 v29, s62, v11, v29
  buffer_store_dwordx2 v[28:29], v8, s[8:11], s25 offen offset:1792
  s_add_u32 s18, s18, 1
  s_add_u32 s27, s27, 131072
  s_and_b32 s57, s18, 3
  s_lshl_b32 s57, s57, 14
  s_add_u32 s56, s57, s28
  s_add_u32 s19, s56, 4096
  s_add_u32 s20, s56, 5120
  s_cmp_eq_u32 s24, -1
  s_cbranch_scc1 FAST_RSKIP
  s_add_u32 s57, s57, s24
  s_add_u32 s57, s57, 80216064
  s_add_u32 s58, s18, 2
  s_and_b32 s58, s58, 3
  s_lshl_b32 s58, s58, 14
  s_add_u32 s58, s58, s24
  s_add_u32 s58, s58, 80216064
  v_mov_b32 v46, 0x3f80
  v_mov_b32 v47, 0x3f800000
  v_cndmask_b32 v46, v46, v47, s[44:45]
  v_cndmask_b32 v12, 0, v46, s[36:37]
  v_cndmask_b32 v13, 0, v46, s[38:39]
  v_cndmask_b32 v14, 0, v46, s[40:41]
  v_cndmask_b32 v15, 0, v46, s[42:43]
  s_waitcnt vmcnt(0)
FAST_RPOLL:
  buffer_load_dwordx4 v[48:51], v9, s[8:11], s49 offen sc1
  buffer_load_dwordx4 v[52:55], v9, s[8:11], s46 offen sc1
  buffer_load_dwordx4 v[56:59], v9, s[8:11], s47 offen sc1
  buffer_load_dwordx4 v[60:63], v9, s[8:11], s48 offen sc1
  s_waitcnt vmcnt(3)
  v_mfma_f32_16x16x32_bf16 v[16:19], v[48:51], v[12:15], 0
  v_xor_b32 v20, v49, v11
  s_waitcnt vmcnt(2)
  v_mfma_f32_16x16x32_bf16 v[16:19], v[52:55], v[12:15], v[16:19]
  v_xor_b32 v21, v51, v11
  s_waitcnt vmcnt(1)
  v_mfma_f32_16x16x32_bf16 v[16:19], v[56:59], v[12:15], v[16:19]
  v_bitop3_b32 v20, v53, v11, v20 bitop3:0xbe
  s_waitcnt vmcnt(0)
  v_mfma_f32_16x16x32_bf16 v[16:19], v[60:63], v[12:15], v[16:19]
  v_bitop3_b32 v21, v55, v11, v21 bitop3:0xbe
  v_bitop3_b32 v20, v57, v11, v20 bitop3:0xbe
  v_bitop3_b32 v21, v59, v11, v21 bitop3:0xbe
  v_bitop3_b32 v20, v61, v11, v20 bitop3:0xbe
  v_bitop3_b32 v21, v63, v11, v21 bitop3:0xbe
  v_bitop3_b32 v20, v20, v21, s62 bitop3:0xa8
  v_cmp_ne_u32 vcc, 0, v20
  s_cbranch_vccnz FAST_RRETRY
  v_permlane32_swap_b32 v16, v17
  v_permlane32_swap_b32 v18, v19
  v_add_f32 v16, v16, v17
  v_add_f32 v18, v18, v19
  s_mov_b64 exec, s[30:31]
  v_cvt_pk_bf16_f32 v16, v16, v18
  v_min_u32 v16, 0xfffffffe, v16
  buffer_store_dword v16, v10, s[8:11], s57 offen
  v_mov_b32 v17, -1
  buffer_store_dword v17, v10, s[8:11], s58 offen
  s_mov_b64 exec, -1
FAST_RSKIP:
  v_add_u32 v72, s55, v1
  v_mov_b64 v[12:13], 0
  v_mov_b64 v[14:15], 0
  v_mov_b64 v[16:17], 0
  v_mov_b64 v[18:19], 0
  v_mov_b64 v[20:21], 0
  v_mov_b64 v[22:23], 0
  v_mov_b64 v[24:25], 0
  v_mov_b64 v[26:27], 0
  v_mov_b64 v[28:29], 0
  v_mov_b64 v[30:31], 0
  v_mov_b64 v[32:33], 0
  v_mov_b64 v[34:35], 0
  ds_read_b128 v[48:51], v5 offset:0
  ds_read_b128 v[52:55], v5 offset:1024
  ds_read_b128 v[56:59], v5 offset:2048
  ds_read_b128 v[60:63], v5 offset:3072
  s_waitcnt vmcnt(1)
  s_barrier
  buffer_load_dwordx4 v[36:39], v1, s[8:11], s56 offen sc1
  buffer_load_dwordx4 v[40:43], v1, s[8:11], s19 offen sc1
  s_cmp_eq_u32 s17, 3
  s_cbranch_scc0 FAST_C3_7
  buffer_load_dwordx4 v[44:47], v1, s[8:11], s20 offen sc1
FAST_C3_7:
  s_branch FAST_CWAIT
FAST_CPOLL:
  s_waitcnt vmcnt(2)
  buffer_load_dwordx4 v[36:39], v1, s[8:11], s56 offen sc1
  s_waitcnt vmcnt(2)
  buffer_load_dwordx4 v[40:43], v1, s[8:11], s19 offen sc1
  s_cmp_eq_u32 s17, 3
  s_cbranch_scc0 FAST_C3_8
  s_waitcnt vmcnt(2)
  buffer_load_dwordx4 v[44:47], v1, s[8:11], s20 offen sc1
FAST_C3_8:
FAST_CWAIT:
  s_cmp_eq_u32 s17, 3
  s_cbranch_scc0 FAST_CNO3
  s_waitcnt vmcnt(2)
  ds_write_b128 v72, v[36:39]
  v_max3_u32 v11, v36, v37, v38
  s_waitcnt vmcnt(1)
  ds_write_b128 v72, v[40:43] offset:4096
  v_max3_u32 v11, v11, v39, v40
  v_max3_u32 v11, v11, v41, v42
  s_waitcnt vmcnt(0)
  ds_write_b128 v72, v[44:47] offset:5120
  v_max3_u32 v11, v11, v43, v44
  v_max3_u32 v11, v11, v45, v46
  v_max_u32 v11, v11, v47
  s_branch FAST_CJ
FAST_CNO3:
  s_waitcnt vmcnt(1)
  ds_write_b128 v72, v[36:39]
  v_max3_u32 v11, v36, v37, v38
  s_waitcnt vmcnt(0)
  ds_write_b128 v72, v[40:43] offset:4096
  v_max3_u32 v11, v11, v39, v40
  v_max3_u32 v11, v11, v41, v42
  v_max_u32 v11, v11, v43
FAST_CJ:
  v_cmp_eq_u32 vcc, -1, v11
  s_cbranch_vccz FAST_PRE
  s_add_u32 s59, s59, 1
  s_cmp_lt_u32 s59, 200000
  s_cbranch_scc1 FAST_CPOLL
  s_branch L_CHAIN_DONE
FAST_KC_5o:
  s_add_u32 s63, s18, 1
  s_and_b32 s63, s63, 63
  buffer_load_dword v11, off, s[64:67], s63 sc1
  s_branch FAST_KC_5
FAST_KD_6o:
  s_add_u32 s99, s99, 4
  s_waitcnt vmcnt(2)
FAST_KD_6q:
  s_waitcnt vmcnt(0)
  v_readfirstlane_b32 s20, v11
  s_cmp_ge_u32 s20, 32
  s_cbranch_scc1 FAST_KD_6
  s_add_u32 s59, s59, 1
  s_cmp_ge_u32 s59, 200000
  s_cbranch_scc1 L_CHAIN_DONE
  buffer_load_dword v11, off, s[64:67], s63 sc1
  s_waitcnt vmcnt(0)
  s_branch FAST_KD_6q
FAST_RRETRY:
  s_add_u32 s59, s59, 1
  s_cmp_lt_u32 s59, 200000
  s_cbranch_scc1 FAST_RPOLL
  s_branch L_CHAIN_DONE
SLOW_PRE:
  s_waitcnt lgkmcnt(0)
  s_barrier
SLOW_STEP:
  ds_read_b128 v[36:39], v4 offset:0
  ds_read_b128 v[40:43], v4 offset:1024
  ds_read_b128 v[44:47], v4 offset:2048
  s_cmp_eq_u32 s18, s99
  s_cbranch_scc1 SLOW_KC_9o
SLOW_KC_9:
  s_add_u32 s19, s26, 16777216
  buffer_load_dwordx4 v[72:75], v1, s[8:11], s19 offen sc1
  buffer_load_dwordx4 v[76:79], v1, s[8:11], s19 offen offset:1024 sc1
  s_waitcnt lgkmcnt(2)
  v_smfmac_f32_16x16x64_bf16 v[12:15], v[36:39], a[144:151], v0
  v_smfmac_f32_16x16x64_bf16 v[24:27], v[36:39], v[48:55], v0
  ds_read_b128 v[48:51], v5 offset:4096
  ds_read_b128 v[52:55], v5 offset:5120
  v_smfmac_f32_16x16x64_bf16 v[16:19], v[36:39], a[152:159], v0
  v_smfmac_f32_16x16x64_bf16 v[20:23], v[36:39], a[160:167], v0
  v_smfmac_f32_16x16x64_bf16 v[32:35], v[36:39], v[56:63], v0
  ds_read_b128 v[56:59], v5 offset:6144
  ds_read_b128 v[60:63], v5 offset:7168
  v_smfmac_f32_16x16x64_bf16 v[28:31], v[36:39], a[168:175], v0
  ds_read_b128 v[36:39], v4 offset:3072
  s_waitcnt lgkmcnt(6)
  v_smfmac_f32_16x16x64_bf16 v[12:15], v[40:43], a[176:183], v0
  s_waitcnt lgkmcnt(3)
  v_smfmac_f32_16x16x64_bf16 v[24:27], v[40:43], v[48:55], v0
  ds_read_b128 v[48:51], v5 offset:8192
  ds_read_b128 v[52:55], v5 offset:9216
  v_smfmac_f32_16x16x64_bf16 v[16:19], v[40:43], a[184:191], v0
  v_smfmac_f32_16x16x64_bf16 v[20:23], v[40:43], a[192:199], v0
  s_waitcnt lgkmcnt(3)
  v_smfmac_f32_16x16x64_bf16 v[32:35], v[40:43], v[56:63], v0
  ds_read_b128 v[56:59], v5 offset:10240
  ds_read_b128 v[60:63], v5 offset:11264
  v_smfmac_f32_16x16x64_bf16 v[28:31], v[40:43], a[200:207], v0
  ds_read_b128 v[40:43], v4 offset:4096
  v_smfmac_f32_16x16x64_bf16 v[12:15], v[44:47], a[208:215], v0
  s_waitcnt lgkmcnt(3)
  v_smfmac_f32_16x16x64_bf16 v[24:27], v[44:47], v[48:55], v0
  ds_read_b128 v[48:51], v5 offset:12288
  ds_read_b128 v[52:55], v5 offset:13312
  v_smfmac_f32_16x16x64_bf16 v[16:19], v[44:47], a[216:223], v0
  v_smfmac_f32_16x16x64_bf16 v[20:23], v[44:47], a[224:231], v0
  s_waitcnt lgkmcnt(3)
  v_smfmac_f32_16x16x64_bf16 v[32:35], v[44:47], v[56:63], v0
  ds_read_b128 v[56:59], v5 offset:14336
  ds_read_b128 v[60:63], v5 offset:15360
  v_smfmac_f32_16x16x64_bf16 v[28:31], v[44:47], a[232:239], v0
  ds_read_b128 v[44:47], v4 offset:5120
  v_smfmac_f32_16x16x64_bf16 v[12:15], v[36:39], a[240:247], v0
  s_waitcnt lgkmcnt(3)
  v_smfmac_f32_16x16x64_bf16 v[24:27], v[36:39], v[48:55], v0
  ds_read_b128 v[48:51], v5 offset:16384
  ds_read_b128 v[52:55], v5 offset:17408
  v_smfmac_f32_16x16x64_bf16 v[16:19], v[36:39], a[248:255], v0
  v_smfmac_f32_16x16x64_bf16 v[20:23], v[36:39], v[80:87], v0
  s_waitcnt lgkmcnt(3)
  v_smfmac_f32_16x16x64_bf16 v[32:35], v[36:39], v[56:63], v0
  ds_read_b128 v[56:59], v5 offset:18432
  ds_read_b128 v[60:63], v5 offset:19456
  v_smfmac_f32_16x16x64_bf16 v[28:31], v[36:39], v[88:95], v0
  ds_read_b128 v[36:39], v4 offset:6144
  v_smfmac_f32_16x16x64_bf16 v[12:15], v[40:43], v[96:103], v0
  s_waitcnt lgkmcnt(3)
  v_smfmac_f32_16x16x64_bf16 v[24:27], v[40:43], v[48:55], v0
  ds_read_b128 v[48:51], v5 offset:20480
  ds_read_b128 v[52:55], v5 offset:21504
  v_smfmac_f32_16x16x64_bf16 v[16:19], v[40:43], v[104:111], v0
  v_smfmac_f32_16x16x64_bf16 v[20:23], v[40:43], v[112:119], v0
  s_waitcnt lgkmcnt(3)
  v_smfmac_f32_16x16x64_bf16 v[32:35], v[40:43], v[56:63], v0
  ds_read_b128 v[56:59], v5 offset:22528
  ds_read_b128 v[60:63], v5 offset:23552
  v_smfmac_f32_16x16x64_bf16 v[28:31], v[40:43], v[120:127], v0
  ds_read_b128 v[40:43], v4 offset:7168
  v_smfmac_f32_16x16x64_bf16 v[12:15], v[44:47], v[128:135], v0
  s_waitcnt lgkmcnt(3)
  v_smfmac_f32_16x16x64_bf16 v[24:27], v[44:47], v[48:55], v0
  ds_read_b128 v[48:51], v5 offset:24576
  ds_read_b128 v[52:55], v5 offset:25600
  v_smfmac_f32_16x16x64_bf16 v[16:19], v[44:47], v[136:143], v0
  v_smfmac_f32_16x16x64_bf16 v[20:23], v[44:47], v[144:151], v0
  s_waitcnt lgkmcnt(3)
  v_smfmac_f32_16x16x64_bf16 v[32:35], v[44:47], v[56:63], v0
  ds_read_b128 v[56:59], v5 offset:26624
  ds_read_b128 v[60:63], v5 offset:27648
  v_smfmac_f32_16x16x64_bf16 v[28:31], v[44:47], v[152:159], v0
  ds_read_b128 v[44:47], v4 offset:8192
  v_smfmac_f32_16x16x64_bf16 v[12:15], v[36:39], v[160:167], v0
  s_waitcnt lgkmcnt(3)
  v_smfmac_f32_16x16x64_bf16 v[24:27], v[36:39], v[48:55], v0
  ds_read_b128 v[48:51], v5 offset:28672
  ds_read_b128 v[52:55], v5 offset:29696
  v_smfmac_f32_16x16x64_bf16 v[16:19], v[36:39], v[168:175], v0
  v_smfmac_f32_16x16x64_bf16 v[20:23], v[36:39], v[176:183], v0
  s_waitcnt lgkmcnt(3)
  v_smfmac_f32_16x16x64_bf16 v[32:35], v[36:39], v[56:63], v0
  ds_read_b128 v[56:59], v5 offset:32768
  ds_read_b128 v[60:63], v5 offset:33792
  v_smfmac_f32_16x16x64_bf16 v[28:31], v[36:39], v[184:191], v0
  v_smfmac_f32_16x16x64_bf16 v[12:15], v[40:43], v[192:199], v0
  v_smfmac_f32_16x16x64_bf16 v[16:19], v[40:43], v[200:207], v0
  s_waitcnt lgkmcnt(4)
  v_smfmac_f32_16x16x64_bf16 v[12:15], v[44:47], v[224:231], v0
  v_smfmac_f32_16x16x64_bf16 v[16:19], v[44:47], v[232:239], v0
  v_smfmac_f32_16x16x64_bf16 v[20:23], v[40:43], v[208:215], v0
  s_waitcnt lgkmcnt(2)
  v_smfmac_f32_16x16x64_bf16 v[24:27], v[40:43], v[48:55], v0
  ds_read_b128 v[48:51], v5 offset:30720
  ds_read_b128 v[52:55], v5 offset:31744
  v_cvt_pk_bf16_f32 v12, v12, v13
  v_cvt_pk_bf16_f32 v13, v14, v15
  v_smfmac_f32_16x16x64_bf16 v[20:23], v[44:47], v[240:247], v0
  v_cvt_pk_bf16_f32 v14, v16, v17
  v_cvt_pk_bf16_f32 v15, v18, v19
  s_waitcnt lgkmcnt(2)
  v_smfmac_f32_16x16x64_bf16 v[24:27], v[44:47], v[56:63], v0
  ds_read_b128 v[56:59], v5 offset:34816
  ds_read_b128 v[60:63], v5 offset:35840
  s_cmp_eq_u32 s18, s99
  s_cbranch_scc1 SLOW_KD_10o
SLOW_KD_10:
  v_mfma_f32_16x16x16_bf16 v[16:19], v[12:13], v[2:3], 0
  v_mfma_f32_16x16x16_bf16 v[36:39], v[14:15], v[2:3], 0
  v_smfmac_f32_16x16x64_bf16 v[28:31], v[40:43], v[216:223], v0
  s_waitcnt lgkmcnt(2)
  v_smfmac_f32_16x16x64_bf16 v[32:35], v[40:43], v[48:55], v0
  v_cvt_pk_bf16_f32 v20, v20, v21
  v_cvt_pk_bf16_f32 v21, v22, v23
  v_cvt_pk_bf16_f32 v22, v24, v25
  v_cvt_pk_bf16_f32 v23, v26, v27
  v_mfma_f32_16x16x16_bf16 v[24:27], v[20:21], v[2:3], 0
  v_cvt_pk_bf16_f32 v12, v16, v17
  v_cvt_pk_bf16_f32 v13, v18, v19
  v_mfma_f32_16x16x16_bf16 v[16:19], v[22:23], v[2:3], 0
  v_cvt_pk_bf16_f32 v14, v36, v37
  v_cvt_pk_bf16_f32 v15, v38, v39
  s_add_u32 s19, s27, 67108864
  v_smfmac_f32_16x16x64_bf16 v[28:31], v[44:47], v[248:255], v0
  v_mfma_f32_16x16x32_bf16 v[36:39], v[64:67], v[12:15], 0
  v_cvt_pk_bf16_f32 v20, v24, v25
  v_mfma_f32_16x16x32_bf16 v[40:43], v[68:71], v[12:15], 0
  v_cvt_pk_bf16_f32 v21, v26, v27
  v_cvt_pk_bf16_f32 v22, v16, v17
  v_cvt_pk_bf16_f32 v23, v18, v19
  v_add_u32 v11, s52, v1
  s_add_u32 s26, s26, 262144
  v_mfma_f32_16x16x32_bf16 v[24:27], v[20:23], v[12:15], 0
  s_waitcnt lgkmcnt(0)
  v_smfmac_f32_16x16x64_bf16 v[32:35], v[44:47], v[56:63], v0
  v_cndmask_b32 v36, v40, v36, s[30:31]
  v_cndmask_b32 v37, v41, v37, s[30:31]
  v_cndmask_b32 v38, v42, v38, s[30:31]
  v_cndmask_b32 v39, v43, v39, s[30:31]
  ds_write_b128 v11, v[36:39]
  v_cndmask_b32 v24, v25, v24, s[30:31]
  v_cndmask_b32 v26, v27, v26, s[30:31]
  v_add_u32 v11, s53, v1
  v_cndmask_b32 v24, v26, v24, s[32:33]
  ds_write_b32 v11, v24
  buffer_store_dwordx4 v[20:23], v1, s[8:11], s19 offen sc1
  buffer_load_dwordx4 v[64:67], v1, s[8:11], s26 offen sc1
  buffer_load_dwordx4 v[68:71], v1, s[8:11], s26 offen offset:1024 sc1
  s_mov_b64 exec, 1
  buffer_store_dword v0, off, s[8:11], s98 sc1
  s_mov_b64 exec, -1
  s_add_u32 s98, s98, 4
  v_add_u32 v11, 156672, v1
  s_waitcnt lgkmcnt(0)
  s_barrier
  ds_read_b128 v[36:39], v11 offset:0
  ds_read_b128 v[40:43], v11 offset:1024
  ds_read_b128 v[44:47], v11 offset:2048
  ds_read_b128 v[16:19], v11 offset:3072
  ds_read_b128 v[24:27], v11 offset:4096
  v_permlane32_swap_b32 v28, v32
  v_permlane32_swap_b32 v29, v33
  v_permlane32_swap_b32 v30, v34
  v_permlane32_swap_b32 v31, v35
  v_pk_add_f32 v[28:29], v[28:29], v[32:33]
  v_pk_add_f32 v[30:31], v[30:31], v[34:35]
  v_cvt_pk_bf16_f32 v32, v28, v29
  v_cvt_pk_bf16_f32 v33, v30, v31
  s_cmp_eq_u32 s18, 63
  s_cbranch_scc1 L_CHAIN_FIN
  v_cndmask_b32 v34, v32, 0, s[32:33]
  v_cndmask_b32 v35, v33, 0, s[32:33]
  v_cndmask_b32 v30, 0, v32, s[32:33]
  v_cndmask_b32 v31, 0, v33, s[32:33]
  s_waitcnt lgkmcnt(3)
  v_pk_add_f32 v[36:37], v[36:37], v[40:41]
  v_pk_add_f32 v[38:39], v[38:39], v[42:43]
  s_waitcnt lgkmcnt(1)
  v_pk_add_f32 v[44:45], v[44:45], v[16:17]
  v_pk_add_f32 v[46:47], v[46:47], v[18:19]
  v_pk_add_f32 v[36:37], v[36:37], v[44:45]
  v_pk_add_f32 v[38:39], v[38:39], v[46:47]
  s_waitcnt lgkmcnt(0)
  v_pk_add_f32 v[24:25], v[24:25], v[26:27]
  v_max3_f32 v40, v36, v37, v38
  v_add_f32 v24, v24, v25
  v_mov_b32 v20, 0x3f803f80
  v_max3_f32 v40, v40, v39, v24
  v_mov_b32 v21, 0x3f803f80
  v_mov_b32 v22, 0x3f803f80
  v_max_f32_dpp v40, v40, v40 row_ror:8 row_mask:0xf bank_mask:0xf
  v_mov_b32 v41, v40
  v_mov_b32 v23, 0x3f803f80
  v_cndmask_b32 v28, 0, v20, s[32:33]
  v_permlane16_swap_b32 v40, v41
  v_max_f32 v40, v40, v41
  v_mov_b32 v41, v40
  v_cndmask_b32 v29, 0, v20, s[32:33]
  v_add_u32 v11, s54, v7
  v_permlane32_swap_b32 v40, v41
  v_max_f32 v40, v40, v41
  v_mul_f32 v40, s50, v40
  v_fma_f32 v24, v24, s50, -v40
  v_pk_fma_f32 v[36:37], v[36:37], s[50:51], v[40:41] op_sel_hi:[1,0,0] neg_lo:[0,0,1] neg_hi:[0,0,1]
  v_pk_fma_f32 v[38:39], v[38:39], s[50:51], v[40:41] op_sel_hi:[1,0,0] neg_lo:[0,0,1] neg_hi:[0,0,1]
  v_exp_f32 v24, v24
  v_exp_f32 v36, v36
  v_exp_f32 v37, v37
  v_exp_f32 v38, v38
  v_exp_f32 v39, v39
  v_mov_b32_dpp v25, v24 row_ror:8 row_mask:0xf bank_mask:0xf
  v_cvt_pk_bf16_f32 v12, v36, v37
  v_cvt_pk_bf16_f32 v13, v38, v39
  v_cvt_pk_bf16_f32 v42, v24, v25
  v_mov_b32_dpp v14, v12 row_ror:8 row_mask:0xf bank_mask:0xf
  v_mov_b32_dpp v15, v13 row_ror:8 row_mask:0xf bank_mask:0xf
  v_mov_b32 v43, v42
  s_waitcnt vmcnt(4)
  v_mfma_f32_16x16x32_bf16 v[48:51], v[20:23], v[12:15], 0
  v_permlane32_swap_b32 v42, v43
  v_mfma_f32_16x16x32_bf16 v[44:47], v[72:75], v[12:15], 0
  v_mfma_f32_16x16x32_bf16 v[16:19], v[76:79], v[12:15], 0
  v_mfma_f32_16x16x16_bf16 v[48:51], v[28:29], v[42:43], v[48:51]
  v_mfma_f32_16x16x16_bf16 v[44:47], v[30:31], v[42:43], v[44:47]
  v_mfma_f32_16x16x16_bf16 v[16:19], v[34:35], v[42:43], v[16:19]
  v_lshrrev_b32 v24, 1, v1
  s_lshr_b32 s19, s27, 1
  s_add_u32 s19, s19, 75497472
  buffer_store_dwordx2 v[32:33], v24, s[8:11], s19 offen sc1
  v_mov_b64 v[24:25], 0
  v_mov_b64 v[26:27], 0
  v_mov_b64 v[36:37], 0
  v_mov_b64 v[38:39], 0
  v_rcp_f32 v49, v48
  v_mov_b64 v[20:21], 0
  v_mov_b64 v[22:23], 0
  v_pk_mul_f32 v[44:45], v[44:45], v[48:49] op_sel:[0,1] op_sel_hi:[1,1]
  v_pk_mul_f32 v[46:47], v[46:47], v[48:49] op_sel:[0,1] op_sel_hi:[1,1]
  v_pk_mul_f32 v[16:17], v[16:17], v[48:49] op_sel:[0,1] op_sel_hi:[1,1]
  v_pk_mul_f32 v[18:19], v[18:19], v[48:49] op_sel:[0,1] op_sel_hi:[1,1]
  v_cvt_pk_bf16_f32 v12, v44, v45
  v_cvt_pk_bf16_f32 v13, v46, v47
  v_cvt_pk_bf16_f32 v14, v16, v17
  v_cvt_pk_bf16_f32 v15, v18, v19
  s_mov_b64 exec, s[30:31]
  ds_write_b128 v11, v[12:15]
  s_mov_b64 exec, -1
  v_add_u32 v45, 161792, v7
  v_mov_b64 v[40:41], 0
  v_mov_b64 v[42:43], 0
  v_mov_b64 v[28:29], 0
  v_mov_b64 v[30:31], 0
  s_and_b32 s29, s18, 1
  s_lshl_b32 s29, s29, 16
  v_mov_b32 v11, s29
  s_waitcnt lgkmcnt(0)
  s_barrier
  ds_read_b128 v[16:19], v6
  ds_read_b128 v[32:35], v6 offset:1024
  ds_read_b128 v[48:51], v45 offset:0
  ds_read_b128 v[52:55], v45 offset:512
  ds_read_b128 v[56:59], v45 offset:1024
  ds_read_b128 v[60:63], v45 offset:1536
  s_waitcnt lgkmcnt(5)
  v_smfmac_f32_16x16x64_bf16 v[24:27], v[16:19], a[0:7], v0
  s_waitcnt lgkmcnt(4)
  v_smfmac_f32_16x16x64_bf16 v[24:27], v[32:35], a[8:15], v0
  s_waitcnt lgkmcnt(3)
  v_smfmac_f32_16x16x64_bf16 v[20:23], v[48:51], a[16:23], v0
  s_waitcnt lgkmcnt(2)
  v_smfmac_f32_16x16x64_bf16 v[20:23], v[52:55], a[24:31], v0
  v_cvt_pk_bf16_f32 v24, v24, v25
  v_cvt_pk_bf16_f32 v25, v26, v27
  s_waitcnt lgkmcnt(1)
  v_smfmac_f32_16x16x64_bf16 v[20:23], v[56:59], a[32:39], v0
  v_mfma_f32_16x16x16_bf16 v[44:47], v[2:3], v[24:25], 0
  s_waitcnt lgkmcnt(0)
  v_smfmac_f32_16x16x64_bf16 v[20:23], v[60:63], a[40:47], v0
  v_smfmac_f32_16x16x64_bf16 v[36:39], v[48:51], a[48:55], v0
  v_cvt_pk_bf16_f32 v44, v44, v45
  v_cvt_pk_bf16_f32 v45, v46, v47
  v_bfi_b32 v45, s62, v11, v45
  v_smfmac_f32_16x16x64_bf16 v[36:39], v[52:55], a[56:63], v0
  s_mov_b64 exec, s[32:33]
  buffer_store_dwordx2 v[44:45], v8, s[8:11], s25 offen sc1
  s_mov_b64 exec, -1
  v_cvt_pk_bf16_f32 v20, v20, v21
  v_cvt_pk_bf16_f32 v21, v22, v23
  v_smfmac_f32_16x16x64_bf16 v[36:39], v[56:59], a[64:71], v0
  v_bfi_b32 v21, s62, v11, v21
  buffer_store_dwordx2 v[20:21], v8, s[8:11], s25 offen offset:256 sc1
  v_smfmac_f32_16x16x64_bf16 v[36:39], v[60:63], a[72:79], v0
  v_smfmac_f32_16x16x64_bf16 v[40:43], v[48:51], a[80:87], v0
  v_smfmac_f32_16x16x64_bf16 v[40:43], v[52:55], a[88:95], v0
  v_cvt_pk_bf16_f32 v36, v36, v37
  v_cvt_pk_bf16_f32 v37, v38, v39
  v_bfi_b32 v37, s62, v11, v37
  v_smfmac_f32_16x16x64_bf16 v[40:43], v[56:59], a[96:103], v0
  buffer_store_dwordx2 v[36:37], v8, s[8:11], s25 offen offset:768 sc1
  v_smfmac_f32_16x16x64_bf16 v[40:43], v[60:63], a[104:111], v0
  v_smfmac_f32_16x16x64_bf16 v[28:31], v[48:51], a[112:119], v0
  v_smfmac_f32_16x16x64_bf16 v[28:31], v[52:55], a[120:127], v0
  v_cvt_pk_bf16_f32 v40, v40, v41
  v_cvt_pk_bf16_f32 v41, v42, v43
  v_bfi_b32 v41, s62, v11, v41
  v_smfmac_f32_16x16x64_bf16 v[28:31], v[56:59], a[128:135], v0
  buffer_store_dwordx2 v[40:41], v8, s[8:11], s25 offen offset:1280 sc1
  v_smfmac_f32_16x16x64_bf16 v[28:31], v[60:63], a[136:143], v0
  s_nop 7
  v_cvt_pk_bf16_f32 v28, v28, v29
  v_cvt_pk_bf16_f32 v29, v30, v31
  v_bfi_b32 v29, s62, v11, v29
  buffer_store_dwordx2 v[28:29], v8, s[8:11], s25 offen offset:1792 sc1
  s_add_u32 s18, s18, 1
  s_add_u32 s27, s27, 131072
  s_and_b32 s57, s18, 3
  s_lshl_b32 s57, s57, 14
  s_add_u32 s56, s57, s28
  s_add_u32 s19, s56, 4096
  s_add_u32 s20, s56, 5120
  s_cmp_eq_u32 s24, -1
  s_cbranch_scc1 SLOW_RSKIP
  s_add_u32 s57, s57, s24
  s_add_u32 s57, s57, 80216064
  s_add_u32 s58, s18, 2
  s_and_b32 s58, s58, 3
  s_lshl_b32 s58, s58, 14
  s_add_u32 s58, s58, s24
  s_add_u32 s58, s58, 80216064
  v_mov_b32 v46, 0x3f80
  v_mov_b32 v47, 0x3f800000
  v_cndmask_b32 v46, v46, v47, s[44:45]
  v_cndmask_b32 v12, 0, v46, s[36:37]
  v_cndmask_b32 v13, 0, v46, s[38:39]
  v_cndmask_b32 v14, 0, v46, s[40:41]
  v_cndmask_b32 v15, 0, v46, s[42:43]
  s_waitcnt vmcnt(0)
SLOW_RPOLL:
  buffer_load_dwordx4 v[48:51], v9, s[8:11], s49 offen sc1
  buffer_load_dwordx4 v[52:55], v9, s[8:11], s46 offen sc1
  buffer_load_dwordx4 v[56:59], v9, s[8:11], s47 offen sc1
  buffer_load_dwordx4 v[60:63], v9, s[8:11], s48 offen sc1
  s_waitcnt vmcnt(3)
  v_mfma_f32_16x16x32_bf16 v[16:19], v[48:51], v[12:15], 0
  v_xor_b32 v20, v49, v11
  s_waitcnt vmcnt(2)
  v_mfma_f32_16x16x32_bf16 v[16:19], v[52:55], v[12:15], v[16:19]
  v_xor_b32 v21, v51, v11
  s_waitcnt vmcnt(1)
  v_mfma_f32_16x16x32_bf16 v[16:19], v[56:59], v[12:15], v[16:19]
  v_bitop3_b32 v20, v53, v11, v20 bitop3:0xbe
  s_waitcnt vmcnt(0)
  v_mfma_f32_16x16x32_bf16 v[16:19], v[60:63], v[12:15], v[16:19]
  v_bitop3_b32 v21, v55, v11, v21 bitop3:0xbe
  v_bitop3_b32 v20, v57, v11, v20 bitop3:0xbe
  v_bitop3_b32 v21, v59, v11, v21 bitop3:0xbe
  v_bitop3_b32 v20, v61, v11, v20 bitop3:0xbe
  v_bitop3_b32 v21, v63, v11, v21 bitop3:0xbe
  v_bitop3_b32 v20, v20, v21, s62 bitop3:0xa8
  v_cmp_ne_u32 vcc, 0, v20
  s_cbranch_vccnz SLOW_RRETRY
  v_permlane32_swap_b32 v16, v17
  v_permlane32_swap_b32 v18, v19
  v_add_f32 v16, v16, v17
  v_add_f32 v18, v18, v19
  s_mov_b64 exec, s[30:31]
  v_cvt_pk_bf16_f32 v16, v16, v18
  v_min_u32 v16, 0xfffffffe, v16
  buffer_store_dword v16, v10, s[8:11], s57 offen sc1
  v_mov_b32 v17, -1
  buffer_store_dword v17, v10, s[8:11], s58 offen sc1
  s_mov_b64 exec, -1
SLOW_RSKIP:
  v_add_u32 v72, s55, v1
  v_mov_b64 v[12:13], 0
  v_mov_b64 v[14:15], 0
  v_mov_b64 v[16:17], 0
  v_mov_b64 v[18:19], 0
  v_mov_b64 v[20:21], 0
  v_mov_b64 v[22:23], 0
  v_mov_b64 v[24:25], 0
  v_mov_b64 v[26:27], 0
  v_mov_b64 v[28:29], 0
  v_mov_b64 v[30:31], 0
  v_mov_b64 v[32:33], 0
  v_mov_b64 v[34:35], 0
  ds_read_b128 v[48:51], v5 offset:0
  ds_read_b128 v[52:55], v5 offset:1024
  ds_read_b128 v[56:59], v5 offset:2048
  ds_read_b128 v[60:63], v5 offset:3072
  s_waitcnt vmcnt(1)
  s_barrier
  buffer_load_dwordx4 v[36:39], v1, s[8:11], s56 offen sc1
  buffer_load_dwordx4 v[40:43], v1, s[8:11], s19 offen sc1
  s_cmp_eq_u32 s17, 3
  s_cbranch_scc0 SLOW_C3_11
  buffer_load_dwordx4 v[44:47], v1, s[8:11], s20 offen sc1
SLOW_C3_11:
  s_branch SLOW_CWAIT
SLOW_CPOLL:
  s_waitcnt vmcnt(2)
  buffer_load_dwordx4 v[36:39], v1, s[8:11], s56 offen sc1
  s_waitcnt vmcnt(2)
  buffer_load_dwordx4 v[40:43], v1, s[8:11], s19 offen sc1
  s_cmp_eq_u32 s17, 3
  s_cbranch_scc0 SLOW_C3_12
  s_waitcnt vmcnt(2)
  buffer_load_dwordx4 v[44:47], v1, s[8:11], s20 offen sc1
SLOW_C3_12:
SLOW_CWAIT:
  s_cmp_eq_u32 s17, 3
  s_cbranch_scc0 SLOW_CNO3
  s_waitcnt vmcnt(2)
  ds_write_b128 v72, v[36:39]
  v_max3_u32 v11, v36, v37, v38
  s_waitcnt vmcnt(1)
  ds_write_b128 v72, v[40:43] offset:4096
  v_max3_u32 v11, v11, v39, v40
  v_max3_u32 v11, v11, v41, v42
  s_waitcnt vmcnt(0)
  ds_write_b128 v72, v[44:47] offset:5120
  v_max3_u32 v11, v11, v43, v44
  v_max3_u32 v11, v11, v45, v46
  v_max_u32 v11, v11, v47
  s_branch SLOW_CJ
SLOW_CNO3:
  s_waitcnt vmcnt(1)
  ds_write_b128 v72, v[36:39]
  v_max3_u32 v11, v36, v37, v38
  s_waitcnt vmcnt(0)
  ds_write_b128 v72, v[40:43] offset:4096
  v_max3_u32 v11, v11, v39, v40
  v_max3_u32 v11, v11, v41, v42
  v_max_u32 v11, v11, v43
SLOW_CJ:
  v_cmp_eq_u32 vcc, -1, v11
  s_cbranch_vccz SLOW_PRE
  s_add_u32 s59, s59, 1
  s_cmp_lt_u32 s59, 200000
  s_cbranch_scc1 SLOW_CPOLL
  s_branch L_CHAIN_DONE
SLOW_KC_9o:
  s_add_u32 s63, s18, 1
  s_and_b32 s63, s63, 63
  buffer_load_dword v11, off, s[64:67], s63 sc1
  s_branch SLOW_KC_9
SLOW_KD_10o:
  s_add_u32 s99, s99, 4
  s_waitcnt vmcnt(2)
SLOW_KD_10q:
  s_waitcnt vmcnt(0)
  v_readfirstlane_b32 s20, v11
  s_cmp_ge_u32 s20, 32
  s_cbranch_scc1 SLOW_KD_10
  s_add_u32 s59, s59, 1
  s_cmp_ge_u32 s59, 200000
  s_cbranch_scc1 L_CHAIN_DONE
  buffer_load_dword v11, off, s[64:67], s63 sc1
  s_waitcnt vmcnt(0)
  s_branch SLOW_KD_10q
SLOW_RRETRY:
  s_add_u32 s59, s59, 1
  s_cmp_lt_u32 s59, 200000
  s_cbranch_scc1 SLOW_RPOLL
  s_branch L_CHAIN_DONE
  s_branch L_CHAIN_DONE
L_CHAIN_FIN:
  v_lshrrev_b32 v28, 1, v1
  s_lshr_b32 s19, s27, 1
  s_add_u32 s19, s19, 75497472
  buffer_store_dwordx2 v[32:33], v28, s[8:11], s19 offen sc1
  s_waitcnt vmcnt(0)
  s_barrier
  s_cmp_eq_u32 s17, 3
  s_cbranch_scc0 L_CHAIN_DONE
  v_mov_b32 v20, 1
  s_mov_b64 exec, 1
  buffer_store_dword v20, off, s[8:11], s95 offset:252 sc1
  buffer_store_dword v20, off, s[8:11], s95 offset:256 sc1
  s_mov_b64 exec, -1
L_CHAIN_DONE:
  s_branch L_END
L_WORKER:
  s_and_b32 s96, s2, 7
  s_lshr_b32 s98, s2, 3
  s_mov_b32 s95, 0
  s_cmp_ge_u32 s96, 5
  s_cselect_b32 s95, 11, 0
  s_cmp_eq_u32 s96, 7
  s_cselect_b32 s95, 10, s95
  s_cmp_lt_u32 s98, s95
  s_cbranch_scc0 L_WA
  s_sub_u32 s94, s96, 5
  s_mul_i32 s94, s94, 11
  s_add_u32 s94, s94, s98
  s_load_dwordx2 s[8:9], s[70:71], 56
  s_load_dwordx2 s[12:13], s[70:71], 64
  s_load_dwordx2 s[16:17], s[70:71], 96
  s_load_dwordx2 s[20:21], s[70:71], 88
  s_waitcnt lgkmcnt(0)
  s_mov_b32 s10, 2359296
  s_mov_b32 s11, 0x00020000
  s_mov_b32 s14, 1990656
  s_mov_b32 s15, 0x00020000
  s_mov_b32 s18, 268435456
  s_mov_b32 s19, 0x00020000
  s_mov_b32 s22, 256
  s_mov_b32 s23, 0x00020000
  v_lshrrev_b32 v12, 6, v0
  s_nop 0
  v_readfirstlane_b32 s28, v12
  v_and_b32 v0, 63, v0
  v_lshlrev_b32 v1, 4, v0
  v_lshlrev_b32 v6, 3, v0
  v_lshrrev_b32 v12, 3, v0
  v_and_b32 v13, 7, v0
  v_xor_b32 v13, v13, v12
  v_lshlrev_b32 v13, 4, v13
  v_mul_u32_u24 v12, 1152, v12
  v_add_u32 v2, v12, v13
  v_and_b32 v12, 15, v0
  v_lshrrev_b32 v13, 4, v0
  v_and_b32 v14, 7, v0
  v_xor_b32 v14, v14, v13
  v_lshlrev_b32 v14, 4, v14
  v_lshlrev_b32 v15, 7, v12
  s_lshl_b32 s32, s28, 12
  v_add3_u32 v3, v15, v14, s32
  v_xor_b32 v4, 64, v3
  v_bfe_u32 v14, v0, 2, 2
  v_lshlrev_b32 v15, 3, v13
  v_add_u32 v15, v15, v14
  v_mul_u32_u24 v15, 288, v15
  v_and_b32 v14, 3, v0
  v_lshlrev_b32 v14, 3, v14
  v_add_u32 v15, v15, v14
  v_add_u32 v5, 16384, v15
  s_add_u32 s32, s28, 0
  s_lshl_b32 s32, s32, 6
  v_add_u32 v12, s32, v0
  v_mul_u32_u24 v13, 3641, v12
  v_lshrrev_b32 v13, 16, v13
  v_mul_u32_u24 v14, 18, v13
  v_sub_u32 v14, v12, v14
  v_mul_u32_u24 v13, 3456, v13
  v_lshlrev_b32 v14, 4, v14
  v_add_u32 v7, v13, v14
  s_add_u32 s32, s28, 4
  s_lshl_b32 s32, s32, 6
  v_add_u32 v12, s32, v0
  v_mul_u32_u24 v13, 3641, v12
  v_lshrrev_b32 v13, 16, v13
  v_mul_u32_u24 v14, 18, v13
  v_sub_u32 v14, v12, v14
  v_mul_u32_u24 v13, 3456, v13
  v_lshlrev_b32 v14, 4, v14
  v_add_u32 v8, v13, v14
  s_add_u32 s32, s28, 8
  s_lshl_b32 s32, s32, 6
  v_add_u32 v12, s32, v0
  v_mul_u32_u24 v13, 3641, v12
  v_lshrrev_b32 v13, 16, v13
  v_mul_u32_u24 v14, 18, v13
  v_sub_u32 v14, v12, v14
  v_mul_u32_u24 v13, 3456, v13
  v_lshlrev_b32 v14, 4, v14
  v_add_u32 v9, v13, v14
  s_add_u32 s32, s28, 12
  s_lshl_b32 s32, s32, 6
  v_add_u32 v12, s32, v0
  v_mul_u32_u24 v13, 3641, v12
  v_lshrrev_b32 v13, 16, v13
  v_mul_u32_u24 v14, 18, v13
  v_sub_u32 v14, v12, v14
  v_mul_u32_u24 v13, 3456, v13
  v_lshlrev_b32 v14, 4, v14
  v_add_u32 v10, v13, v14
  s_add_u32 s32, s28, 16
  s_lshl_b32 s32, s32, 6
  v_add_u32 v12, s32, v0
  v_mul_u32_u24 v13, 3641, v12
  v_lshrrev_b32 v13, 16, v13
  v_mul_u32_u24 v14, 18, v13
  v_sub_u32 v14, v12, v14
  v_mul_u32_u24 v13, 3456, v13
  v_lshlrev_b32 v14, 4, v14
  v_add_u32 v11, v13, v14
  s_mov_b32 s97, s28
  s_lshr_b32 s29, s94, 3
  s_and_b32 s30, s94, 7
  v_accvgpr_write_b32 a0, 0
  v_accvgpr_write_b32 a1, 0
  v_accvgpr_write_b32 a2, 0
  v_accvgpr_write_b32 a3, 0
  v_accvgpr_write_b32 a4, 0
  v_accvgpr_write_b32 a5, 0
  v_accvgpr_write_b32 a6, 0
  v_accvgpr_write_b32 a7, 0
  v_accvgpr_write_b32 a8, 0
  v_accvgpr_write_b32 a9, 0
  v_accvgpr_write_b32 a10, 0
  v_accvgpr_write_b32 a11, 0
  v_accvgpr_write_b32 a12, 0
  v_accvgpr_write_b32 a13, 0
  v_accvgpr_write_b32 a14, 0
  v_accvgpr_write_b32 a15, 0
  v_accvgpr_write_b32 a16, 0
  v_accvgpr_write_b32 a17, 0
  v_accvgpr_write_b32 a18, 0
  v_accvgpr_write_b32 a19, 0
  v_accvgpr_write_b32 a20, 0
  v_accvgpr_write_b32 a21, 0
  v_accvgpr_write_b32 a22, 0
  v_accvgpr_write_b32 a23, 0
  v_accvgpr_write_b32 a24, 0
  v_accvgpr_write_b32 a25, 0
  v_accvgpr_write_b32 a26, 0
  v_accvgpr_write_b32 a27, 0
  v_accvgpr_write_b32 a28, 0
  v_accvgpr_write_b32 a29, 0
  v_accvgpr_write_b32 a30, 0
  v_accvgpr_write_b32 a31, 0
  v_accvgpr_write_b32 a32, 0
  v_accvgpr_write_b32 a33, 0
  v_accvgpr_write_b32 a34, 0
  v_accvgpr_write_b32 a35, 0
  v_accvgpr_write_b32 a36, 0
  v_accvgpr_write_b32 a37, 0
  v_accvgpr_write_b32 a38, 0
  v_accvgpr_write_b32 a39, 0
  v_accvgpr_write_b32 a40, 0
  v_accvgpr_write_b32 a41, 0
  v_accvgpr_write_b32 a42, 0
  v_accvgpr_write_b32 a43, 0
  v_accvgpr_write_b32 a44, 0
  v_accvgpr_write_b32 a45, 0
  v_accvgpr_write_b32 a46, 0
  v_accvgpr_write_b32 a47, 0
  v_accvgpr_write_b32 a48, 0
  v_accvgpr_write_b32 a49, 0
  v_accvgpr_write_b32 a50, 0
  v_accvgpr_write_b32 a51, 0
  v_accvgpr_write_b32 a52, 0
  v_accvgpr_write_b32 a53, 0
  v_accvgpr_write_b32 a54, 0
  v_accvgpr_write_b32 a55, 0
  v_accvgpr_write_b32 a56, 0
  v_accvgpr_write_b32 a57, 0
  v_accvgpr_write_b32 a58, 0
  v_accvgpr_write_b32 a59, 0
  v_accvgpr_write_b32 a60, 0
  v_accvgpr_write_b32 a61, 0
  v_accvgpr_write_b32 a62, 0
  v_accvgpr_write_b32 a63, 0
  v_accvgpr_write_b32 a64, 0
  v_accvgpr_write_b32 a65, 0
  v_accvgpr_write_b32 a66, 0
  v_accvgpr_write_b32 a67, 0
  v_accvgpr_write_b32 a68, 0
  v_accvgpr_write_b32 a69, 0
  v_accvgpr_write_b32 a70, 0
  v_accvgpr_write_b32 a71, 0
  v_accvgpr_write_b32 a72, 0
  v_accvgpr_write_b32 a73, 0
  v_accvgpr_write_b32 a74, 0
  v_accvgpr_write_b32 a75, 0
  v_accvgpr_write_b32 a76, 0
  v_accvgpr_write_b32 a77, 0
  v_accvgpr_write_b32 a78, 0
  v_accvgpr_write_b32 a79, 0
  v_accvgpr_write_b32 a80, 0
  v_accvgpr_write_b32 a81, 0
  v_accvgpr_write_b32 a82, 0
  v_accvgpr_write_b32 a83, 0
  v_accvgpr_write_b32 a84, 0
  v_accvgpr_write_b32 a85, 0
  v_accvgpr_write_b32 a86, 0
  v_accvgpr_write_b32 a87, 0
  v_accvgpr_write_b32 a88, 0
  v_accvgpr_write_b32 a89, 0
  v_accvgpr_write_b32 a90, 0
  v_accvgpr_write_b32 a91, 0
  v_accvgpr_write_b32 a92, 0
  v_accvgpr_write_b32 a93, 0
  v_accvgpr_write_b32 a94, 0
  v_accvgpr_write_b32 a95, 0
  v_accvgpr_write_b32 a96, 0
  v_accvgpr_write_b32 a97, 0
  v_accvgpr_write_b32 a98, 0
  v_accvgpr_write_b32 a99, 0
  v_accvgpr_write_b32 a100, 0
  v_accvgpr_write_b32 a101, 0
  v_accvgpr_write_b32 a102, 0
  v_accvgpr_write_b32 a103, 0
  v_accvgpr_write_b32 a104, 0
  v_accvgpr_write_b32 a105, 0
  v_accvgpr_write_b32 a106, 0
  v_accvgpr_write_b32 a107, 0
  v_accvgpr_write_b32 a108, 0
  v_accvgpr_write_b32 a109, 0
  v_accvgpr_write_b32 a110, 0
  v_accvgpr_write_b32 a111, 0
  v_accvgpr_write_b32 a112, 0
  v_accvgpr_write_b32 a113, 0
  v_accvgpr_write_b32 a114, 0
  v_accvgpr_write_b32 a115, 0
  v_accvgpr_write_b32 a116, 0
  v_accvgpr_write_b32 a117, 0
  v_accvgpr_write_b32 a118, 0
  v_accvgpr_write_b32 a119, 0
  v_accvgpr_write_b32 a120, 0
  v_accvgpr_write_b32 a121, 0
  v_accvgpr_write_b32 a122, 0
  v_accvgpr_write_b32 a123, 0
  v_accvgpr_write_b32 a124, 0
  v_accvgpr_write_b32 a125, 0
  v_accvgpr_write_b32 a126, 0
  v_accvgpr_write_b32 a127, 0
  v_accvgpr_write_b32 a128, 0
  v_accvgpr_write_b32 a129, 0
  v_accvgpr_write_b32 a130, 0
  v_accvgpr_write_b32 a131, 0
  v_accvgpr_write_b32 a132, 0
  v_accvgpr_write_b32 a133, 0
  v_accvgpr_write_b32 a134, 0
  v_accvgpr_write_b32 a135, 0
  s_mul_i32 s43, s29, 288
  s_mov_b32 s45, 0
B1_RB:
  s_mul_i32 s31, s30, 2
  s_add_u32 s31, s31, s45
  s_lshl_b32 s42, s31, 7
  s_lshl_b32 s32, s28, 5
  s_add_u32 s42, s42, s32
  s_mul_i32 s42, s42, 1152
  s_mov_b32 s41, 0
  s_mov_b32 s40, 0
  s_barrier
  s_lshl_b32 s32, s28, 12
  s_add_u32 s32, s32, s40
  s_lshl_b32 s33, s41, 1
  s_add_u32 s33, s33, s42
  s_add_u32 m0, s32, 0
  s_nop 0
  buffer_load_dwordx4 v2, s[8:11], s33 offen lds
  s_add_u32 s33, s33, 9216
  s_add_u32 m0, s32, 1024
  s_nop 0
  buffer_load_dwordx4 v2, s[8:11], s33 offen lds
  s_add_u32 s33, s33, 9216
  s_add_u32 m0, s32, 2048
  s_nop 0
  buffer_load_dwordx4 v2, s[8:11], s33 offen lds
  s_add_u32 s33, s33, 9216
  s_add_u32 m0, s32, 3072
  s_nop 0
  buffer_load_dwordx4 v2, s[8:11], s33 offen lds
  s_lshl_b32 s32, s28, 10
  s_add_u32 s32, s32, s40
  s_mul_i32 s33, s41, 3456
  s_add_u32 s33, s33, s43
  s_add_u32 m0, s32, 16384
  s_nop 0
  buffer_load_dwordx4 v7, s[12:15], s33 offen lds
  s_add_u32 m0, s32, 20480
  s_nop 0
  buffer_load_dwordx4 v8, s[12:15], s33 offen lds
  s_add_u32 m0, s32, 24576
  s_nop 0
  buffer_load_dwordx4 v9, s[12:15], s33 offen lds
  s_add_u32 m0, s32, 28672
  s_nop 0
  buffer_load_dwordx4 v10, s[12:15], s33 offen lds
  s_cmp_lt_u32 s28, 2
  s_cbranch_scc0 B1a_m4_13
  s_add_u32 m0, s32, 32768
  s_nop 0
  buffer_load_dwordx4 v11, s[12:15], s33 offen lds
B1a_m4_13:
  s_add_u32 s33, s33, 1152
  s_add_u32 m0, s32, 34816
  s_nop 0
  buffer_load_dwordx4 v7, s[12:15], s33 offen lds
  s_add_u32 m0, s32, 38912
  s_nop 0
  buffer_load_dwordx4 v8, s[12:15], s33 offen lds
  s_add_u32 m0, s32, 43008
  s_nop 0
  buffer_load_dwordx4 v9, s[12:15], s33 offen lds
  s_add_u32 m0, s32, 47104
  s_nop 0
  buffer_load_dwordx4 v10, s[12:15], s33 offen lds
  s_cmp_lt_u32 s28, 2
  s_cbranch_scc0 B1a_m4_14
  s_add_u32 m0, s32, 51200
  s_nop 0
  buffer_load_dwordx4 v11, s[12:15], s33 offen lds
B1a_m4_14:
  s_add_u32 s33, s33, 1152
  s_add_u32 m0, s32, 53248
  s_nop 0
  buffer_load_dwordx4 v7, s[12:15], s33 offen lds
  s_add_u32 m0, s32, 57344
  s_nop 0
  buffer_load_dwordx4 v8, s[12:15], s33 offen lds
  s_add_u32 m0, s32, 61440
  s_nop 0
  buffer_load_dwordx4 v9, s[12:15], s33 offen lds
  s_add_u32 m0, s32, 65536
  s_nop 0
  buffer_load_dwordx4 v10, s[12:15], s33 offen lds
  s_cmp_lt_u32 s28, 2
  s_cbranch_scc0 B1a_m4_15
  s_add_u32 m0, s32, 69632
  s_nop 0
  buffer_load_dwordx4 v11, s[12:15], s33 offen lds
B1a_m4_15:
  s_mov_b32 s41, 64
  s_mov_b32 s40, 71680
  s_waitcnt vmcnt(0)
  s_barrier
  s_lshl_b32 s32, s28, 12
  s_add_u32 s32, s32, s40
  s_lshl_b32 s33, s41, 1
  s_add_u32 s33, s33, s42
  s_add_u32 m0, s32, 0
  s_nop 0
  buffer_load_dwordx4 v2, s[8:11], s33 offen lds
  s_add_u32 s33, s33, 9216
  s_add_u32 m0, s32, 1024
  s_nop 0
  buffer_load_dwordx4 v2, s[8:11], s33 offen lds
  s_add_u32 s33, s33, 9216
  s_add_u32 m0, s32, 2048
  s_nop 0
  buffer_load_dwordx4 v2, s[8:11], s33 offen lds
  s_add_u32 s33, s33, 9216
  s_add_u32 m0, s32, 3072
  s_nop 0
  buffer_load_dwordx4 v2, s[8:11], s33 offen lds
  s_lshl_b32 s32, s28, 10
  s_add_u32 s32, s32, s40
  s_mul_i32 s33, s41, 3456
  s_add_u32 s33, s33, s43
  s_add_u32 m0, s32, 16384
  s_nop 0
  buffer_load_dwordx4 v7, s[12:15], s33 offen lds
  s_add_u32 m0, s32, 20480
  s_nop 0
  buffer_load_dwordx4 v8, s[12:15], s33 offen lds
  s_add_u32 m0, s32, 24576
  s_nop 0
  buffer_load_dwordx4 v9, s[12:15], s33 offen lds
  s_add_u32 m0, s32, 28672
  s_nop 0
  buffer_load_dwordx4 v10, s[12:15], s33 offen lds
  s_cmp_lt_u32 s28, 2
  s_cbranch_scc0 B1b_m4_16
  s_add_u32 m0, s32, 32768
  s_nop 0
  buffer_load_dwordx4 v11, s[12:15], s33 offen lds
B1b_m4_16:
  s_add_u32 s33, s33, 1152
  s_add_u32 m0, s32, 34816
  s_nop 0
  buffer_load_dwordx4 v7, s[12:15], s33 offen lds
  s_add_u32 m0, s32, 38912
  s_nop 0
  buffer_load_dwordx4 v8, s[12:15], s33 offen lds
  s_add_u32 m0, s32, 43008
  s_nop 0
  buffer_load_dwordx4 v9, s[12:15], s33 offen lds
  s_add_u32 m0, s32, 47104
  s_nop 0
  buffer_load_dwordx4 v10, s[12:15], s33 offen lds
  s_cmp_lt_u32 s28, 2
  s_cbranch_scc0 B1b_m4_17
  s_add_u32 m0, s32, 51200
  s_nop 0
  buffer_load_dwordx4 v11, s[12:15], s33 offen lds
B1b_m4_17:
  s_add_u32 s33, s33, 1152
  s_add_u32 m0, s32, 53248
  s_nop 0
  buffer_load_dwordx4 v7, s[12:15], s33 offen lds
  s_add_u32 m0, s32, 57344
  s_nop 0
  buffer_load_dwordx4 v8, s[12:15], s33 offen lds
  s_add_u32 m0, s32, 61440
  s_nop 0
  buffer_load_dwordx4 v9, s[12:15], s33 offen lds
  s_add_u32 m0, s32, 65536
  s_nop 0
  buffer_load_dwordx4 v10, s[12:15], s33 offen lds
  s_cmp_lt_u32 s28, 2
  s_cbranch_scc0 B1b_m4_18
  s_add_u32 m0, s32, 69632
  s_nop 0
  buffer_load_dwordx4 v11, s[12:15], s33 offen lds
B1b_m4_18:
  ds_read_b128 a[136:139], v3 offset:0
  ds_read_b128 a[140:143], v3 offset:2048
  ds_read_b64_tr_b16 a[152:153], v5 offset:0
  ds_read_b64_tr_b16 a[154:155], v5 offset:1152
  ds_read_b64_tr_b16 a[156:157], v5 offset:32
  ds_read_b64_tr_b16 a[158:159], v5 offset:1184
  ds_read_b64_tr_b16 a[160:161], v5 offset:64
  ds_read_b64_tr_b16 a[162:163], v5 offset:1216
  ds_read_b64_tr_b16 a[164:165], v5 offset:96
  ds_read_b64_tr_b16 a[166:167], v5 offset:1248
  ds_read_b64_tr_b16 a[168:169], v5 offset:128
  ds_read_b64_tr_b16 a[170:171], v5 offset:1280
  ds_read_b64_tr_b16 a[172:173], v5 offset:160
  ds_read_b64_tr_b16 a[174:175], v5 offset:1312
  s_waitcnt lgkmcnt(10)
  v_mfma_f32_16x16x32_bf16 v[40:43], a[152:155], a[136:139], 0
  v_mfma_f32_16x16x32_bf16 v[44:47], a[152:155], a[140:143], 0
  ds_read_b64_tr_b16 a[176:177], v5 offset:192
  ds_read_b64_tr_b16 a[178:179], v5 offset:1344
  s_waitcnt lgkmcnt(10)
  v_mfma_f32_16x16x32_bf16 v[48:51], a[156:159], a[136:139], 0
  v_mfma_f32_16x16x32_bf16 v[52:55], a[156:159], a[140:143], 0
  ds_read_b64_tr_b16 a[180:181], v5 offset:224
  ds_read_b64_tr_b16 a[182:183], v5 offset:1376
  s_waitcnt lgkmcnt(10)
  v_mfma_f32_16x16x32_bf16 v[56:59], a[160:163], a[136:139], 0
  v_mfma_f32_16x16x32_bf16 v[60:63], a[160:163], a[140:143], 0
  ds_read_b64_tr_b16 a[152:153], v5 offset:256
  ds_read_b64_tr_b16 a[154:155], v5 offset:1408
  s_waitcnt lgkmcnt(10)
  v_mfma_f32_16x16x32_bf16 v[64:67], a[164:167], a[136:139], 0
  v_mfma_f32_16x16x32_bf16 v[68:71], a[164:167], a[140:143], 0
  ds_read_b64_tr_b16 a[156:157], v5 offset:18432
  ds_read_b64_tr_b16 a[158:159], v5 offset:19584
  s_waitcnt lgkmcnt(10)
  v_mfma_f32_16x16x32_bf16 v[72:75], a[168:171], a[136:139], 0
  v_mfma_f32_16x16x32_bf16 v[76:79], a[168:171], a[140:143], 0
  ds_read_b64_tr_b16 a[160:161], v5 offset:18464
  ds_read_b64_tr_b16 a[162:163], v5 offset:19616
  s_waitcnt lgkmcnt(10)
  v_mfma_f32_16x16x32_bf16 v[80:83], a[172:175], a[136:139], 0
  v_mfma_f32_16x16x32_bf16 v[84:87], a[172:175], a[140:143], 0
  ds_read_b64_tr_b16 a[164:165], v5 offset:18496
  ds_read_b64_tr_b16 a[166:167], v5 offset:19648
  s_waitcnt lgkmcnt(10)
  v_mfma_f32_16x16x32_bf16 v[88:91], a[176:179], a[136:139], 0
  v_mfma_f32_16x16x32_bf16 v[92:95], a[176:179], a[140:143], 0
  ds_read_b64_tr_b16 a[168:169], v5 offset:18528
  ds_read_b64_tr_b16 a[170:171], v5 offset:19680
  s_waitcnt lgkmcnt(10)
  v_mfma_f32_16x16x32_bf16 v[96:99], a[180:183], a[136:139], 0
  v_mfma_f32_16x16x32_bf16 v[100:103], a[180:183], a[140:143], 0
  ds_read_b64_tr_b16 a[172:173], v5 offset:18560
  ds_read_b64_tr_b16 a[174:175], v5 offset:19712
  s_waitcnt lgkmcnt(10)
  v_mfma_f32_16x16x32_bf16 v[104:107], a[152:155], a[136:139], 0
  v_mfma_f32_16x16x32_bf16 v[108:111], a[152:155], a[140:143], 0
  ds_read_b64_tr_b16 a[176:177], v5 offset:18592
  ds_read_b64_tr_b16 a[178:179], v5 offset:19744
  s_waitcnt lgkmcnt(10)
  v_mfma_f32_16x16x32_bf16 v[112:115], a[136:139], a[156:159], 0
  v_mfma_f32_16x16x32_bf16 v[116:119], a[140:143], a[156:159], 0
  ds_read_b64_tr_b16 a[180:181], v5 offset:18624
  ds_read_b64_tr_b16 a[182:183], v5 offset:19776
  s_waitcnt lgkmcnt(10)
  v_mfma_f32_16x16x32_bf16 v[120:123], a[136:139], a[160:163], 0
  v_mfma_f32_16x16x32_bf16 v[124:127], a[140:143], a[160:163], 0
  ds_read_b64_tr_b16 a[152:153], v5 offset:18656
  ds_read_b64_tr_b16 a[154:155], v5 offset:19808
  s_waitcnt lgkmcnt(10)
  v_mfma_f32_16x16x32_bf16 v[128:131], a[136:139], a[164:167], 0
  v_mfma_f32_16x16x32_bf16 v[132:135], a[140:143], a[164:167], 0
  ds_read_b64_tr_b16 a[156:157], v5 offset:18688
  ds_read_b64_tr_b16 a[158:159], v5 offset:19840
  s_waitcnt lgkmcnt(10)
  v_mfma_f32_16x16x32_bf16 v[136:139], a[136:139], a[168:171], 0
  v_mfma_f32_16x16x32_bf16 v[140:143], a[140:143], a[168:171], 0
  ds_read_b64_tr_b16 a[160:161], v5 offset:36864
  ds_read_b64_tr_b16 a[162:163], v5 offset:38016
  s_waitcnt lgkmcnt(10)
  v_mfma_f32_16x16x32_bf16 v[144:147], a[136:139], a[172:175], 0
  v_mfma_f32_16x16x32_bf16 v[148:151], a[140:143], a[172:175], 0
  ds_read_b64_tr_b16 a[164:165], v5 offset:36896
  ds_read_b64_tr_b16 a[166:167], v5 offset:38048
  s_waitcnt lgkmcnt(10)
  v_mfma_f32_16x16x32_bf16 v[152:155], a[136:139], a[176:179], 0
  v_mfma_f32_16x16x32_bf16 v[156:159], a[140:143], a[176:179], 0
  ds_read_b64_tr_b16 a[168:169], v5 offset:36928
  ds_read_b64_tr_b16 a[170:171], v5 offset:38080
  s_waitcnt lgkmcnt(10)
  v_mfma_f32_16x16x32_bf16 v[160:163], a[136:139], a[180:183], 0
  v_mfma_f32_16x16x32_bf16 v[164:167], a[140:143], a[180:183], 0
  ds_read_b64_tr_b16 a[172:173], v5 offset:36960
  ds_read_b64_tr_b16 a[174:175], v5 offset:38112
  s_waitcnt lgkmcnt(10)
  v_mfma_f32_16x16x32_bf16 v[168:171], a[136:139], a[152:155], 0
  v_mfma_f32_16x16x32_bf16 v[172:175], a[140:143], a[152:155], 0
  ds_read_b64_tr_b16 a[176:177], v5 offset:36992
  ds_read_b64_tr_b16 a[178:179], v5 offset:38144
  s_waitcnt lgkmcnt(10)
  v_mfma_f32_16x16x32_bf16 v[176:179], a[136:139], a[156:159], 0
  v_mfma_f32_16x16x32_bf16 v[180:183], a[140:143], a[156:159], 0
  ds_read_b64_tr_b16 a[180:181], v5 offset:37024
  ds_read_b64_tr_b16 a[182:183], v5 offset:38176
  s_waitcnt lgkmcnt(10)
  v_mfma_f32_16x16x32_bf16 v[184:187], a[136:139], a[160:163], 0
  v_mfma_f32_16x16x32_bf16 v[188:191], a[140:143], a[160:163], 0
  ds_read_b64_tr_b16 a[152:153], v5 offset:37056
  ds_read_b64_tr_b16 a[154:155], v5 offset:38208
  s_waitcnt lgkmcnt(10)
  v_mfma_f32_16x16x32_bf16 v[192:195], a[136:139], a[164:167], 0
  v_mfma_f32_16x16x32_bf16 v[196:199], a[140:143], a[164:167], 0
  ds_read_b64_tr_b16 a[156:157], v5 offset:37088
  ds_read_b64_tr_b16 a[158:159], v5 offset:38240
  s_waitcnt lgkmcnt(10)
  v_mfma_f32_16x16x32_bf16 v[200:203], a[136:139], a[168:171], 0
  v_mfma_f32_16x16x32_bf16 v[204:207], a[140:143], a[168:171], 0
  ds_read_b64_tr_b16 a[160:161], v5 offset:37120
  ds_read_b64_tr_b16 a[162:163], v5 offset:38272
  s_waitcnt lgkmcnt(10)
  v_mfma_f32_16x16x32_bf16 v[208:211], a[136:139], a[172:175], 0
  v_mfma_f32_16x16x32_bf16 v[212:215], a[140:143], a[172:175], 0
  s_waitcnt lgkmcnt(8)
  v_mfma_f32_16x16x32_bf16 v[216:219], a[136:139], a[176:179], 0
  v_mfma_f32_16x16x32_bf16 v[220:223], a[140:143], a[176:179], 0
  s_waitcnt lgkmcnt(6)
  v_mfma_f32_16x16x32_bf16 v[224:227], a[136:139], a[180:183], 0
  v_mfma_f32_16x16x32_bf16 v[228:231], a[140:143], a[180:183], 0
  s_waitcnt lgkmcnt(4)
  v_mfma_f32_16x16x32_bf16 v[232:235], a[136:139], a[152:155], 0
  v_mfma_f32_16x16x32_bf16 v[236:239], a[140:143], a[152:155], 0
  s_waitcnt lgkmcnt(2)
  v_mfma_f32_16x16x32_bf16 v[240:243], a[136:139], a[156:159], 0
  v_mfma_f32_16x16x32_bf16 v[244:247], a[140:143], a[156:159], 0
  s_waitcnt lgkmcnt(0)
  v_mfma_f32_16x16x32_bf16 v[248:251], a[136:139], a[160:163], 0
  v_mfma_f32_16x16x32_bf16 v[252:255], a[140:143], a[160:163], 0
  ds_read_b128 a[144:147], v4 offset:0
  ds_read_b128 a[148:151], v4 offset:2048
  ds_read_b64_tr_b16 a[152:153], v5 offset:9216
  ds_read_b64_tr_b16 a[154:155], v5 offset:10368
  ds_read_b64_tr_b16 a[156:157], v5 offset:9248
  ds_read_b64_tr_b16 a[158:159], v5 offset:10400
  ds_read_b64_tr_b16 a[160:161], v5 offset:9280
  ds_read_b64_tr_b16 a[162:163], v5 offset:10432
  ds_read_b64_tr_b16 a[164:165], v5 offset:9312
  ds_read_b64_tr_b16 a[166:167], v5 offset:10464
  ds_read_b64_tr_b16 a[168:169], v5 offset:9344
  ds_read_b64_tr_b16 a[170:171], v5 offset:10496
  ds_read_b64_tr_b16 a[172:173], v5 offset:9376
  ds_read_b64_tr_b16 a[174:175], v5 offset:10528
  s_waitcnt lgkmcnt(10)
  v_mfma_f32_16x16x32_bf16 v[40:43], a[152:155], a[144:147], v[40:43]
  v_mfma_f32_16x16x32_bf16 v[44:47], a[152:155], a[148:151], v[44:47]
  ds_read_b64_tr_b16 a[176:177], v5 offset:9408
  ds_read_b64_tr_b16 a[178:179], v5 offset:10560
  s_waitcnt lgkmcnt(10)
  v_mfma_f32_16x16x32_bf16 v[48:51], a[156:159], a[144:147], v[48:51]
  v_mfma_f32_16x16x32_bf16 v[52:55], a[156:159], a[148:151], v[52:55]
  ds_read_b64_tr_b16 a[180:181], v5 offset:9440
  ds_read_b64_tr_b16 a[182:183], v5 offset:10592
  s_waitcnt lgkmcnt(10)
  v_mfma_f32_16x16x32_bf16 v[56:59], a[160:163], a[144:147], v[56:59]
  v_mfma_f32_16x16x32_bf16 v[60:63], a[160:163], a[148:151], v[60:63]
  ds_read_b64_tr_b16 a[152:153], v5 offset:9472
  ds_read_b64_tr_b16 a[154:155], v5 offset:10624
  s_waitcnt lgkmcnt(10)
  v_mfma_f32_16x16x32_bf16 v[64:67], a[164:167], a[144:147], v[64:67]
  v_mfma_f32_16x16x32_bf16 v[68:71], a[164:167], a[148:151], v[68:71]
  ds_read_b64_tr_b16 a[156:157], v5 offset:27648
  ds_read_b64_tr_b16 a[158:159], v5 offset:28800
  s_waitcnt lgkmcnt(10)
  v_mfma_f32_16x16x32_bf16 v[72:75], a[168:171], a[144:147], v[72:75]
  v_mfma_f32_16x16x32_bf16 v[76:79], a[168:171], a[148:151], v[76:79]
  ds_read_b64_tr_b16 a[160:161], v5 offset:27680
  ds_read_b64_tr_b16 a[162:163], v5 offset:28832
  s_waitcnt lgkmcnt(10)
  v_mfma_f32_16x16x32_bf16 v[80:83], a[172:175], a[144:147], v[80:83]
  v_mfma_f32_16x16x32_bf16 v[84:87], a[172:175], a[148:151], v[84:87]
  ds_read_b64_tr_b16 a[164:165], v5 offset:27712
  ds_read_b64_tr_b16 a[166:167], v5 offset:28864
  s_waitcnt lgkmcnt(10)
  v_mfma_f32_16x16x32_bf16 v[88:91], a[176:179], a[144:147], v[88:91]
  v_mfma_f32_16x16x32_bf16 v[92:95], a[176:179], a[148:151], v[92:95]
  ds_read_b64_tr_b16 a[168:169], v5 offset:27744
  ds_read_b64_tr_b16 a[170:171], v5 offset:28896
  s_waitcnt lgkmcnt(10)
  v_mfma_f32_16x16x32_bf16 v[96:99], a[180:183], a[144:147], v[96:99]
  v_mfma_f32_16x16x32_bf16 v[100:103], a[180:183], a[148:151], v[100:103]
  ds_read_b64_tr_b16 a[172:173], v5 offset:27776
  ds_read_b64_tr_b16 a[174:175], v5 offset:28928
  s_waitcnt lgkmcnt(10)
  v_mfma_f32_16x16x32_bf16 v[104:107], a[152:155], a[144:147], v[104:107]
  v_mfma_f32_16x16x32_bf16 v[108:111], a[152:155], a[148:151], v[108:111]
  ds_read_b64_tr_b16 a[176:177], v5 offset:27808
  ds_read_b64_tr_b16 a[178:179], v5 offset:28960
  s_waitcnt lgkmcnt(10)
  v_mfma_f32_16x16x32_bf16 v[112:115], a[144:147], a[156:159], v[112:115]
  v_mfma_f32_16x16x32_bf16 v[116:119], a[148:151], a[156:159], v[116:119]
  ds_read_b64_tr_b16 a[180:181], v5 offset:27840
  ds_read_b64_tr_b16 a[182:183], v5 offset:28992
  s_waitcnt lgkmcnt(10)
  v_mfma_f32_16x16x32_bf16 v[120:123], a[144:147], a[160:163], v[120:123]
  v_mfma_f32_16x16x32_bf16 v[124:127], a[148:151], a[160:163], v[124:127]
  ds_read_b64_tr_b16 a[152:153], v5 offset:27872
  ds_read_b64_tr_b16 a[154:155], v5 offset:29024
  s_waitcnt lgkmcnt(10)
  v_mfma_f32_16x16x32_bf16 v[128:131], a[144:147], a[164:167], v[128:131]
  v_mfma_f32_16x16x32_bf16 v[132:135], a[148:151], a[164:167], v[132:135]
  ds_read_b64_tr_b16 a[156:157], v5 offset:27904
  ds_read_b64_tr_b16 a[158:159], v5 offset:29056
  s_waitcnt lgkmcnt(10)
  v_mfma_f32_16x16x32_bf16 v[136:139], a[144:147], a[168:171], v[136:139]
  v_mfma_f32_16x16x32_bf16 v[140:143], a[148:151], a[168:171], v[140:143]
  ds_read_b64_tr_b16 a[160:161], v5 offset:46080
  ds_read_b64_tr_b16 a[162:163], v5 offset:47232
  s_waitcnt lgkmcnt(10)
  v_mfma_f32_16x16x32_bf16 v[144:147], a[144:147], a[172:175], v[144:147]
  v_mfma_f32_16x16x32_bf16 v[148:151], a[148:151], a[172:175], v[148:151]
  ds_read_b64_tr_b16 a[164:165], v5 offset:46112
  ds_read_b64_tr_b16 a[166:167], v5 offset:47264
  s_waitcnt lgkmcnt(10)
  v_mfma_f32_16x16x32_bf16 v[152:155], a[144:147], a[176:179], v[152:155]
  v_mfma_f32_16x16x32_bf16 v[156:159], a[148:151], a[176:179], v[156:159]
  ds_read_b64_tr_b16 a[168:169], v5 offset:46144
  ds_read_b64_tr_b16 a[170:171], v5 offset:47296
  s_waitcnt lgkmcnt(10)
  v_mfma_f32_16x16x32_bf16 v[160:163], a[144:147], a[180:183], v[160:163]
  v_mfma_f32_16x16x32_bf16 v[164:167], a[148:151], a[180:183], v[164:167]
  ds_read_b64_tr_b16 a[172:173], v5 offset:46176
  ds_read_b64_tr_b16 a[174:175], v5 offset:47328
  s_waitcnt lgkmcnt(10)
  v_mfma_f32_16x16x32_bf16 v[168:171], a[144:147], a[152:155], v[168:171]
  v_mfma_f32_16x16x32_bf16 v[172:175], a[148:151], a[152:155], v[172:175]
  ds_read_b64_tr_b16 a[176:177], v5 offset:46208
  ds_read_b64_tr_b16 a[178:179], v5 offset:47360
  s_waitcnt lgkmcnt(10)
  v_mfma_f32_16x16x32_bf16 v[176:179], a[144:147], a[156:159], v[176:179]
  v_mfma_f32_16x16x32_bf16 v[180:183], a[148:151], a[156:159], v[180:183]
  ds_read_b64_tr_b16 a[180:181], v5 offset:46240
  ds_read_b64_tr_b16 a[182:183], v5 offset:47392
  s_waitcnt lgkmcnt(10)
  v_mfma_f32_16x16x32_bf16 v[184:187], a[144:147], a[160:163], v[184:187]
  v_mfma_f32_16x16x32_bf16 v[188:191], a[148:151], a[160:163], v[188:191]
  ds_read_b64_tr_b16 a[152:153], v5 offset:46272
  ds_read_b64_tr_b16 a[154:155], v5 offset:47424
  s_waitcnt lgkmcnt(10)
  v_mfma_f32_16x16x32_bf16 v[192:195], a[144:147], a[164:167], v[192:195]
  v_mfma_f32_16x16x32_bf16 v[196:199], a[148:151], a[164:167], v[196:199]
  ds_read_b64_tr_b16 a[156:157], v5 offset:46304
  ds_read_b64_tr_b16 a[158:159], v5 offset:47456
  s_waitcnt lgkmcnt(10)
  v_mfma_f32_16x16x32_bf16 v[200:203], a[144:147], a[168:171], v[200:203]
  v_mfma_f32_16x16x32_bf16 v[204:207], a[148:151], a[168:171], v[204:207]
  ds_read_b64_tr_b16 a[160:161], v5 offset:46336
  ds_read_b64_tr_b16 a[162:163], v5 offset:47488
  s_waitcnt lgkmcnt(10)
  v_mfma_f32_16x16x32_bf16 v[208:211], a[144:147], a[172:175], v[208:211]
  v_mfma_f32_16x16x32_bf16 v[212:215], a[148:151], a[172:175], v[212:215]
  s_waitcnt lgkmcnt(8)
  v_mfma_f32_16x16x32_bf16 v[216:219], a[144:147], a[176:179], v[216:219]
  v_mfma_f32_16x16x32_bf16 v[220:223], a[148:151], a[176:179], v[220:223]
  s_waitcnt lgkmcnt(6)
  v_mfma_f32_16x16x32_bf16 v[224:227], a[144:147], a[180:183], v[224:227]
  v_mfma_f32_16x16x32_bf16 v[228:231], a[148:151], a[180:183], v[228:231]
  s_waitcnt lgkmcnt(4)
  v_mfma_f32_16x16x32_bf16 v[232:235], a[144:147], a[152:155], v[232:235]
  v_mfma_f32_16x16x32_bf16 v[236:239], a[148:151], a[152:155], v[236:239]
  s_waitcnt lgkmcnt(2)
  v_mfma_f32_16x16x32_bf16 v[240:243], a[144:147], a[156:159], v[240:243]
  v_mfma_f32_16x16x32_bf16 v[244:247], a[148:151], a[156:159], v[244:247]
  s_waitcnt lgkmcnt(0)
  v_mfma_f32_16x16x32_bf16 v[248:251], a[144:147], a[160:163], v[248:251]
  v_mfma_f32_16x16x32_bf16 v[252:255], a[148:151], a[160:163], v[252:255]
  s_mov_b32 s44, 1
  s_mov_b32 s46, 71680
B1_KL:
  v_add_u32 v3, s46, v3
  v_add_u32 v4, s46, v4
  v_add_u32 v5, s46, v5
  s_sub_u32 s46, 0, s46
  s_sub_u32 s40, 71680, s40
  s_add_u32 s41, s41, 64
  s_waitcnt vmcnt(0) lgkmcnt(0)
  s_barrier
  s_cmp_lt_u32 s41, 576
  s_cbranch_scc0 B1_NODMA
  s_lshl_b32 s32, s28, 12
  s_add_u32 s32, s32, s40
  s_lshl_b32 s33, s41, 1
  s_add_u32 s33, s33, s42
  s_add_u32 m0, s32, 0
  s_nop 0
  buffer_load_dwordx4 v2, s[8:11], s33 offen lds
  s_add_u32 s33, s33, 9216
  s_add_u32 m0, s32, 1024
  s_nop 0
  buffer_load_dwordx4 v2, s[8:11], s33 offen lds
  s_add_u32 s33, s33, 9216
  s_add_u32 m0, s32, 2048
  s_nop 0
  buffer_load_dwordx4 v2, s[8:11], s33 offen lds
  s_add_u32 s33, s33, 9216
  s_add_u32 m0, s32, 3072
  s_nop 0
  buffer_load_dwordx4 v2, s[8:11], s33 offen lds
  s_lshl_b32 s32, s28, 10
  s_add_u32 s32, s32, s40
  s_mul_i32 s33, s41, 3456
  s_add_u32 s33, s33, s43
  s_add_u32 m0, s32, 16384
  s_nop 0
  buffer_load_dwordx4 v7, s[12:15], s33 offen lds
  s_add_u32 m0, s32, 20480
  s_nop 0
  buffer_load_dwordx4 v8, s[12:15], s33 offen lds
  s_add_u32 m0, s32, 24576
  s_nop 0
  buffer_load_dwordx4 v9, s[12:15], s33 offen lds
  s_add_u32 m0, s32, 28672
  s_nop 0
  buffer_load_dwordx4 v10, s[12:15], s33 offen lds
  s_cmp_lt_u32 s28, 2
  s_cbranch_scc0 B1c_m4_19
  s_add_u32 m0, s32, 32768
  s_nop 0
  buffer_load_dwordx4 v11, s[12:15], s33 offen lds
B1c_m4_19:
  s_add_u32 s33, s33, 1152
  s_add_u32 m0, s32, 34816
  s_nop 0
  buffer_load_dwordx4 v7, s[12:15], s33 offen lds
  s_add_u32 m0, s32, 38912
  s_nop 0
  buffer_load_dwordx4 v8, s[12:15], s33 offen lds
  s_add_u32 m0, s32, 43008
  s_nop 0
  buffer_load_dwordx4 v9, s[12:15], s33 offen lds
  s_add_u32 m0, s32, 47104
  s_nop 0
  buffer_load_dwordx4 v10, s[12:15], s33 offen lds
  s_cmp_lt_u32 s28, 2
  s_cbranch_scc0 B1c_m4_20
  s_add_u32 m0, s32, 51200
  s_nop 0
  buffer_load_dwordx4 v11, s[12:15], s33 offen lds
B1c_m4_20:
  s_add_u32 s33, s33, 1152
  s_add_u32 m0, s32, 53248
  s_nop 0
  buffer_load_dwordx4 v7, s[12:15], s33 offen lds
  s_add_u32 m0, s32, 57344
  s_nop 0
  buffer_load_dwordx4 v8, s[12:15], s33 offen lds
  s_add_u32 m0, s32, 61440
  s_nop 0
  buffer_load_dwordx4 v9, s[12:15], s33 offen lds
  s_add_u32 m0, s32, 65536
  s_nop 0
  buffer_load_dwordx4 v10, s[12:15], s33 offen lds
  s_cmp_lt_u32 s28, 2
  s_cbranch_scc0 B1c_m4_21
  s_add_u32 m0, s32, 69632
  s_nop 0
  buffer_load_dwordx4 v11, s[12:15], s33 offen lds
B1c_m4_21:
B1_NODMA:
  ds_read_b128 a[136:139], v3 offset:0
  ds_read_b128 a[140:143], v3 offset:2048
  ds_read_b64_tr_b16 a[152:153], v5 offset:0
  ds_read_b64_tr_b16 a[154:155], v5 offset:1152
  ds_read_b64_tr_b16 a[156:157], v5 offset:32
  ds_read_b64_tr_b16 a[158:159], v5 offset:1184
  ds_read_b64_tr_b16 a[160:161], v5 offset:64
  ds_read_b64_tr_b16 a[162:163], v5 offset:1216
  ds_read_b64_tr_b16 a[164:165], v5 offset:96
  ds_read_b64_tr_b16 a[166:167], v5 offset:1248
  ds_read_b64_tr_b16 a[168:169], v5 offset:128
  ds_read_b64_tr_b16 a[170:171], v5 offset:1280
  ds_read_b64_tr_b16 a[172:173], v5 offset:160
  ds_read_b64_tr_b16 a[174:175], v5 offset:1312
  s_waitcnt lgkmcnt(10)
  v_mfma_f32_16x16x32_bf16 v[40:43], a[152:155], a[136:139], v[40:43]
  v_mfma_f32_16x16x32_bf16 v[44:47], a[152:155], a[140:143], v[44:47]
  ds_read_b64_tr_b16 a[176:177], v5 offset:192
  ds_read_b64_tr_b16 a[178:179], v5 offset:1344
  s_waitcnt lgkmcnt(10)
  v_mfma_f32_16x16x32_bf16 v[48:51], a[156:159], a[136:139], v[48:51]
  v_mfma_f32_16x16x32_bf16 v[52:55], a[156:159], a[140:143], v[52:55]
  ds_read_b64_tr_b16 a[180:181], v5 offset:224
  ds_read_b64_tr_b16 a[182:183], v5 offset:1376
  s_waitcnt lgkmcnt(10)
  v_mfma_f32_16x16x32_bf16 v[56:59], a[160:163], a[136:139], v[56:59]
  v_mfma_f32_16x16x32_bf16 v[60:63], a[160:163], a[140:143], v[60:63]
  ds_read_b64_tr_b16 a[152:153], v5 offset:256
  ds_read_b64_tr_b16 a[154:155], v5 offset:1408
  s_waitcnt lgkmcnt(10)
  v_mfma_f32_16x16x32_bf16 v[64:67], a[164:167], a[136:139], v[64:67]
  v_mfma_f32_16x16x32_bf16 v[68:71], a[164:167], a[140:143], v[68:71]
  ds_read_b64_tr_b16 a[156:157], v5 offset:18432
  ds_read_b64_tr_b16 a[158:159], v5 offset:19584
  s_waitcnt lgkmcnt(10)
  v_mfma_f32_16x16x32_bf16 v[72:75], a[168:171], a[136:139], v[72:75]
  v_mfma_f32_16x16x32_bf16 v[76:79], a[168:171], a[140:143], v[76:79]
  ds_read_b64_tr_b16 a[160:161], v5 offset:18464
  ds_read_b64_tr_b16 a[162:163], v5 offset:19616
  s_waitcnt lgkmcnt(10)
  v_mfma_f32_16x16x32_bf16 v[80:83], a[172:175], a[136:139], v[80:83]
  v_mfma_f32_16x16x32_bf16 v[84:87], a[172:175], a[140:143], v[84:87]
  ds_read_b64_tr_b16 a[164:165], v5 offset:18496
  ds_read_b64_tr_b16 a[166:167], v5 offset:19648
  s_waitcnt lgkmcnt(10)
  v_mfma_f32_16x16x32_bf16 v[88:91], a[176:179], a[136:139], v[88:91]
  v_mfma_f32_16x16x32_bf16 v[92:95], a[176:179], a[140:143], v[92:95]
  ds_read_b64_tr_b16 a[168:169], v5 offset:18528
  ds_read_b64_tr_b16 a[170:171], v5 offset:19680
  s_waitcnt lgkmcnt(10)
  v_mfma_f32_16x16x32_bf16 v[96:99], a[180:183], a[136:139], v[96:99]
  v_mfma_f32_16x16x32_bf16 v[100:103], a[180:183], a[140:143], v[100:103]
  ds_read_b64_tr_b16 a[172:173], v5 offset:18560
  ds_read_b64_tr_b16 a[174:175], v5 offset:19712
  s_waitcnt lgkmcnt(10)
  v_mfma_f32_16x16x32_bf16 v[104:107], a[152:155], a[136:139], v[104:107]
  v_mfma_f32_16x16x32_bf16 v[108:111], a[152:155], a[140:143], v[108:111]
  ds_read_b64_tr_b16 a[176:177], v5 offset:18592
  ds_read_b64_tr_b16 a[178:179], v5 offset:19744
  s_waitcnt lgkmcnt(10)
  v_mfma_f32_16x16x32_bf16 v[112:115], a[136:139], a[156:159], v[112:115]
  v_mfma_f32_16x16x32_bf16 v[116:119], a[140:143], a[156:159], v[116:119]
  ds_read_b64_tr_b16 a[180:181], v5 offset:18624
  ds_read_b64_tr_b16 a[182:183], v5 offset:19776
  s_waitcnt lgkmcnt(10)
  v_mfma_f32_16x16x32_bf16 v[120:123], a[136:139], a[160:163], v[120:123]
  v_mfma_f32_16x16x32_bf16 v[124:127], a[140:143], a[160:163], v[124:127]
  ds_read_b64_tr_b16 a[152:153], v5 offset:18656
  ds_read_b64_tr_b16 a[154:155], v5 offset:19808
  s_waitcnt lgkmcnt(10)
  v_mfma_f32_16x16x32_bf16 v[128:131], a[136:139], a[164:167], v[128:131]
  v_mfma_f32_16x16x32_bf16 v[132:135], a[140:143], a[164:167], v[132:135]
  ds_read_b64_tr_b16 a[156:157], v5 offset:18688
  ds_read_b64_tr_b16 a[158:159], v5 offset:19840
  s_waitcnt lgkmcnt(10)
  v_mfma_f32_16x16x32_bf16 v[136:139], a[136:139], a[168:171], v[136:139]
  v_mfma_f32_16x16x32_bf16 v[140:143], a[140:143], a[168:171], v[140:143]
  ds_read_b64_tr_b16 a[160:161], v5 offset:36864
  ds_read_b64_tr_b16 a[162:163], v5 offset:38016
  s_waitcnt lgkmcnt(10)
  v_mfma_f32_16x16x32_bf16 v[144:147], a[136:139], a[172:175], v[144:147]
  v_mfma_f32_16x16x32_bf16 v[148:151], a[140:143], a[172:175], v[148:151]
  ds_read_b64_tr_b16 a[164:165], v5 offset:36896
  ds_read_b64_tr_b16 a[166:167], v5 offset:38048
  s_waitcnt lgkmcnt(10)
  v_mfma_f32_16x16x32_bf16 v[152:155], a[136:139], a[176:179], v[152:155]
  v_mfma_f32_16x16x32_bf16 v[156:159], a[140:143], a[176:179], v[156:159]
  ds_read_b64_tr_b16 a[168:169], v5 offset:36928
  ds_read_b64_tr_b16 a[170:171], v5 offset:38080
  s_waitcnt lgkmcnt(10)
  v_mfma_f32_16x16x32_bf16 v[160:163], a[136:139], a[180:183], v[160:163]
  v_mfma_f32_16x16x32_bf16 v[164:167], a[140:143], a[180:183], v[164:167]
  ds_read_b64_tr_b16 a[172:173], v5 offset:36960
  ds_read_b64_tr_b16 a[174:175], v5 offset:38112
  s_waitcnt lgkmcnt(10)
  v_mfma_f32_16x16x32_bf16 v[168:171], a[136:139], a[152:155], v[168:171]
  v_mfma_f32_16x16x32_bf16 v[172:175], a[140:143], a[152:155], v[172:175]
  ds_read_b64_tr_b16 a[176:177], v5 offset:36992
  ds_read_b64_tr_b16 a[178:179], v5 offset:38144
  s_waitcnt lgkmcnt(10)
  v_mfma_f32_16x16x32_bf16 v[176:179], a[136:139], a[156:159], v[176:179]
  v_mfma_f32_16x16x32_bf16 v[180:183], a[140:143], a[156:159], v[180:183]
  ds_read_b64_tr_b16 a[180:181], v5 offset:37024
  ds_read_b64_tr_b16 a[182:183], v5 offset:38176
  s_waitcnt lgkmcnt(10)
  v_mfma_f32_16x16x32_bf16 v[184:187], a[136:139], a[160:163], v[184:187]
  v_mfma_f32_16x16x32_bf16 v[188:191], a[140:143], a[160:163], v[188:191]
  ds_read_b64_tr_b16 a[152:153], v5 offset:37056
  ds_read_b64_tr_b16 a[154:155], v5 offset:38208
  s_waitcnt lgkmcnt(10)
  v_mfma_f32_16x16x32_bf16 v[192:195], a[136:139], a[164:167], v[192:195]
  v_mfma_f32_16x16x32_bf16 v[196:199], a[140:143], a[164:167], v[196:199]
  ds_read_b64_tr_b16 a[156:157], v5 offset:37088
  ds_read_b64_tr_b16 a[158:159], v5 offset:38240
  s_waitcnt lgkmcnt(10)
  v_mfma_f32_16x16x32_bf16 v[200:203], a[136:139], a[168:171], v[200:203]
  v_mfma_f32_16x16x32_bf16 v[204:207], a[140:143], a[168:171], v[204:207]
  ds_read_b64_tr_b16 a[160:161], v5 offset:37120
  ds_read_b64_tr_b16 a[162:163], v5 offset:38272
  s_waitcnt lgkmcnt(10)
  v_mfma_f32_16x16x32_bf16 v[208:211], a[136:139], a[172:175], v[208:211]
  v_mfma_f32_16x16x32_bf16 v[212:215], a[140:143], a[172:175], v[212:215]
  s_waitcnt lgkmcnt(8)
  v_mfma_f32_16x16x32_bf16 v[216:219], a[136:139], a[176:179], v[216:219]
  v_mfma_f32_16x16x32_bf16 v[220:223], a[140:143], a[176:179], v[220:223]
  s_waitcnt lgkmcnt(6)
  v_mfma_f32_16x16x32_bf16 v[224:227], a[136:139], a[180:183], v[224:227]
  v_mfma_f32_16x16x32_bf16 v[228:231], a[140:143], a[180:183], v[228:231]
  s_waitcnt lgkmcnt(4)
  v_mfma_f32_16x16x32_bf16 v[232:235], a[136:139], a[152:155], v[232:235]
  v_mfma_f32_16x16x32_bf16 v[236:239], a[140:143], a[152:155], v[236:239]
  s_waitcnt lgkmcnt(2)
  v_mfma_f32_16x16x32_bf16 v[240:243], a[136:139], a[156:159], v[240:243]
  v_mfma_f32_16x16x32_bf16 v[244:247], a[140:143], a[156:159], v[244:247]
  s_waitcnt lgkmcnt(0)
  v_mfma_f32_16x16x32_bf16 v[248:251], a[136:139], a[160:163], v[248:251]
  v_mfma_f32_16x16x32_bf16 v[252:255], a[140:143], a[160:163], v[252:255]
  ds_read_b128 a[144:147], v4 offset:0
  ds_read_b128 a[148:151], v4 offset:2048
  ds_read_b64_tr_b16 a[152:153], v5 offset:9216
  ds_read_b64_tr_b16 a[154:155], v5 offset:10368
  ds_read_b64_tr_b16 a[156:157], v5 offset:9248
  ds_read_b64_tr_b16 a[158:159], v5 offset:10400
  ds_read_b64_tr_b16 a[160:161], v5 offset:9280
  ds_read_b64_tr_b16 a[162:163], v5 offset:10432
  ds_read_b64_tr_b16 a[164:165], v5 offset:9312
  ds_read_b64_tr_b16 a[166:167], v5 offset:10464
  ds_read_b64_tr_b16 a[168:169], v5 offset:9344
  ds_read_b64_tr_b16 a[170:171], v5 offset:10496
  ds_read_b64_tr_b16 a[172:173], v5 offset:9376
  ds_read_b64_tr_b16 a[174:175], v5 offset:10528
  s_waitcnt lgkmcnt(10)
  v_mfma_f32_16x16x32_bf16 v[40:43], a[152:155], a[144:147], v[40:43]
  v_mfma_f32_16x16x32_bf16 v[44:47], a[152:155], a[148:151], v[44:47]
  ds_read_b64_tr_b16 a[176:177], v5 offset:9408
  ds_read_b64_tr_b16 a[178:179], v5 offset:10560
  s_waitcnt lgkmcnt(10)
  v_mfma_f32_16x16x32_bf16 v[48:51], a[156:159], a[144:147], v[48:51]
  v_mfma_f32_16x16x32_bf16 v[52:55], a[156:159], a[148:151], v[52:55]
  ds_read_b64_tr_b16 a[180:181], v5 offset:9440
  ds_read_b64_tr_b16 a[182:183], v5 offset:10592
  s_waitcnt lgkmcnt(10)
  v_mfma_f32_16x16x32_bf16 v[56:59], a[160:163], a[144:147], v[56:59]
  v_mfma_f32_16x16x32_bf16 v[60:63], a[160:163], a[148:151], v[60:63]
  ds_read_b64_tr_b16 a[152:153], v5 offset:9472
  ds_read_b64_tr_b16 a[154:155], v5 offset:10624
  s_waitcnt lgkmcnt(10)
  v_mfma_f32_16x16x32_bf16 v[64:67], a[164:167], a[144:147], v[64:67]
  v_mfma_f32_16x16x32_bf16 v[68:71], a[164:167], a[148:151], v[68:71]
  ds_read_b64_tr_b16 a[156:157], v5 offset:27648
  ds_read_b64_tr_b16 a[158:159], v5 offset:28800
  s_waitcnt lgkmcnt(10)
  v_mfma_f32_16x16x32_bf16 v[72:75], a[168:171], a[144:147], v[72:75]
  v_mfma_f32_16x16x32_bf16 v[76:79], a[168:171], a[148:151], v[76:79]
  ds_read_b64_tr_b16 a[160:161], v5 offset:27680
  ds_read_b64_tr_b16 a[162:163], v5 offset:28832
  s_waitcnt lgkmcnt(10)
  v_mfma_f32_16x16x32_bf16 v[80:83], a[172:175], a[144:147], v[80:83]
  v_mfma_f32_16x16x32_bf16 v[84:87], a[172:175], a[148:151], v[84:87]
  ds_read_b64_tr_b16 a[164:165], v5 offset:27712
  ds_read_b64_tr_b16 a[166:167], v5 offset:28864
  s_waitcnt lgkmcnt(10)
  v_mfma_f32_16x16x32_bf16 v[88:91], a[176:179], a[144:147], v[88:91]
  v_mfma_f32_16x16x32_bf16 v[92:95], a[176:179], a[148:151], v[92:95]
  ds_read_b64_tr_b16 a[168:169], v5 offset:27744
  ds_read_b64_tr_b16 a[170:171], v5 offset:28896
  s_waitcnt lgkmcnt(10)
  v_mfma_f32_16x16x32_bf16 v[96:99], a[180:183], a[144:147], v[96:99]
  v_mfma_f32_16x16x32_bf16 v[100:103], a[180:183], a[148:151], v[100:103]
  ds_read_b64_tr_b16 a[172:173], v5 offset:27776
  ds_read_b64_tr_b16 a[174:175], v5 offset:28928
  s_waitcnt lgkmcnt(10)
  v_mfma_f32_16x16x32_bf16 v[104:107], a[152:155], a[144:147], v[104:107]
  v_mfma_f32_16x16x32_bf16 v[108:111], a[152:155], a[148:151], v[108:111]
  ds_read_b64_tr_b16 a[176:177], v5 offset:27808
  ds_read_b64_tr_b16 a[178:179], v5 offset:28960
  s_waitcnt lgkmcnt(10)
  v_mfma_f32_16x16x32_bf16 v[112:115], a[144:147], a[156:159], v[112:115]
  v_mfma_f32_16x16x32_bf16 v[116:119], a[148:151], a[156:159], v[116:119]
  ds_read_b64_tr_b16 a[180:181], v5 offset:27840
  ds_read_b64_tr_b16 a[182:183], v5 offset:28992
  s_waitcnt lgkmcnt(10)
  v_mfma_f32_16x16x32_bf16 v[120:123], a[144:147], a[160:163], v[120:123]
  v_mfma_f32_16x16x32_bf16 v[124:127], a[148:151], a[160:163], v[124:127]
  ds_read_b64_tr_b16 a[152:153], v5 offset:27872
  ds_read_b64_tr_b16 a[154:155], v5 offset:29024
  s_waitcnt lgkmcnt(10)
  v_mfma_f32_16x16x32_bf16 v[128:131], a[144:147], a[164:167], v[128:131]
  v_mfma_f32_16x16x32_bf16 v[132:135], a[148:151], a[164:167], v[132:135]
  ds_read_b64_tr_b16 a[156:157], v5 offset:27904
  ds_read_b64_tr_b16 a[158:159], v5 offset:29056
  s_waitcnt lgkmcnt(10)
  v_mfma_f32_16x16x32_bf16 v[136:139], a[144:147], a[168:171], v[136:139]
  v_mfma_f32_16x16x32_bf16 v[140:143], a[148:151], a[168:171], v[140:143]
  ds_read_b64_tr_b16 a[160:161], v5 offset:46080
  ds_read_b64_tr_b16 a[162:163], v5 offset:47232
  s_waitcnt lgkmcnt(10)
  v_mfma_f32_16x16x32_bf16 v[144:147], a[144:147], a[172:175], v[144:147]
  v_mfma_f32_16x16x32_bf16 v[148:151], a[148:151], a[172:175], v[148:151]
  ds_read_b64_tr_b16 a[164:165], v5 offset:46112
  ds_read_b64_tr_b16 a[166:167], v5 offset:47264
  s_waitcnt lgkmcnt(10)
  v_mfma_f32_16x16x32_bf16 v[152:155], a[144:147], a[176:179], v[152:155]
  v_mfma_f32_16x16x32_bf16 v[156:159], a[148:151], a[176:179], v[156:159]
  ds_read_b64_tr_b16 a[168:169], v5 offset:46144
  ds_read_b64_tr_b16 a[170:171], v5 offset:47296
  s_waitcnt lgkmcnt(10)
  v_mfma_f32_16x16x32_bf16 v[160:163], a[144:147], a[180:183], v[160:163]
  v_mfma_f32_16x16x32_bf16 v[164:167], a[148:151], a[180:183], v[164:167]
  ds_read_b64_tr_b16 a[172:173], v5 offset:46176
  ds_read_b64_tr_b16 a[174:175], v5 offset:47328
  s_waitcnt lgkmcnt(10)
  v_mfma_f32_16x16x32_bf16 v[168:171], a[144:147], a[152:155], v[168:171]
  v_mfma_f32_16x16x32_bf16 v[172:175], a[148:151], a[152:155], v[172:175]
  ds_read_b64_tr_b16 a[176:177], v5 offset:46208
  ds_read_b64_tr_b16 a[178:179], v5 offset:47360
  s_waitcnt lgkmcnt(10)
  v_mfma_f32_16x16x32_bf16 v[176:179], a[144:147], a[156:159], v[176:179]
  v_mfma_f32_16x16x32_bf16 v[180:183], a[148:151], a[156:159], v[180:183]
  ds_read_b64_tr_b16 a[180:181], v5 offset:46240
  ds_read_b64_tr_b16 a[182:183], v5 offset:47392
  s_waitcnt lgkmcnt(10)
  v_mfma_f32_16x16x32_bf16 v[184:187], a[144:147], a[160:163], v[184:187]
  v_mfma_f32_16x16x32_bf16 v[188:191], a[148:151], a[160:163], v[188:191]
  ds_read_b64_tr_b16 a[152:153], v5 offset:46272
  ds_read_b64_tr_b16 a[154:155], v5 offset:47424
  s_waitcnt lgkmcnt(10)
  v_mfma_f32_16x16x32_bf16 v[192:195], a[144:147], a[164:167], v[192:195]
  v_mfma_f32_16x16x32_bf16 v[196:199], a[148:151], a[164:167], v[196:199]
  ds_read_b64_tr_b16 a[156:157], v5 offset:46304
  ds_read_b64_tr_b16 a[158:159], v5 offset:47456
  s_waitcnt lgkmcnt(10)
  v_mfma_f32_16x16x32_bf16 v[200:203], a[144:147], a[168:171], v[200:203]
  v_mfma_f32_16x16x32_bf16 v[204:207], a[148:151], a[168:171], v[204:207]
  ds_read_b64_tr_b16 a[160:161], v5 offset:46336
  ds_read_b64_tr_b16 a[162:163], v5 offset:47488
  s_waitcnt lgkmcnt(10)
  v_mfma_f32_16x16x32_bf16 v[208:211], a[144:147], a[172:175], v[208:211]
  v_mfma_f32_16x16x32_bf16 v[212:215], a[148:151], a[172:175], v[212:215]
  s_waitcnt lgkmcnt(8)
  v_mfma_f32_16x16x32_bf16 v[216:219], a[144:147], a[176:179], v[216:219]
  v_mfma_f32_16x16x32_bf16 v[220:223], a[148:151], a[176:179], v[220:223]
  s_waitcnt lgkmcnt(6)
  v_mfma_f32_16x16x32_bf16 v[224:227], a[144:147], a[180:183], v[224:227]
  v_mfma_f32_16x16x32_bf16 v[228:231], a[148:151], a[180:183], v[228:231]
  s_waitcnt lgkmcnt(4)
  v_mfma_f32_16x16x32_bf16 v[232:235], a[144:147], a[152:155], v[232:235]
  v_mfma_f32_16x16x32_bf16 v[236:239], a[148:151], a[152:155], v[236:239]
  s_waitcnt lgkmcnt(2)
  v_mfma_f32_16x16x32_bf16 v[240:243], a[144:147], a[156:159], v[240:243]
  v_mfma_f32_16x16x32_bf16 v[244:247], a[148:151], a[156:159], v[244:247]
  s_waitcnt lgkmcnt(0)
  v_mfma_f32_16x16x32_bf16 v[248:251], a[144:147], a[160:163], v[248:251]
  v_mfma_f32_16x16x32_bf16 v[252:255], a[148:151], a[160:163], v[252:255]
  s_add_u32 s44, s44, 1
  s_cmp_lt_u32 s44, 9
  s_cbranch_scc1 B1_KL
  s_lshl_b32 s32, s31, 3
  s_lshl_b32 s33, s28, 1
  s_add_u32 s32, s32, s33
  s_mul_i32 s32, s32, 18432
  s_mul_i32 s33, s29, 4608
  s_add_u32 s32, s32, s33
  s_add_u32 s32, s32, 83886080
  s_add_u32 s33, s32, 18432
  v_cvt_pk_bf16_f32 v12, v40, v41
  v_cvt_pk_bf16_f32 v13, v42, v43
  v_lshlrev_b32 v40, 16, v12
  v_and_b32 v41, 0xffff0000, v12
  v_lshlrev_b32 v42, 16, v13
  v_and_b32 v43, 0xffff0000, v13
  v_mul_f32 v12, 0x3fb8aa3b, v40
  v_mul_f32 v13, 0x3fb8aa3b, v41
  v_mul_f32 v14, 0x3fb8aa3b, v42
  v_mul_f32 v15, 0x3fb8aa3b, v43
  v_exp_f32 v12, v12
  v_exp_f32 v13, v13
  v_exp_f32 v14, v14
  v_exp_f32 v15, v15
  v_cmp_lt_f32 vcc, 0, v40
  v_add_f32 v40, 1.0, v40
  s_nop 0
  v_cndmask_b32 v40, v12, v40, vcc
  v_cmp_lt_f32 vcc, 0, v41
  v_add_f32 v41, 1.0, v41
  s_nop 0
  v_cndmask_b32 v41, v13, v41, vcc
  v_cmp_lt_f32 vcc, 0, v42
  v_add_f32 v42, 1.0, v42
  s_nop 0
  v_cndmask_b32 v42, v14, v42, vcc
  v_cmp_lt_f32 vcc, 0, v43
  v_add_f32 v43, 1.0, v43
  s_nop 0
  v_cndmask_b32 v43, v15, v43, vcc
  v_cvt_pk_bf16_f32 v12, v40, v41
  v_cvt_pk_bf16_f32 v13, v42, v43
  v_lshlrev_b32 v40, 16, v12
  v_and_b32 v41, 0xffff0000, v12
  v_lshlrev_b32 v42, 16, v13
  v_and_b32 v43, 0xffff0000, v13
  v_add_f32 v40, 0x358637bd, v40
  v_add_f32 v41, 0x358637bd, v41
  v_add_f32 v42, 0x358637bd, v42
  v_add_f32 v43, 0x358637bd, v43
  v_cvt_pk_bf16_f32 v40, v40, v41
  v_cvt_pk_bf16_f32 v41, v42, v43
  buffer_store_dwordx2 v[40:41], v6, s[16:19], s32 offen offset:0 sc1
  v_cvt_pk_bf16_f32 v12, v44, v45
  v_cvt_pk_bf16_f32 v13, v46, v47
  v_lshlrev_b32 v44, 16, v12
  v_and_b32 v45, 0xffff0000, v12
  v_lshlrev_b32 v46, 16, v13
  v_and_b32 v47, 0xffff0000, v13
  v_mul_f32 v12, 0x3fb8aa3b, v44
  v_mul_f32 v13, 0x3fb8aa3b, v45
  v_mul_f32 v14, 0x3fb8aa3b, v46
  v_mul_f32 v15, 0x3fb8aa3b, v47
  v_exp_f32 v12, v12
  v_exp_f32 v13, v13
  v_exp_f32 v14, v14
  v_exp_f32 v15, v15
  v_cmp_lt_f32 vcc, 0, v44
  v_add_f32 v44, 1.0, v44
  s_nop 0
  v_cndmask_b32 v44, v12, v44, vcc
  v_cmp_lt_f32 vcc, 0, v45
  v_add_f32 v45, 1.0, v45
  s_nop 0
  v_cndmask_b32 v45, v13, v45, vcc
  v_cmp_lt_f32 vcc, 0, v46
  v_add_f32 v46, 1.0, v46
  s_nop 0
  v_cndmask_b32 v46, v14, v46, vcc
  v_cmp_lt_f32 vcc, 0, v47
  v_add_f32 v47, 1.0, v47
  s_nop 0
  v_cndmask_b32 v47, v15, v47, vcc
  v_cvt_pk_bf16_f32 v12, v44, v45
  v_cvt_pk_bf16_f32 v13, v46, v47
  v_lshlrev_b32 v44, 16, v12
  v_and_b32 v45, 0xffff0000, v12
  v_lshlrev_b32 v46, 16, v13
  v_and_b32 v47, 0xffff0000, v13
  v_add_f32 v44, 0x358637bd, v44
  v_add_f32 v45, 0x358637bd, v45
  v_add_f32 v46, 0x358637bd, v46
  v_add_f32 v47, 0x358637bd, v47
  v_cvt_pk_bf16_f32 v44, v44, v45
  v_cvt_pk_bf16_f32 v45, v46, v47
  buffer_store_dwordx2 v[44:45], v6, s[16:19], s33 offen offset:0 sc1
  v_cvt_pk_bf16_f32 v12, v48, v49
  v_cvt_pk_bf16_f32 v13, v50, v51
  v_lshlrev_b32 v48, 16, v12
  v_and_b32 v49, 0xffff0000, v12
  v_lshlrev_b32 v50, 16, v13
  v_and_b32 v51, 0xffff0000, v13
  v_mul_f32 v12, 0x3fb8aa3b, v48
  v_mul_f32 v13, 0x3fb8aa3b, v49
  v_mul_f32 v14, 0x3fb8aa3b, v50
  v_mul_f32 v15, 0x3fb8aa3b, v51
  v_exp_f32 v12, v12
  v_exp_f32 v13, v13
  v_exp_f32 v14, v14
  v_exp_f32 v15, v15
  v_cmp_lt_f32 vcc, 0, v48
  v_add_f32 v48, 1.0, v48
  s_nop 0
  v_cndmask_b32 v48, v12, v48, vcc
  v_cmp_lt_f32 vcc, 0, v49
  v_add_f32 v49, 1.0, v49
  s_nop 0
  v_cndmask_b32 v49, v13, v49, vcc
  v_cmp_lt_f32 vcc, 0, v50
  v_add_f32 v50, 1.0, v50
  s_nop 0
  v_cndmask_b32 v50, v14, v50, vcc
  v_cmp_lt_f32 vcc, 0, v51
  v_add_f32 v51, 1.0, v51
  s_nop 0
  v_cndmask_b32 v51, v15, v51, vcc
  v_cvt_pk_bf16_f32 v12, v48, v49
  v_cvt_pk_bf16_f32 v13, v50, v51
  v_lshlrev_b32 v48, 16, v12
  v_and_b32 v49, 0xffff0000, v12
  v_lshlrev_b32 v50, 16, v13
  v_and_b32 v51, 0xffff0000, v13
  v_add_f32 v48, 0x358637bd, v48
  v_add_f32 v49, 0x358637bd, v49
  v_add_f32 v50, 0x358637bd, v50
  v_add_f32 v51, 0x358637bd, v51
  v_cvt_pk_bf16_f32 v48, v48, v49
  v_cvt_pk_bf16_f32 v49, v50, v51
  buffer_store_dwordx2 v[48:49], v6, s[16:19], s32 offen offset:512 sc1
  v_cvt_pk_bf16_f32 v12, v52, v53
  v_cvt_pk_bf16_f32 v13, v54, v55
  v_lshlrev_b32 v52, 16, v12
  v_and_b32 v53, 0xffff0000, v12
  v_lshlrev_b32 v54, 16, v13
  v_and_b32 v55, 0xffff0000, v13
  v_mul_f32 v12, 0x3fb8aa3b, v52
  v_mul_f32 v13, 0x3fb8aa3b, v53
  v_mul_f32 v14, 0x3fb8aa3b, v54
  v_mul_f32 v15, 0x3fb8aa3b, v55
  v_exp_f32 v12, v12
  v_exp_f32 v13, v13
  v_exp_f32 v14, v14
  v_exp_f32 v15, v15
  v_cmp_lt_f32 vcc, 0, v52
  v_add_f32 v52, 1.0, v52
  s_nop 0
  v_cndmask_b32 v52, v12, v52, vcc
  v_cmp_lt_f32 vcc, 0, v53
  v_add_f32 v53, 1.0, v53
  s_nop 0
  v_cndmask_b32 v53, v13, v53, vcc
  v_cmp_lt_f32 vcc, 0, v54
  v_add_f32 v54, 1.0, v54
  s_nop 0
  v_cndmask_b32 v54, v14, v54, vcc
  v_cmp_lt_f32 vcc, 0, v55
  v_add_f32 v55, 1.0, v55
  s_nop 0
  v_cndmask_b32 v55, v15, v55, vcc
  v_cvt_pk_bf16_f32 v12, v52, v53
  v_cvt_pk_bf16_f32 v13, v54, v55
  v_lshlrev_b32 v52, 16, v12
  v_and_b32 v53, 0xffff0000, v12
  v_lshlrev_b32 v54, 16, v13
  v_and_b32 v55, 0xffff0000, v13
  v_add_f32 v52, 0x358637bd, v52
  v_add_f32 v53, 0x358637bd, v53
  v_add_f32 v54, 0x358637bd, v54
  v_add_f32 v55, 0x358637bd, v55
  v_cvt_pk_bf16_f32 v52, v52, v53
  v_cvt_pk_bf16_f32 v53, v54, v55
  buffer_store_dwordx2 v[52:53], v6, s[16:19], s33 offen offset:512 sc1
  v_cvt_pk_bf16_f32 v12, v56, v57
  v_cvt_pk_bf16_f32 v13, v58, v59
  v_lshlrev_b32 v56, 16, v12
  v_and_b32 v57, 0xffff0000, v12
  v_lshlrev_b32 v58, 16, v13
  v_and_b32 v59, 0xffff0000, v13
  v_mul_f32 v12, 0x3fb8aa3b, v56
  v_mul_f32 v13, 0x3fb8aa3b, v57
  v_mul_f32 v14, 0x3fb8aa3b, v58
  v_mul_f32 v15, 0x3fb8aa3b, v59
  v_exp_f32 v12, v12
  v_exp_f32 v13, v13
  v_exp_f32 v14, v14
  v_exp_f32 v15, v15
  v_cmp_lt_f32 vcc, 0, v56
  v_add_f32 v56, 1.0, v56
  s_nop 0
  v_cndmask_b32 v56, v12, v56, vcc
  v_cmp_lt_f32 vcc, 0, v57
  v_add_f32 v57, 1.0, v57
  s_nop 0
  v_cndmask_b32 v57, v13, v57, vcc
  v_cmp_lt_f32 vcc, 0, v58
  v_add_f32 v58, 1.0, v58
  s_nop 0
  v_cndmask_b32 v58, v14, v58, vcc
  v_cmp_lt_f32 vcc, 0, v59
  v_add_f32 v59, 1.0, v59
  s_nop 0
  v_cndmask_b32 v59, v15, v59, vcc
  v_cvt_pk_bf16_f32 v12, v56, v57
  v_cvt_pk_bf16_f32 v13, v58, v59
  v_lshlrev_b32 v56, 16, v12
  v_and_b32 v57, 0xffff0000, v12
  v_lshlrev_b32 v58, 16, v13
  v_and_b32 v59, 0xffff0000, v13
  v_add_f32 v56, 0x358637bd, v56
  v_add_f32 v57, 0x358637bd, v57
  v_add_f32 v58, 0x358637bd, v58
  v_add_f32 v59, 0x358637bd, v59
  v_cvt_pk_bf16_f32 v56, v56, v57
  v_cvt_pk_bf16_f32 v57, v58, v59
  buffer_store_dwordx2 v[56:57], v6, s[16:19], s32 offen offset:1024 sc1
  v_cvt_pk_bf16_f32 v12, v60, v61
  v_cvt_pk_bf16_f32 v13, v62, v63
  v_lshlrev_b32 v60, 16, v12
  v_and_b32 v61, 0xffff0000, v12
  v_lshlrev_b32 v62, 16, v13
  v_and_b32 v63, 0xffff0000, v13
  v_mul_f32 v12, 0x3fb8aa3b, v60
  v_mul_f32 v13, 0x3fb8aa3b, v61
  v_mul_f32 v14, 0x3fb8aa3b, v62
  v_mul_f32 v15, 0x3fb8aa3b, v63
  v_exp_f32 v12, v12
  v_exp_f32 v13, v13
  v_exp_f32 v14, v14
  v_exp_f32 v15, v15
  v_cmp_lt_f32 vcc, 0, v60
  v_add_f32 v60, 1.0, v60
  s_nop 0
  v_cndmask_b32 v60, v12, v60, vcc
  v_cmp_lt_f32 vcc, 0, v61
  v_add_f32 v61, 1.0, v61
  s_nop 0
  v_cndmask_b32 v61, v13, v61, vcc
  v_cmp_lt_f32 vcc, 0, v62
  v_add_f32 v62, 1.0, v62
  s_nop 0
  v_cndmask_b32 v62, v14, v62, vcc
  v_cmp_lt_f32 vcc, 0, v63
  v_add_f32 v63, 1.0, v63
  s_nop 0
  v_cndmask_b32 v63, v15, v63, vcc
  v_cvt_pk_bf16_f32 v12, v60, v61
  v_cvt_pk_bf16_f32 v13, v62, v63
  v_lshlrev_b32 v60, 16, v12
  v_and_b32 v61, 0xffff0000, v12
  v_lshlrev_b32 v62, 16, v13
  v_and_b32 v63, 0xffff0000, v13
  v_add_f32 v60, 0x358637bd, v60
  v_add_f32 v61, 0x358637bd, v61
  v_add_f32 v62, 0x358637bd, v62
  v_add_f32 v63, 0x358637bd, v63
  v_cvt_pk_bf16_f32 v60, v60, v61
  v_cvt_pk_bf16_f32 v61, v62, v63
  buffer_store_dwordx2 v[60:61], v6, s[16:19], s33 offen offset:1024 sc1
  v_cvt_pk_bf16_f32 v12, v64, v65
  v_cvt_pk_bf16_f32 v13, v66, v67
  v_lshlrev_b32 v64, 16, v12
  v_and_b32 v65, 0xffff0000, v12
  v_lshlrev_b32 v66, 16, v13
  v_and_b32 v67, 0xffff0000, v13
  v_mul_f32 v12, 0x3fb8aa3b, v64
  v_mul_f32 v13, 0x3fb8aa3b, v65
  v_mul_f32 v14, 0x3fb8aa3b, v66
  v_mul_f32 v15, 0x3fb8aa3b, v67
  v_exp_f32 v12, v12
  v_exp_f32 v13, v13
  v_exp_f32 v14, v14
  v_exp_f32 v15, v15
  v_cmp_lt_f32 vcc, 0, v64
  v_add_f32 v64, 1.0, v64
  s_nop 0
  v_cndmask_b32 v64, v12, v64, vcc
  v_cmp_lt_f32 vcc, 0, v65
  v_add_f32 v65, 1.0, v65
  s_nop 0
  v_cndmask_b32 v65, v13, v65, vcc
  v_cmp_lt_f32 vcc, 0, v66
  v_add_f32 v66, 1.0, v66
  s_nop 0
  v_cndmask_b32 v66, v14, v66, vcc
  v_cmp_lt_f32 vcc, 0, v67
  v_add_f32 v67, 1.0, v67
  s_nop 0
  v_cndmask_b32 v67, v15, v67, vcc
  v_cvt_pk_bf16_f32 v12, v64, v65
  v_cvt_pk_bf16_f32 v13, v66, v67
  v_lshlrev_b32 v64, 16, v12
  v_and_b32 v65, 0xffff0000, v12
  v_lshlrev_b32 v66, 16, v13
  v_and_b32 v67, 0xffff0000, v13
  v_add_f32 v64, 0x358637bd, v64
  v_add_f32 v65, 0x358637bd, v65
  v_add_f32 v66, 0x358637bd, v66
  v_add_f32 v67, 0x358637bd, v67
  v_cvt_pk_bf16_f32 v64, v64, v65
  v_cvt_pk_bf16_f32 v65, v66, v67
  buffer_store_dwordx2 v[64:65], v6, s[16:19], s32 offen offset:1536 sc1
  v_cvt_pk_bf16_f32 v12, v68, v69
  v_cvt_pk_bf16_f32 v13, v70, v71
  v_lshlrev_b32 v68, 16, v12
  v_and_b32 v69, 0xffff0000, v12
  v_lshlrev_b32 v70, 16, v13
  v_and_b32 v71, 0xffff0000, v13
  v_mul_f32 v12, 0x3fb8aa3b, v68
  v_mul_f32 v13, 0x3fb8aa3b, v69
  v_mul_f32 v14, 0x3fb8aa3b, v70
  v_mul_f32 v15, 0x3fb8aa3b, v71
  v_exp_f32 v12, v12
  v_exp_f32 v13, v13
  v_exp_f32 v14, v14
  v_exp_f32 v15, v15
  v_cmp_lt_f32 vcc, 0, v68
  v_add_f32 v68, 1.0, v68
  s_nop 0
  v_cndmask_b32 v68, v12, v68, vcc
  v_cmp_lt_f32 vcc, 0, v69
  v_add_f32 v69, 1.0, v69
  s_nop 0
  v_cndmask_b32 v69, v13, v69, vcc
  v_cmp_lt_f32 vcc, 0, v70
  v_add_f32 v70, 1.0, v70
  s_nop 0
  v_cndmask_b32 v70, v14, v70, vcc
  v_cmp_lt_f32 vcc, 0, v71
  v_add_f32 v71, 1.0, v71
  s_nop 0
  v_cndmask_b32 v71, v15, v71, vcc
  v_cvt_pk_bf16_f32 v12, v68, v69
  v_cvt_pk_bf16_f32 v13, v70, v71
  v_lshlrev_b32 v68, 16, v12
  v_and_b32 v69, 0xffff0000, v12
  v_lshlrev_b32 v70, 16, v13
  v_and_b32 v71, 0xffff0000, v13
  v_add_f32 v68, 0x358637bd, v68
  v_add_f32 v69, 0x358637bd, v69
  v_add_f32 v70, 0x358637bd, v70
  v_add_f32 v71, 0x358637bd, v71
  v_cvt_pk_bf16_f32 v68, v68, v69
  v_cvt_pk_bf16_f32 v69, v70, v71
  buffer_store_dwordx2 v[68:69], v6, s[16:19], s33 offen offset:1536 sc1
  v_cvt_pk_bf16_f32 v12, v72, v73
  v_cvt_pk_bf16_f32 v13, v74, v75
  v_lshlrev_b32 v72, 16, v12
  v_and_b32 v73, 0xffff0000, v12
  v_lshlrev_b32 v74, 16, v13
  v_and_b32 v75, 0xffff0000, v13
  v_mul_f32 v12, 0x3fb8aa3b, v72
  v_mul_f32 v13, 0x3fb8aa3b, v73
  v_mul_f32 v14, 0x3fb8aa3b, v74
  v_mul_f32 v15, 0x3fb8aa3b, v75
  v_exp_f32 v12, v12
  v_exp_f32 v13, v13
  v_exp_f32 v14, v14
  v_exp_f32 v15, v15
  v_cmp_lt_f32 vcc, 0, v72
  v_add_f32 v72, 1.0, v72
  s_nop 0
  v_cndmask_b32 v72, v12, v72, vcc
  v_cmp_lt_f32 vcc, 0, v73
  v_add_f32 v73, 1.0, v73
  s_nop 0
  v_cndmask_b32 v73, v13, v73, vcc
  v_cmp_lt_f32 vcc, 0, v74
  v_add_f32 v74, 1.0, v74
  s_nop 0
  v_cndmask_b32 v74, v14, v74, vcc
  v_cmp_lt_f32 vcc, 0, v75
  v_add_f32 v75, 1.0, v75
  s_nop 0
  v_cndmask_b32 v75, v15, v75, vcc
  v_cvt_pk_bf16_f32 v12, v72, v73
  v_cvt_pk_bf16_f32 v13, v74, v75
  v_lshlrev_b32 v72, 16, v12
  v_and_b32 v73, 0xffff0000, v12
  v_lshlrev_b32 v74, 16, v13
  v_and_b32 v75, 0xffff0000, v13
  v_add_f32 v72, 0x358637bd, v72
  v_add_f32 v73, 0x358637bd, v73
  v_add_f32 v74, 0x358637bd, v74
  v_add_f32 v75, 0x358637bd, v75
  v_cvt_pk_bf16_f32 v72, v72, v73
  v_cvt_pk_bf16_f32 v73, v74, v75
  buffer_store_dwordx2 v[72:73], v6, s[16:19], s32 offen offset:2048 sc1
  v_cvt_pk_bf16_f32 v12, v76, v77
  v_cvt_pk_bf16_f32 v13, v78, v79
  v_lshlrev_b32 v76, 16, v12
  v_and_b32 v77, 0xffff0000, v12
  v_lshlrev_b32 v78, 16, v13
  v_and_b32 v79, 0xffff0000, v13
  v_mul_f32 v12, 0x3fb8aa3b, v76
  v_mul_f32 v13, 0x3fb8aa3b, v77
  v_mul_f32 v14, 0x3fb8aa3b, v78
  v_mul_f32 v15, 0x3fb8aa3b, v79
  v_exp_f32 v12, v12
  v_exp_f32 v13, v13
  v_exp_f32 v14, v14
  v_exp_f32 v15, v15
  v_cmp_lt_f32 vcc, 0, v76
  v_add_f32 v76, 1.0, v76
  s_nop 0
  v_cndmask_b32 v76, v12, v76, vcc
  v_cmp_lt_f32 vcc, 0, v77
  v_add_f32 v77, 1.0, v77
  s_nop 0
  v_cndmask_b32 v77, v13, v77, vcc
  v_cmp_lt_f32 vcc, 0, v78
  v_add_f32 v78, 1.0, v78
  s_nop 0
  v_cndmask_b32 v78, v14, v78, vcc
  v_cmp_lt_f32 vcc, 0, v79
  v_add_f32 v79, 1.0, v79
  s_nop 0
  v_cndmask_b32 v79, v15, v79, vcc
  v_cvt_pk_bf16_f32 v12, v76, v77
  v_cvt_pk_bf16_f32 v13, v78, v79
  v_lshlrev_b32 v76, 16, v12
  v_and_b32 v77, 0xffff0000, v12
  v_lshlrev_b32 v78, 16, v13
  v_and_b32 v79, 0xffff0000, v13
  v_add_f32 v76, 0x358637bd, v76
  v_add_f32 v77, 0x358637bd, v77
  v_add_f32 v78, 0x358637bd, v78
  v_add_f32 v79, 0x358637bd, v79
  v_cvt_pk_bf16_f32 v76, v76, v77
  v_cvt_pk_bf16_f32 v77, v78, v79
  buffer_store_dwordx2 v[76:77], v6, s[16:19], s33 offen offset:2048 sc1
  v_cvt_pk_bf16_f32 v12, v80, v81
  v_cvt_pk_bf16_f32 v13, v82, v83
  v_lshlrev_b32 v80, 16, v12
  v_and_b32 v81, 0xffff0000, v12
  v_lshlrev_b32 v82, 16, v13
  v_and_b32 v83, 0xffff0000, v13
  v_mul_f32 v12, 0x3fb8aa3b, v80
  v_mul_f32 v13, 0x3fb8aa3b, v81
  v_mul_f32 v14, 0x3fb8aa3b, v82
  v_mul_f32 v15, 0x3fb8aa3b, v83
  v_exp_f32 v12, v12
  v_exp_f32 v13, v13
  v_exp_f32 v14, v14
  v_exp_f32 v15, v15
  v_cmp_lt_f32 vcc, 0, v80
  v_add_f32 v80, 1.0, v80
  s_nop 0
  v_cndmask_b32 v80, v12, v80, vcc
  v_cmp_lt_f32 vcc, 0, v81
  v_add_f32 v81, 1.0, v81
  s_nop 0
  v_cndmask_b32 v81, v13, v81, vcc
  v_cmp_lt_f32 vcc, 0, v82
  v_add_f32 v82, 1.0, v82
  s_nop 0
  v_cndmask_b32 v82, v14, v82, vcc
  v_cmp_lt_f32 vcc, 0, v83
  v_add_f32 v83, 1.0, v83
  s_nop 0
  v_cndmask_b32 v83, v15, v83, vcc
  v_cvt_pk_bf16_f32 v12, v80, v81
  v_cvt_pk_bf16_f32 v13, v82, v83
  v_lshlrev_b32 v80, 16, v12
  v_and_b32 v81, 0xffff0000, v12
  v_lshlrev_b32 v82, 16, v13
  v_and_b32 v83, 0xffff0000, v13
  v_add_f32 v80, 0x358637bd, v80
  v_add_f32 v81, 0x358637bd, v81
  v_add_f32 v82, 0x358637bd, v82
  v_add_f32 v83, 0x358637bd, v83
  v_cvt_pk_bf16_f32 v80, v80, v81
  v_cvt_pk_bf16_f32 v81, v82, v83
  buffer_store_dwordx2 v[80:81], v6, s[16:19], s32 offen offset:2560 sc1
  v_cvt_pk_bf16_f32 v12, v84, v85
  v_cvt_pk_bf16_f32 v13, v86, v87
  v_lshlrev_b32 v84, 16, v12
  v_and_b32 v85, 0xffff0000, v12
  v_lshlrev_b32 v86, 16, v13
  v_and_b32 v87, 0xffff0000, v13
  v_mul_f32 v12, 0x3fb8aa3b, v84
  v_mul_f32 v13, 0x3fb8aa3b, v85
  v_mul_f32 v14, 0x3fb8aa3b, v86
  v_mul_f32 v15, 0x3fb8aa3b, v87
  v_exp_f32 v12, v12
  v_exp_f32 v13, v13
  v_exp_f32 v14, v14
  v_exp_f32 v15, v15
  v_cmp_lt_f32 vcc, 0, v84
  v_add_f32 v84, 1.0, v84
  s_nop 0
  v_cndmask_b32 v84, v12, v84, vcc
  v_cmp_lt_f32 vcc, 0, v85
  v_add_f32 v85, 1.0, v85
  s_nop 0
  v_cndmask_b32 v85, v13, v85, vcc
  v_cmp_lt_f32 vcc, 0, v86
  v_add_f32 v86, 1.0, v86
  s_nop 0
  v_cndmask_b32 v86, v14, v86, vcc
  v_cmp_lt_f32 vcc, 0, v87
  v_add_f32 v87, 1.0, v87
  s_nop 0
  v_cndmask_b32 v87, v15, v87, vcc
  v_cvt_pk_bf16_f32 v12, v84, v85
  v_cvt_pk_bf16_f32 v13, v86, v87
  v_lshlrev_b32 v84, 16, v12
  v_and_b32 v85, 0xffff0000, v12
  v_lshlrev_b32 v86, 16, v13
  v_and_b32 v87, 0xffff0000, v13
  v_add_f32 v84, 0x358637bd, v84
  v_add_f32 v85, 0x358637bd, v85
  v_add_f32 v86, 0x358637bd, v86
  v_add_f32 v87, 0x358637bd, v87
  v_cvt_pk_bf16_f32 v84, v84, v85
  v_cvt_pk_bf16_f32 v85, v86, v87
  buffer_store_dwordx2 v[84:85], v6, s[16:19], s33 offen offset:2560 sc1
  v_cvt_pk_bf16_f32 v12, v88, v89
  v_cvt_pk_bf16_f32 v13, v90, v91
  v_lshlrev_b32 v88, 16, v12
  v_and_b32 v89, 0xffff0000, v12
  v_lshlrev_b32 v90, 16, v13
  v_and_b32 v91, 0xffff0000, v13
  v_mul_f32 v12, 0x3fb8aa3b, v88
  v_mul_f32 v13, 0x3fb8aa3b, v89
  v_mul_f32 v14, 0x3fb8aa3b, v90
  v_mul_f32 v15, 0x3fb8aa3b, v91
  v_exp_f32 v12, v12
  v_exp_f32 v13, v13
  v_exp_f32 v14, v14
  v_exp_f32 v15, v15
  v_cmp_lt_f32 vcc, 0, v88
  v_add_f32 v88, 1.0, v88
  s_nop 0
  v_cndmask_b32 v88, v12, v88, vcc
  v_cmp_lt_f32 vcc, 0, v89
  v_add_f32 v89, 1.0, v89
  s_nop 0
  v_cndmask_b32 v89, v13, v89, vcc
  v_cmp_lt_f32 vcc, 0, v90
  v_add_f32 v90, 1.0, v90
  s_nop 0
  v_cndmask_b32 v90, v14, v90, vcc
  v_cmp_lt_f32 vcc, 0, v91
  v_add_f32 v91, 1.0, v91
  s_nop 0
  v_cndmask_b32 v91, v15, v91, vcc
  v_cvt_pk_bf16_f32 v12, v88, v89
  v_cvt_pk_bf16_f32 v13, v90, v91
  v_lshlrev_b32 v88, 16, v12
  v_and_b32 v89, 0xffff0000, v12
  v_lshlrev_b32 v90, 16, v13
  v_and_b32 v91, 0xffff0000, v13
  v_add_f32 v88, 0x358637bd, v88
  v_add_f32 v89, 0x358637bd, v89
  v_add_f32 v90, 0x358637bd, v90
  v_add_f32 v91, 0x358637bd, v91
  v_cvt_pk_bf16_f32 v88, v88, v89
  v_cvt_pk_bf16_f32 v89, v90, v91
  buffer_store_dwordx2 v[88:89], v6, s[16:19], s32 offen offset:3072 sc1
  v_cvt_pk_bf16_f32 v12, v92, v93
  v_cvt_pk_bf16_f32 v13, v94, v95
  v_lshlrev_b32 v92, 16, v12
  v_and_b32 v93, 0xffff0000, v12
  v_lshlrev_b32 v94, 16, v13
  v_and_b32 v95, 0xffff0000, v13
  v_mul_f32 v12, 0x3fb8aa3b, v92
  v_mul_f32 v13, 0x3fb8aa3b, v93
  v_mul_f32 v14, 0x3fb8aa3b, v94
  v_mul_f32 v15, 0x3fb8aa3b, v95
  v_exp_f32 v12, v12
  v_exp_f32 v13, v13
  v_exp_f32 v14, v14
  v_exp_f32 v15, v15
  v_cmp_lt_f32 vcc, 0, v92
  v_add_f32 v92, 1.0, v92
  s_nop 0
  v_cndmask_b32 v92, v12, v92, vcc
  v_cmp_lt_f32 vcc, 0, v93
  v_add_f32 v93, 1.0, v93
  s_nop 0
  v_cndmask_b32 v93, v13, v93, vcc
  v_cmp_lt_f32 vcc, 0, v94
  v_add_f32 v94, 1.0, v94
  s_nop 0
  v_cndmask_b32 v94, v14, v94, vcc
  v_cmp_lt_f32 vcc, 0, v95
  v_add_f32 v95, 1.0, v95
  s_nop 0
  v_cndmask_b32 v95, v15, v95, vcc
  v_cvt_pk_bf16_f32 v12, v92, v93
  v_cvt_pk_bf16_f32 v13, v94, v95
  v_lshlrev_b32 v92, 16, v12
  v_and_b32 v93, 0xffff0000, v12
  v_lshlrev_b32 v94, 16, v13
  v_and_b32 v95, 0xffff0000, v13
  v_add_f32 v92, 0x358637bd, v92
  v_add_f32 v93, 0x358637bd, v93
  v_add_f32 v94, 0x358637bd, v94
  v_add_f32 v95, 0x358637bd, v95
  v_cvt_pk_bf16_f32 v92, v92, v93
  v_cvt_pk_bf16_f32 v93, v94, v95
  buffer_store_dwordx2 v[92:93], v6, s[16:19], s33 offen offset:3072 sc1
  v_cvt_pk_bf16_f32 v12, v96, v97
  v_cvt_pk_bf16_f32 v13, v98, v99
  v_lshlrev_b32 v96, 16, v12
  v_and_b32 v97, 0xffff0000, v12
  v_lshlrev_b32 v98, 16, v13
  v_and_b32 v99, 0xffff0000, v13
  v_mul_f32 v12, 0x3fb8aa3b, v96
  v_mul_f32 v13, 0x3fb8aa3b, v97
  v_mul_f32 v14, 0x3fb8aa3b, v98
  v_mul_f32 v15, 0x3fb8aa3b, v99
  v_exp_f32 v12, v12
  v_exp_f32 v13, v13
  v_exp_f32 v14, v14
  v_exp_f32 v15, v15
  v_cmp_lt_f32 vcc, 0, v96
  v_add_f32 v96, 1.0, v96
  s_nop 0
  v_cndmask_b32 v96, v12, v96, vcc
  v_cmp_lt_f32 vcc, 0, v97
  v_add_f32 v97, 1.0, v97
  s_nop 0
  v_cndmask_b32 v97, v13, v97, vcc
  v_cmp_lt_f32 vcc, 0, v98
  v_add_f32 v98, 1.0, v98
  s_nop 0
  v_cndmask_b32 v98, v14, v98, vcc
  v_cmp_lt_f32 vcc, 0, v99
  v_add_f32 v99, 1.0, v99
  s_nop 0
  v_cndmask_b32 v99, v15, v99, vcc
  v_cvt_pk_bf16_f32 v12, v96, v97
  v_cvt_pk_bf16_f32 v13, v98, v99
  v_lshlrev_b32 v96, 16, v12
  v_and_b32 v97, 0xffff0000, v12
  v_lshlrev_b32 v98, 16, v13
  v_and_b32 v99, 0xffff0000, v13
  v_add_f32 v96, 0x358637bd, v96
  v_add_f32 v97, 0x358637bd, v97
  v_add_f32 v98, 0x358637bd, v98
  v_add_f32 v99, 0x358637bd, v99
  v_cvt_pk_bf16_f32 v96, v96, v97
  v_cvt_pk_bf16_f32 v97, v98, v99
  buffer_store_dwordx2 v[96:97], v6, s[16:19], s32 offen offset:3584 sc1
  v_cvt_pk_bf16_f32 v12, v100, v101
  v_cvt_pk_bf16_f32 v13, v102, v103
  v_lshlrev_b32 v100, 16, v12
  v_and_b32 v101, 0xffff0000, v12
  v_lshlrev_b32 v102, 16, v13
  v_and_b32 v103, 0xffff0000, v13
  v_mul_f32 v12, 0x3fb8aa3b, v100
  v_mul_f32 v13, 0x3fb8aa3b, v101
  v_mul_f32 v14, 0x3fb8aa3b, v102
  v_mul_f32 v15, 0x3fb8aa3b, v103
  v_exp_f32 v12, v12
  v_exp_f32 v13, v13
  v_exp_f32 v14, v14
  v_exp_f32 v15, v15
  v_cmp_lt_f32 vcc, 0, v100
  v_add_f32 v100, 1.0, v100
  s_nop 0
  v_cndmask_b32 v100, v12, v100, vcc
  v_cmp_lt_f32 vcc, 0, v101
  v_add_f32 v101, 1.0, v101
  s_nop 0
  v_cndmask_b32 v101, v13, v101, vcc
  v_cmp_lt_f32 vcc, 0, v102
  v_add_f32 v102, 1.0, v102
  s_nop 0
  v_cndmask_b32 v102, v14, v102, vcc
  v_cmp_lt_f32 vcc, 0, v103
  v_add_f32 v103, 1.0, v103
  s_nop 0
  v_cndmask_b32 v103, v15, v103, vcc
  v_cvt_pk_bf16_f32 v12, v100, v101
  v_cvt_pk_bf16_f32 v13, v102, v103
  v_lshlrev_b32 v100, 16, v12
  v_and_b32 v101, 0xffff0000, v12
  v_lshlrev_b32 v102, 16, v13
  v_and_b32 v103, 0xffff0000, v13
  v_add_f32 v100, 0x358637bd, v100
  v_add_f32 v101, 0x358637bd, v101
  v_add_f32 v102, 0x358637bd, v102
  v_add_f32 v103, 0x358637bd, v103
  v_cvt_pk_bf16_f32 v100, v100, v101
  v_cvt_pk_bf16_f32 v101, v102, v103
  buffer_store_dwordx2 v[100:101], v6, s[16:19], s33 offen offset:3584 sc1
  v_cvt_pk_bf16_f32 v12, v104, v105
  v_cvt_pk_bf16_f32 v13, v106, v107
  v_lshlrev_b32 v104, 16, v12
  v_and_b32 v105, 0xffff0000, v12
  v_lshlrev_b32 v106, 16, v13
  v_and_b32 v107, 0xffff0000, v13
  v_mul_f32 v12, 0x3fb8aa3b, v104
  v_mul_f32 v13, 0x3fb8aa3b, v105
  v_mul_f32 v14, 0x3fb8aa3b, v106
  v_mul_f32 v15, 0x3fb8aa3b, v107
  v_exp_f32 v12, v12
  v_exp_f32 v13, v13
  v_exp_f32 v14, v14
  v_exp_f32 v15, v15
  v_cmp_lt_f32 vcc, 0, v104
  v_add_f32 v104, 1.0, v104
  s_nop 0
  v_cndmask_b32 v104, v12, v104, vcc
  v_cmp_lt_f32 vcc, 0, v105
  v_add_f32 v105, 1.0, v105
  s_nop 0
  v_cndmask_b32 v105, v13, v105, vcc
  v_cmp_lt_f32 vcc, 0, v106
  v_add_f32 v106, 1.0, v106
  s_nop 0
  v_cndmask_b32 v106, v14, v106, vcc
  v_cmp_lt_f32 vcc, 0, v107
  v_add_f32 v107, 1.0, v107
  s_nop 0
  v_cndmask_b32 v107, v15, v107, vcc
  v_cvt_pk_bf16_f32 v12, v104, v105
  v_cvt_pk_bf16_f32 v13, v106, v107
  v_lshlrev_b32 v104, 16, v12
  v_and_b32 v105, 0xffff0000, v12
  v_lshlrev_b32 v106, 16, v13
  v_and_b32 v107, 0xffff0000, v13
  v_add_f32 v104, 0x358637bd, v104
  v_add_f32 v105, 0x358637bd, v105
  v_add_f32 v106, 0x358637bd, v106
  v_add_f32 v107, 0x358637bd, v107
  v_cvt_pk_bf16_f32 v104, v104, v105
  v_cvt_pk_bf16_f32 v105, v106, v107
  s_add_u32 s34, s32, 4096
  buffer_store_dwordx2 v[104:105], v6, s[16:19], s34 offen offset:0 sc1
  v_cvt_pk_bf16_f32 v12, v108, v109
  v_cvt_pk_bf16_f32 v13, v110, v111
  v_lshlrev_b32 v108, 16, v12
  v_and_b32 v109, 0xffff0000, v12
  v_lshlrev_b32 v110, 16, v13
  v_and_b32 v111, 0xffff0000, v13
  v_mul_f32 v12, 0x3fb8aa3b, v108
  v_mul_f32 v13, 0x3fb8aa3b, v109
  v_mul_f32 v14, 0x3fb8aa3b, v110
  v_mul_f32 v15, 0x3fb8aa3b, v111
  v_exp_f32 v12, v12
  v_exp_f32 v13, v13
  v_exp_f32 v14, v14
  v_exp_f32 v15, v15
  v_cmp_lt_f32 vcc, 0, v108
  v_add_f32 v108, 1.0, v108
  s_nop 0
  v_cndmask_b32 v108, v12, v108, vcc
  v_cmp_lt_f32 vcc, 0, v109
  v_add_f32 v109, 1.0, v109
  s_nop 0
  v_cndmask_b32 v109, v13, v109, vcc
  v_cmp_lt_f32 vcc, 0, v110
  v_add_f32 v110, 1.0, v110
  s_nop 0
  v_cndmask_b32 v110, v14, v110, vcc
  v_cmp_lt_f32 vcc, 0, v111
  v_add_f32 v111, 1.0, v111
  s_nop 0
  v_cndmask_b32 v111, v15, v111, vcc
  v_cvt_pk_bf16_f32 v12, v108, v109
  v_cvt_pk_bf16_f32 v13, v110, v111
  v_lshlrev_b32 v108, 16, v12
  v_and_b32 v109, 0xffff0000, v12
  v_lshlrev_b32 v110, 16, v13
  v_and_b32 v111, 0xffff0000, v13
  v_add_f32 v108, 0x358637bd, v108
  v_add_f32 v109, 0x358637bd, v109
  v_add_f32 v110, 0x358637bd, v110
  v_add_f32 v111, 0x358637bd, v111
  v_cvt_pk_bf16_f32 v108, v108, v109
  v_cvt_pk_bf16_f32 v109, v110, v111
  s_add_u32 s34, s33, 4096
  buffer_store_dwordx2 v[108:109], v6, s[16:19], s34 offen offset:0 sc1
  v_cvt_pk_bf16_f32 v12, v112, v113
  v_cvt_pk_bf16_f32 v13, v114, v115
  v_lshlrev_b32 v112, 16, v12
  v_and_b32 v113, 0xffff0000, v12
  v_lshlrev_b32 v114, 16, v13
  v_and_b32 v115, 0xffff0000, v13
  v_mul_f32 v12, 0x3fb8aa3b, v112
  v_mul_f32 v13, 0x3fb8aa3b, v113
  v_mul_f32 v14, 0x3fb8aa3b, v114
  v_mul_f32 v15, 0x3fb8aa3b, v115
  v_exp_f32 v12, v12
  v_exp_f32 v13, v13
  v_exp_f32 v14, v14
  v_exp_f32 v15, v15
  v_cmp_lt_f32 vcc, 0, v112
  v_add_f32 v112, 1.0, v112
  s_nop 0
  v_cndmask_b32 v112, v12, v112, vcc
  v_cmp_lt_f32 vcc, 0, v113
  v_add_f32 v113, 1.0, v113
  s_nop 0
  v_cndmask_b32 v113, v13, v113, vcc
  v_cmp_lt_f32 vcc, 0, v114
  v_add_f32 v114, 1.0, v114
  s_nop 0
  v_cndmask_b32 v114, v14, v114, vcc
  v_cmp_lt_f32 vcc, 0, v115
  v_add_f32 v115, 1.0, v115
  s_nop 0
  v_cndmask_b32 v115, v15, v115, vcc
  v_cvt_pk_bf16_f32 v12, v112, v113
  v_cvt_pk_bf16_f32 v13, v114, v115
  v_lshlrev_b32 v112, 16, v12
  v_and_b32 v113, 0xffff0000, v12
  v_lshlrev_b32 v114, 16, v13
  v_and_b32 v115, 0xffff0000, v13
  v_add_f32 v112, 0x358637bd, v112
  v_add_f32 v113, 0x358637bd, v113
  v_add_f32 v114, 0x358637bd, v114
  v_add_f32 v115, 0x358637bd, v115
  v_cvt_pk_bf16_f32 v112, v112, v113
  v_cvt_pk_bf16_f32 v113, v114, v115
  v_cvt_pk_bf16_f32 v12, v116, v117
  v_cvt_pk_bf16_f32 v13, v118, v119
  v_lshlrev_b32 v116, 16, v12
  v_and_b32 v117, 0xffff0000, v12
  v_lshlrev_b32 v118, 16, v13
  v_and_b32 v119, 0xffff0000, v13
  v_mul_f32 v12, 0x3fb8aa3b, v116
  v_mul_f32 v13, 0x3fb8aa3b, v117
  v_mul_f32 v14, 0x3fb8aa3b, v118
  v_mul_f32 v15, 0x3fb8aa3b, v119
  v_exp_f32 v12, v12
  v_exp_f32 v13, v13
  v_exp_f32 v14, v14
  v_exp_f32 v15, v15
  v_cmp_lt_f32 vcc, 0, v116
  v_add_f32 v116, 1.0, v116
  s_nop 0
  v_cndmask_b32 v116, v12, v116, vcc
  v_cmp_lt_f32 vcc, 0, v117
  v_add_f32 v117, 1.0, v117
  s_nop 0
  v_cndmask_b32 v117, v13, v117, vcc
  v_cmp_lt_f32 vcc, 0, v118
  v_add_f32 v118, 1.0, v118
  s_nop 0
  v_cndmask_b32 v118, v14, v118, vcc
  v_cmp_lt_f32 vcc, 0, v119
  v_add_f32 v119, 1.0, v119
  s_nop 0
  v_cndmask_b32 v119, v15, v119, vcc
  v_cvt_pk_bf16_f32 v12, v116, v117
  v_cvt_pk_bf16_f32 v13, v118, v119
  v_lshlrev_b32 v116, 16, v12
  v_and_b32 v117, 0xffff0000, v12
  v_lshlrev_b32 v118, 16, v13
  v_and_b32 v119, 0xffff0000, v13
  v_add_f32 v116, 0x358637bd, v116
  v_add_f32 v117, 0x358637bd, v117
  v_add_f32 v118, 0x358637bd, v118
  v_add_f32 v119, 0x358637bd, v119
  v_cvt_pk_bf16_f32 v116, v116, v117
  v_cvt_pk_bf16_f32 v117, v118, v119
  v_mov_b64 v[114:115], v[116:117]
  v_cvt_pk_bf16_f32 v12, v120, v121
  v_cvt_pk_bf16_f32 v13, v122, v123
  v_lshlrev_b32 v120, 16, v12
  v_and_b32 v121, 0xffff0000, v12
  v_lshlrev_b32 v122, 16, v13
  v_and_b32 v123, 0xffff0000, v13
  v_mul_f32 v12, 0x3fb8aa3b, v120
  v_mul_f32 v13, 0x3fb8aa3b, v121
  v_mul_f32 v14, 0x3fb8aa3b, v122
  v_mul_f32 v15, 0x3fb8aa3b, v123
  v_exp_f32 v12, v12
  v_exp_f32 v13, v13
  v_exp_f32 v14, v14
  v_exp_f32 v15, v15
  v_cmp_lt_f32 vcc, 0, v120
  v_add_f32 v120, 1.0, v120
  s_nop 0
  v_cndmask_b32 v120, v12, v120, vcc
  v_cmp_lt_f32 vcc, 0, v121
  v_add_f32 v121, 1.0, v121
  s_nop 0
  v_cndmask_b32 v121, v13, v121, vcc
  v_cmp_lt_f32 vcc, 0, v122
  v_add_f32 v122, 1.0, v122
  s_nop 0
  v_cndmask_b32 v122, v14, v122, vcc
  v_cmp_lt_f32 vcc, 0, v123
  v_add_f32 v123, 1.0, v123
  s_nop 0
  v_cndmask_b32 v123, v15, v123, vcc
  v_cvt_pk_bf16_f32 v12, v120, v121
  v_cvt_pk_bf16_f32 v13, v122, v123
  v_lshlrev_b32 v120, 16, v12
  v_and_b32 v121, 0xffff0000, v12
  v_lshlrev_b32 v122, 16, v13
  v_and_b32 v123, 0xffff0000, v13
  v_add_f32 v120, 0x358637bd, v120
  v_add_f32 v121, 0x358637bd, v121
  v_add_f32 v122, 0x358637bd, v122
  v_add_f32 v123, 0x358637bd, v123
  v_cvt_pk_bf16_f32 v120, v120, v121
  v_cvt_pk_bf16_f32 v121, v122, v123
  v_cvt_pk_bf16_f32 v12, v124, v125
  v_cvt_pk_bf16_f32 v13, v126, v127
  v_lshlrev_b32 v124, 16, v12
  v_and_b32 v125, 0xffff0000, v12
  v_lshlrev_b32 v126, 16, v13
  v_and_b32 v127, 0xffff0000, v13
  v_mul_f32 v12, 0x3fb8aa3b, v124
  v_mul_f32 v13, 0x3fb8aa3b, v125
  v_mul_f32 v14, 0x3fb8aa3b, v126
  v_mul_f32 v15, 0x3fb8aa3b, v127
  v_exp_f32 v12, v12
  v_exp_f32 v13, v13
  v_exp_f32 v14, v14
  v_exp_f32 v15, v15
  v_cmp_lt_f32 vcc, 0, v124
  v_add_f32 v124, 1.0, v124
  s_nop 0
  v_cndmask_b32 v124, v12, v124, vcc
  v_cmp_lt_f32 vcc, 0, v125
  v_add_f32 v125, 1.0, v125
  s_nop 0
  v_cndmask_b32 v125, v13, v125, vcc
  v_cmp_lt_f32 vcc, 0, v126
  v_add_f32 v126, 1.0, v126
  s_nop 0
  v_cndmask_b32 v126, v14, v126, vcc
  v_cmp_lt_f32 vcc, 0, v127
  v_add_f32 v127, 1.0, v127
  s_nop 0
  v_cndmask_b32 v127, v15, v127, vcc
  v_cvt_pk_bf16_f32 v12, v124, v125
  v_cvt_pk_bf16_f32 v13, v126, v127
  v_lshlrev_b32 v124, 16, v12
  v_and_b32 v125, 0xffff0000, v12
  v_lshlrev_b32 v126, 16, v13
  v_and_b32 v127, 0xffff0000, v13
  v_add_f32 v124, 0x358637bd, v124
  v_add_f32 v125, 0x358637bd, v125
  v_add_f32 v126, 0x358637bd, v126
  v_add_f32 v127, 0x358637bd, v127
  v_cvt_pk_bf16_f32 v124, v124, v125
  v_cvt_pk_bf16_f32 v125, v126, v127
  v_mov_b64 v[122:123], v[124:125]
  v_cvt_pk_bf16_f32 v12, v128, v129
  v_cvt_pk_bf16_f32 v13, v130, v131
  v_lshlrev_b32 v128, 16, v12
  v_and_b32 v129, 0xffff0000, v12
  v_lshlrev_b32 v130, 16, v13
  v_and_b32 v131, 0xffff0000, v13
  v_mul_f32 v12, 0x3fb8aa3b, v128
  v_mul_f32 v13, 0x3fb8aa3b, v129
  v_mul_f32 v14, 0x3fb8aa3b, v130
  v_mul_f32 v15, 0x3fb8aa3b, v131
  v_exp_f32 v12, v12
  v_exp_f32 v13, v13
  v_exp_f32 v14, v14
  v_exp_f32 v15, v15
  v_cmp_lt_f32 vcc, 0, v128
  v_add_f32 v128, 1.0, v128
  s_nop 0
  v_cndmask_b32 v128, v12, v128, vcc
  v_cmp_lt_f32 vcc, 0, v129
  v_add_f32 v129, 1.0, v129
  s_nop 0
  v_cndmask_b32 v129, v13, v129, vcc
  v_cmp_lt_f32 vcc, 0, v130
  v_add_f32 v130, 1.0, v130
  s_nop 0
  v_cndmask_b32 v130, v14, v130, vcc
  v_cmp_lt_f32 vcc, 0, v131
  v_add_f32 v131, 1.0, v131
  s_nop 0
  v_cndmask_b32 v131, v15, v131, vcc
  v_cvt_pk_bf16_f32 v12, v128, v129
  v_cvt_pk_bf16_f32 v13, v130, v131
  v_lshlrev_b32 v128, 16, v12
  v_and_b32 v129, 0xffff0000, v12
  v_lshlrev_b32 v130, 16, v13
  v_and_b32 v131, 0xffff0000, v13
  v_add_f32 v128, 0x358637bd, v128
  v_add_f32 v129, 0x358637bd, v129
  v_add_f32 v130, 0x358637bd, v130
  v_add_f32 v131, 0x358637bd, v131
  v_cvt_pk_bf16_f32 v128, v128, v129
  v_cvt_pk_bf16_f32 v129, v130, v131
  v_cvt_pk_bf16_f32 v12, v132, v133
  v_cvt_pk_bf16_f32 v13, v134, v135
  v_lshlrev_b32 v132, 16, v12
  v_and_b32 v133, 0xffff0000, v12
  v_lshlrev_b32 v134, 16, v13
  v_and_b32 v135, 0xffff0000, v13
  v_mul_f32 v12, 0x3fb8aa3b, v132
  v_mul_f32 v13, 0x3fb8aa3b, v133
  v_mul_f32 v14, 0x3fb8aa3b, v134
  v_mul_f32 v15, 0x3fb8aa3b, v135
  v_exp_f32 v12, v12
  v_exp_f32 v13, v13
  v_exp_f32 v14, v14
  v_exp_f32 v15, v15
  v_cmp_lt_f32 vcc, 0, v132
  v_add_f32 v132, 1.0, v132
  s_nop 0
  v_cndmask_b32 v132, v12, v132, vcc
  v_cmp_lt_f32 vcc, 0, v133
  v_add_f32 v133, 1.0, v133
  s_nop 0
  v_cndmask_b32 v133, v13, v133, vcc
  v_cmp_lt_f32 vcc, 0, v134
  v_add_f32 v134, 1.0, v134
  s_nop 0
  v_cndmask_b32 v134, v14, v134, vcc
  v_cmp_lt_f32 vcc, 0, v135
  v_add_f32 v135, 1.0, v135
  s_nop 0
  v_cndmask_b32 v135, v15, v135, vcc
  v_cvt_pk_bf16_f32 v12, v132, v133
  v_cvt_pk_bf16_f32 v13, v134, v135
  v_lshlrev_b32 v132, 16, v12
  v_and_b32 v133, 0xffff0000, v12
  v_lshlrev_b32 v134, 16, v13
  v_and_b32 v135, 0xffff0000, v13
  v_add_f32 v132, 0x358637bd, v132
  v_add_f32 v133, 0x358637bd, v133
  v_add_f32 v134, 0x358637bd, v134
  v_add_f32 v135, 0x358637bd, v135
  v_cvt_pk_bf16_f32 v132, v132, v133
  v_cvt_pk_bf16_f32 v133, v134, v135
  v_mov_b64 v[130:131], v[132:133]
  v_cvt_pk_bf16_f32 v12, v136, v137
  v_cvt_pk_bf16_f32 v13, v138, v139
  v_lshlrev_b32 v136, 16, v12
  v_and_b32 v137, 0xffff0000, v12
  v_lshlrev_b32 v138, 16, v13
  v_and_b32 v139, 0xffff0000, v13
  v_mul_f32 v12, 0x3fb8aa3b, v136
  v_mul_f32 v13, 0x3fb8aa3b, v137
  v_mul_f32 v14, 0x3fb8aa3b, v138
  v_mul_f32 v15, 0x3fb8aa3b, v139
  v_exp_f32 v12, v12
  v_exp_f32 v13, v13
  v_exp_f32 v14, v14
  v_exp_f32 v15, v15
  v_cmp_lt_f32 vcc, 0, v136
  v_add_f32 v136, 1.0, v136
  s_nop 0
  v_cndmask_b32 v136, v12, v136, vcc
  v_cmp_lt_f32 vcc, 0, v137
  v_add_f32 v137, 1.0, v137
  s_nop 0
  v_cndmask_b32 v137, v13, v137, vcc
  v_cmp_lt_f32 vcc, 0, v138
  v_add_f32 v138, 1.0, v138
  s_nop 0
  v_cndmask_b32 v138, v14, v138, vcc
  v_cmp_lt_f32 vcc, 0, v139
  v_add_f32 v139, 1.0, v139
  s_nop 0
  v_cndmask_b32 v139, v15, v139, vcc
  v_cvt_pk_bf16_f32 v12, v136, v137
  v_cvt_pk_bf16_f32 v13, v138, v139
  v_lshlrev_b32 v136, 16, v12
  v_and_b32 v137, 0xffff0000, v12
  v_lshlrev_b32 v138, 16, v13
  v_and_b32 v139, 0xffff0000, v13
  v_add_f32 v136, 0x358637bd, v136
  v_add_f32 v137, 0x358637bd, v137
  v_add_f32 v138, 0x358637bd, v138
  v_add_f32 v139, 0x358637bd, v139
  v_cvt_pk_bf16_f32 v136, v136, v137
  v_cvt_pk_bf16_f32 v137, v138, v139
  v_cvt_pk_bf16_f32 v12, v140, v141
  v_cvt_pk_bf16_f32 v13, v142, v143
  v_lshlrev_b32 v140, 16, v12
  v_and_b32 v141, 0xffff0000, v12
  v_lshlrev_b32 v142, 16, v13
  v_and_b32 v143, 0xffff0000, v13
  v_mul_f32 v12, 0x3fb8aa3b, v140
  v_mul_f32 v13, 0x3fb8aa3b, v141
  v_mul_f32 v14, 0x3fb8aa3b, v142
  v_mul_f32 v15, 0x3fb8aa3b, v143
  v_exp_f32 v12, v12
  v_exp_f32 v13, v13
  v_exp_f32 v14, v14
  v_exp_f32 v15, v15
  v_cmp_lt_f32 vcc, 0, v140
  v_add_f32 v140, 1.0, v140
  s_nop 0
  v_cndmask_b32 v140, v12, v140, vcc
  v_cmp_lt_f32 vcc, 0, v141
  v_add_f32 v141, 1.0, v141
  s_nop 0
  v_cndmask_b32 v141, v13, v141, vcc
  v_cmp_lt_f32 vcc, 0, v142
  v_add_f32 v142, 1.0, v142
  s_nop 0
  v_cndmask_b32 v142, v14, v142, vcc
  v_cmp_lt_f32 vcc, 0, v143
  v_add_f32 v143, 1.0, v143
  s_nop 0
  v_cndmask_b32 v143, v15, v143, vcc
  v_cvt_pk_bf16_f32 v12, v140, v141
  v_cvt_pk_bf16_f32 v13, v142, v143
  v_lshlrev_b32 v140, 16, v12
  v_and_b32 v141, 0xffff0000, v12
  v_lshlrev_b32 v142, 16, v13
  v_and_b32 v143, 0xffff0000, v13
  v_add_f32 v140, 0x358637bd, v140
  v_add_f32 v141, 0x358637bd, v141
  v_add_f32 v142, 0x358637bd, v142
  v_add_f32 v143, 0x358637bd, v143
  v_cvt_pk_bf16_f32 v140, v140, v141
  v_cvt_pk_bf16_f32 v141, v142, v143
  v_mov_b64 v[138:139], v[140:141]
  v_cvt_pk_bf16_f32 v12, v144, v145
  v_cvt_pk_bf16_f32 v13, v146, v147
  v_lshlrev_b32 v144, 16, v12
  v_and_b32 v145, 0xffff0000, v12
  v_lshlrev_b32 v146, 16, v13
  v_and_b32 v147, 0xffff0000, v13
  v_mul_f32 v12, 0x3fb8aa3b, v144
  v_mul_f32 v13, 0x3fb8aa3b, v145
  v_mul_f32 v14, 0x3fb8aa3b, v146
  v_mul_f32 v15, 0x3fb8aa3b, v147
  v_exp_f32 v12, v12
  v_exp_f32 v13, v13
  v_exp_f32 v14, v14
  v_exp_f32 v15, v15
  v_cmp_lt_f32 vcc, 0, v144
  v_add_f32 v144, 1.0, v144
  s_nop 0
  v_cndmask_b32 v144, v12, v144, vcc
  v_cmp_lt_f32 vcc, 0, v145
  v_add_f32 v145, 1.0, v145
  s_nop 0
  v_cndmask_b32 v145, v13, v145, vcc
  v_cmp_lt_f32 vcc, 0, v146
  v_add_f32 v146, 1.0, v146
  s_nop 0
  v_cndmask_b32 v146, v14, v146, vcc
  v_cmp_lt_f32 vcc, 0, v147
  v_add_f32 v147, 1.0, v147
  s_nop 0
  v_cndmask_b32 v147, v15, v147, vcc
  v_cvt_pk_bf16_f32 v12, v144, v145
  v_cvt_pk_bf16_f32 v13, v146, v147
  v_lshlrev_b32 v144, 16, v12
  v_and_b32 v145, 0xffff0000, v12
  v_lshlrev_b32 v146, 16, v13
  v_and_b32 v147, 0xffff0000, v13
  v_add_f32 v144, 0x358637bd, v144
  v_add_f32 v145, 0x358637bd, v145
  v_add_f32 v146, 0x358637bd, v146
  v_add_f32 v147, 0x358637bd, v147
  v_cvt_pk_bf16_f32 v144, v144, v145
  v_cvt_pk_bf16_f32 v145, v146, v147
  v_cvt_pk_bf16_f32 v12, v148, v149
  v_cvt_pk_bf16_f32 v13, v150, v151
  v_lshlrev_b32 v148, 16, v12
  v_and_b32 v149, 0xffff0000, v12
  v_lshlrev_b32 v150, 16, v13
  v_and_b32 v151, 0xffff0000, v13
  v_mul_f32 v12, 0x3fb8aa3b, v148
  v_mul_f32 v13, 0x3fb8aa3b, v149
  v_mul_f32 v14, 0x3fb8aa3b, v150
  v_mul_f32 v15, 0x3fb8aa3b, v151
  v_exp_f32 v12, v12
  v_exp_f32 v13, v13
  v_exp_f32 v14, v14
  v_exp_f32 v15, v15
  v_cmp_lt_f32 vcc, 0, v148
  v_add_f32 v148, 1.0, v148
  s_nop 0
  v_cndmask_b32 v148, v12, v148, vcc
  v_cmp_lt_f32 vcc, 0, v149
  v_add_f32 v149, 1.0, v149
  s_nop 0
  v_cndmask_b32 v149, v13, v149, vcc
  v_cmp_lt_f32 vcc, 0, v150
  v_add_f32 v150, 1.0, v150
  s_nop 0
  v_cndmask_b32 v150, v14, v150, vcc
  v_cmp_lt_f32 vcc, 0, v151
  v_add_f32 v151, 1.0, v151
  s_nop 0
  v_cndmask_b32 v151, v15, v151, vcc
  v_cvt_pk_bf16_f32 v12, v148, v149
  v_cvt_pk_bf16_f32 v13, v150, v151
  v_lshlrev_b32 v148, 16, v12
  v_and_b32 v149, 0xffff0000, v12
  v_lshlrev_b32 v150, 16, v13
  v_and_b32 v151, 0xffff0000, v13
  v_add_f32 v148, 0x358637bd, v148
  v_add_f32 v149, 0x358637bd, v149
  v_add_f32 v150, 0x358637bd, v150
  v_add_f32 v151, 0x358637bd, v151
  v_cvt_pk_bf16_f32 v148, v148, v149
  v_cvt_pk_bf16_f32 v149, v150, v151
  v_mov_b64 v[146:147], v[148:149]
  v_cvt_pk_bf16_f32 v12, v152, v153
  v_cvt_pk_bf16_f32 v13, v154, v155
  v_lshlrev_b32 v152, 16, v12
  v_and_b32 v153, 0xffff0000, v12
  v_lshlrev_b32 v154, 16, v13
  v_and_b32 v155, 0xffff0000, v13
  v_mul_f32 v12, 0x3fb8aa3b, v152
  v_mul_f32 v13, 0x3fb8aa3b, v153
  v_mul_f32 v14, 0x3fb8aa3b, v154
  v_mul_f32 v15, 0x3fb8aa3b, v155
  v_exp_f32 v12, v12
  v_exp_f32 v13, v13
  v_exp_f32 v14, v14
  v_exp_f32 v15, v15
  v_cmp_lt_f32 vcc, 0, v152
  v_add_f32 v152, 1.0, v152
  s_nop 0
  v_cndmask_b32 v152, v12, v152, vcc
  v_cmp_lt_f32 vcc, 0, v153
  v_add_f32 v153, 1.0, v153
  s_nop 0
  v_cndmask_b32 v153, v13, v153, vcc
  v_cmp_lt_f32 vcc, 0, v154
  v_add_f32 v154, 1.0, v154
  s_nop 0
  v_cndmask_b32 v154, v14, v154, vcc
  v_cmp_lt_f32 vcc, 0, v155
  v_add_f32 v155, 1.0, v155
  s_nop 0
  v_cndmask_b32 v155, v15, v155, vcc
  v_cvt_pk_bf16_f32 v12, v152, v153
  v_cvt_pk_bf16_f32 v13, v154, v155
  v_lshlrev_b32 v152, 16, v12
  v_and_b32 v153, 0xffff0000, v12
  v_lshlrev_b32 v154, 16, v13
  v_and_b32 v155, 0xffff0000, v13
  v_add_f32 v152, 0x358637bd, v152
  v_add_f32 v153, 0x358637bd, v153
  v_add_f32 v154, 0x358637bd, v154
  v_add_f32 v155, 0x358637bd, v155
  v_cvt_pk_bf16_f32 v152, v152, v153
  v_cvt_pk_bf16_f32 v153, v154, v155
  v_cvt_pk_bf16_f32 v12, v156, v157
  v_cvt_pk_bf16_f32 v13, v158, v159
  v_lshlrev_b32 v156, 16, v12
  v_and_b32 v157, 0xffff0000, v12
  v_lshlrev_b32 v158, 16, v13
  v_and_b32 v159, 0xffff0000, v13
  v_mul_f32 v12, 0x3fb8aa3b, v156
  v_mul_f32 v13, 0x3fb8aa3b, v157
  v_mul_f32 v14, 0x3fb8aa3b, v158
  v_mul_f32 v15, 0x3fb8aa3b, v159
  v_exp_f32 v12, v12
  v_exp_f32 v13, v13
  v_exp_f32 v14, v14
  v_exp_f32 v15, v15
  v_cmp_lt_f32 vcc, 0, v156
  v_add_f32 v156, 1.0, v156
  s_nop 0
  v_cndmask_b32 v156, v12, v156, vcc
  v_cmp_lt_f32 vcc, 0, v157
  v_add_f32 v157, 1.0, v157
  s_nop 0
  v_cndmask_b32 v157, v13, v157, vcc
  v_cmp_lt_f32 vcc, 0, v158
  v_add_f32 v158, 1.0, v158
  s_nop 0
  v_cndmask_b32 v158, v14, v158, vcc
  v_cmp_lt_f32 vcc, 0, v159
  v_add_f32 v159, 1.0, v159
  s_nop 0
  v_cndmask_b32 v159, v15, v159, vcc
  v_cvt_pk_bf16_f32 v12, v156, v157
  v_cvt_pk_bf16_f32 v13, v158, v159
  v_lshlrev_b32 v156, 16, v12
  v_and_b32 v157, 0xffff0000, v12
  v_lshlrev_b32 v158, 16, v13
  v_and_b32 v159, 0xffff0000, v13
  v_add_f32 v156, 0x358637bd, v156
  v_add_f32 v157, 0x358637bd, v157
  v_add_f32 v158, 0x358637bd, v158
  v_add_f32 v159, 0x358637bd, v159
  v_cvt_pk_bf16_f32 v156, v156, v157
  v_cvt_pk_bf16_f32 v157, v158, v159
  v_mov_b64 v[154:155], v[156:157]
  v_cvt_pk_bf16_f32 v12, v160, v161
  v_cvt_pk_bf16_f32 v13, v162, v163
  v_lshlrev_b32 v160, 16, v12
  v_and_b32 v161, 0xffff0000, v12
  v_lshlrev_b32 v162, 16, v13
  v_and_b32 v163, 0xffff0000, v13
  v_mul_f32 v12, 0x3fb8aa3b, v160
  v_mul_f32 v13, 0x3fb8aa3b, v161
  v_mul_f32 v14, 0x3fb8aa3b, v162
  v_mul_f32 v15, 0x3fb8aa3b, v163
  v_exp_f32 v12, v12
  v_exp_f32 v13, v13
  v_exp_f32 v14, v14
  v_exp_f32 v15, v15
  v_cmp_lt_f32 vcc, 0, v160
  v_add_f32 v160, 1.0, v160
  s_nop 0
  v_cndmask_b32 v160, v12, v160, vcc
  v_cmp_lt_f32 vcc, 0, v161
  v_add_f32 v161, 1.0, v161
  s_nop 0
  v_cndmask_b32 v161, v13, v161, vcc
  v_cmp_lt_f32 vcc, 0, v162
  v_add_f32 v162, 1.0, v162
  s_nop 0
  v_cndmask_b32 v162, v14, v162, vcc
  v_cmp_lt_f32 vcc, 0, v163
  v_add_f32 v163, 1.0, v163
  s_nop 0
  v_cndmask_b32 v163, v15, v163, vcc
  v_cvt_pk_bf16_f32 v12, v160, v161
  v_cvt_pk_bf16_f32 v13, v162, v163
  v_lshlrev_b32 v160, 16, v12
  v_and_b32 v161, 0xffff0000, v12
  v_lshlrev_b32 v162, 16, v13
  v_and_b32 v163, 0xffff0000, v13
  v_add_f32 v160, 0x358637bd, v160
  v_add_f32 v161, 0x358637bd, v161
  v_add_f32 v162, 0x358637bd, v162
  v_add_f32 v163, 0x358637bd, v163
  v_cvt_pk_bf16_f32 v160, v160, v161
  v_cvt_pk_bf16_f32 v161, v162, v163
  v_cvt_pk_bf16_f32 v12, v164, v165
  v_cvt_pk_bf16_f32 v13, v166, v167
  v_lshlrev_b32 v164, 16, v12
  v_and_b32 v165, 0xffff0000, v12
  v_lshlrev_b32 v166, 16, v13
  v_and_b32 v167, 0xffff0000, v13
  v_mul_f32 v12, 0x3fb8aa3b, v164
  v_mul_f32 v13, 0x3fb8aa3b, v165
  v_mul_f32 v14, 0x3fb8aa3b, v166
  v_mul_f32 v15, 0x3fb8aa3b, v167
  v_exp_f32 v12, v12
  v_exp_f32 v13, v13
  v_exp_f32 v14, v14
  v_exp_f32 v15, v15
  v_cmp_lt_f32 vcc, 0, v164
  v_add_f32 v164, 1.0, v164
  s_nop 0
  v_cndmask_b32 v164, v12, v164, vcc
  v_cmp_lt_f32 vcc, 0, v165
  v_add_f32 v165, 1.0, v165
  s_nop 0
  v_cndmask_b32 v165, v13, v165, vcc
  v_cmp_lt_f32 vcc, 0, v166
  v_add_f32 v166, 1.0, v166
  s_nop 0
  v_cndmask_b32 v166, v14, v166, vcc
  v_cmp_lt_f32 vcc, 0, v167
  v_add_f32 v167, 1.0, v167
  s_nop 0
  v_cndmask_b32 v167, v15, v167, vcc
  v_cvt_pk_bf16_f32 v12, v164, v165
  v_cvt_pk_bf16_f32 v13, v166, v167
  v_lshlrev_b32 v164, 16, v12
  v_and_b32 v165, 0xffff0000, v12
  v_lshlrev_b32 v166, 16, v13
  v_and_b32 v167, 0xffff0000, v13
  v_add_f32 v164, 0x358637bd, v164
  v_add_f32 v165, 0x358637bd, v165
  v_add_f32 v166, 0x358637bd, v166
  v_add_f32 v167, 0x358637bd, v167
  v_cvt_pk_bf16_f32 v164, v164, v165
  v_cvt_pk_bf16_f32 v165, v166, v167
  v_mov_b64 v[162:163], v[164:165]
  v_cvt_pk_bf16_f32 v12, v168, v169
  v_cvt_pk_bf16_f32 v13, v170, v171
  v_lshlrev_b32 v168, 16, v12
  v_and_b32 v169, 0xffff0000, v12
  v_lshlrev_b32 v170, 16, v13
  v_and_b32 v171, 0xffff0000, v13
  v_mul_f32 v12, 0x3fb8aa3b, v168
  v_mul_f32 v13, 0x3fb8aa3b, v169
  v_mul_f32 v14, 0x3fb8aa3b, v170
  v_mul_f32 v15, 0x3fb8aa3b, v171
  v_exp_f32 v12, v12
  v_exp_f32 v13, v13
  v_exp_f32 v14, v14
  v_exp_f32 v15, v15
  v_cmp_lt_f32 vcc, 0, v168
  v_add_f32 v168, 1.0, v168
  s_nop 0
  v_cndmask_b32 v168, v12, v168, vcc
  v_cmp_lt_f32 vcc, 0, v169
  v_add_f32 v169, 1.0, v169
  s_nop 0
  v_cndmask_b32 v169, v13, v169, vcc
  v_cmp_lt_f32 vcc, 0, v170
  v_add_f32 v170, 1.0, v170
  s_nop 0
  v_cndmask_b32 v170, v14, v170, vcc
  v_cmp_lt_f32 vcc, 0, v171
  v_add_f32 v171, 1.0, v171
  s_nop 0
  v_cndmask_b32 v171, v15, v171, vcc
  v_cvt_pk_bf16_f32 v12, v168, v169
  v_cvt_pk_bf16_f32 v13, v170, v171
  v_lshlrev_b32 v168, 16, v12
  v_and_b32 v169, 0xffff0000, v12
  v_lshlrev_b32 v170, 16, v13
  v_and_b32 v171, 0xffff0000, v13
  v_add_f32 v168, 0x358637bd, v168
  v_add_f32 v169, 0x358637bd, v169
  v_add_f32 v170, 0x358637bd, v170
  v_add_f32 v171, 0x358637bd, v171
  v_cvt_pk_bf16_f32 v168, v168, v169
  v_cvt_pk_bf16_f32 v169, v170, v171
  v_cvt_pk_bf16_f32 v12, v172, v173
  v_cvt_pk_bf16_f32 v13, v174, v175
  v_lshlrev_b32 v172, 16, v12
  v_and_b32 v173, 0xffff0000, v12
  v_lshlrev_b32 v174, 16, v13
  v_and_b32 v175, 0xffff0000, v13
  v_mul_f32 v12, 0x3fb8aa3b, v172
  v_mul_f32 v13, 0x3fb8aa3b, v173
  v_mul_f32 v14, 0x3fb8aa3b, v174
  v_mul_f32 v15, 0x3fb8aa3b, v175
  v_exp_f32 v12, v12
  v_exp_f32 v13, v13
  v_exp_f32 v14, v14
  v_exp_f32 v15, v15
  v_cmp_lt_f32 vcc, 0, v172
  v_add_f32 v172, 1.0, v172
  s_nop 0
  v_cndmask_b32 v172, v12, v172, vcc
  v_cmp_lt_f32 vcc, 0, v173
  v_add_f32 v173, 1.0, v173
  s_nop 0
  v_cndmask_b32 v173, v13, v173, vcc
  v_cmp_lt_f32 vcc, 0, v174
  v_add_f32 v174, 1.0, v174
  s_nop 0
  v_cndmask_b32 v174, v14, v174, vcc
  v_cmp_lt_f32 vcc, 0, v175
  v_add_f32 v175, 1.0, v175
  s_nop 0
  v_cndmask_b32 v175, v15, v175, vcc
  v_cvt_pk_bf16_f32 v12, v172, v173
  v_cvt_pk_bf16_f32 v13, v174, v175
  v_lshlrev_b32 v172, 16, v12
  v_and_b32 v173, 0xffff0000, v12
  v_lshlrev_b32 v174, 16, v13
  v_and_b32 v175, 0xffff0000, v13
  v_add_f32 v172, 0x358637bd, v172
  v_add_f32 v173, 0x358637bd, v173
  v_add_f32 v174, 0x358637bd, v174
  v_add_f32 v175, 0x358637bd, v175
  v_cvt_pk_bf16_f32 v172, v172, v173
  v_cvt_pk_bf16_f32 v173, v174, v175
  v_mov_b64 v[170:171], v[172:173]
  v_cvt_pk_bf16_f32 v12, v176, v177
  v_cvt_pk_bf16_f32 v13, v178, v179
  v_lshlrev_b32 v176, 16, v12
  v_and_b32 v177, 0xffff0000, v12
  v_lshlrev_b32 v178, 16, v13
  v_and_b32 v179, 0xffff0000, v13
  v_mul_f32 v12, 0x3fb8aa3b, v176
  v_mul_f32 v13, 0x3fb8aa3b, v177
  v_mul_f32 v14, 0x3fb8aa3b, v178
  v_mul_f32 v15, 0x3fb8aa3b, v179
  v_exp_f32 v12, v12
  v_exp_f32 v13, v13
  v_exp_f32 v14, v14
  v_exp_f32 v15, v15
  v_cmp_lt_f32 vcc, 0, v176
  v_add_f32 v176, 1.0, v176
  s_nop 0
  v_cndmask_b32 v176, v12, v176, vcc
  v_cmp_lt_f32 vcc, 0, v177
  v_add_f32 v177, 1.0, v177
  s_nop 0
  v_cndmask_b32 v177, v13, v177, vcc
  v_cmp_lt_f32 vcc, 0, v178
  v_add_f32 v178, 1.0, v178
  s_nop 0
  v_cndmask_b32 v178, v14, v178, vcc
  v_cmp_lt_f32 vcc, 0, v179
  v_add_f32 v179, 1.0, v179
  s_nop 0
  v_cndmask_b32 v179, v15, v179, vcc
  v_cvt_pk_bf16_f32 v12, v176, v177
  v_cvt_pk_bf16_f32 v13, v178, v179
  v_lshlrev_b32 v176, 16, v12
  v_and_b32 v177, 0xffff0000, v12
  v_lshlrev_b32 v178, 16, v13
  v_and_b32 v179, 0xffff0000, v13
  v_add_f32 v176, 0x358637bd, v176
  v_add_f32 v177, 0x358637bd, v177
  v_add_f32 v178, 0x358637bd, v178
  v_add_f32 v179, 0x358637bd, v179
  v_cvt_pk_bf16_f32 v176, v176, v177
  v_cvt_pk_bf16_f32 v177, v178, v179
  v_cvt_pk_bf16_f32 v12, v180, v181
  v_cvt_pk_bf16_f32 v13, v182, v183
  v_lshlrev_b32 v180, 16, v12
  v_and_b32 v181, 0xffff0000, v12
  v_lshlrev_b32 v182, 16, v13
  v_and_b32 v183, 0xffff0000, v13
  v_mul_f32 v12, 0x3fb8aa3b, v180
  v_mul_f32 v13, 0x3fb8aa3b, v181
  v_mul_f32 v14, 0x3fb8aa3b, v182
  v_mul_f32 v15, 0x3fb8aa3b, v183
  v_exp_f32 v12, v12
  v_exp_f32 v13, v13
  v_exp_f32 v14, v14
  v_exp_f32 v15, v15
  v_cmp_lt_f32 vcc, 0, v180
  v_add_f32 v180, 1.0, v180
  s_nop 0
  v_cndmask_b32 v180, v12, v180, vcc
  v_cmp_lt_f32 vcc, 0, v181
  v_add_f32 v181, 1.0, v181
  s_nop 0
  v_cndmask_b32 v181, v13, v181, vcc
  v_cmp_lt_f32 vcc, 0, v182
  v_add_f32 v182, 1.0, v182
  s_nop 0
  v_cndmask_b32 v182, v14, v182, vcc
  v_cmp_lt_f32 vcc, 0, v183
  v_add_f32 v183, 1.0, v183
  s_nop 0
  v_cndmask_b32 v183, v15, v183, vcc
  v_cvt_pk_bf16_f32 v12, v180, v181
  v_cvt_pk_bf16_f32 v13, v182, v183
  v_lshlrev_b32 v180, 16, v12
  v_and_b32 v181, 0xffff0000, v12
  v_lshlrev_b32 v182, 16, v13
  v_and_b32 v183, 0xffff0000, v13
  v_add_f32 v180, 0x358637bd, v180
  v_add_f32 v181, 0x358637bd, v181
  v_add_f32 v182, 0x358637bd, v182
  v_add_f32 v183, 0x358637bd, v183
  v_cvt_pk_bf16_f32 v180, v180, v181
  v_cvt_pk_bf16_f32 v181, v182, v183
  v_mov_b64 v[178:179], v[180:181]
  v_cvt_pk_bf16_f32 v184, v184, v185
  v_cvt_pk_bf16_f32 v185, v186, v187
  v_cvt_pk_bf16_f32 v186, v188, v189
  v_cvt_pk_bf16_f32 v187, v190, v191
  v_cvt_pk_bf16_f32 v192, v192, v193
  v_cvt_pk_bf16_f32 v193, v194, v195
  v_cvt_pk_bf16_f32 v194, v196, v197
  v_cvt_pk_bf16_f32 v195, v198, v199
  v_cvt_pk_bf16_f32 v200, v200, v201
  v_cvt_pk_bf16_f32 v201, v202, v203
  v_cvt_pk_bf16_f32 v202, v204, v205
  v_cvt_pk_bf16_f32 v203, v206, v207
  v_cvt_pk_bf16_f32 v208, v208, v209
  v_cvt_pk_bf16_f32 v209, v210, v211
  v_cvt_pk_bf16_f32 v210, v212, v213
  v_cvt_pk_bf16_f32 v211, v214, v215
  v_cvt_pk_bf16_f32 v216, v216, v217
  v_cvt_pk_bf16_f32 v217, v218, v219
  v_cvt_pk_bf16_f32 v218, v220, v221
  v_cvt_pk_bf16_f32 v219, v222, v223
  v_cvt_pk_bf16_f32 v224, v224, v225
  v_cvt_pk_bf16_f32 v225, v226, v227
  v_cvt_pk_bf16_f32 v226, v228, v229
  v_cvt_pk_bf16_f32 v227, v230, v231
  v_cvt_pk_bf16_f32 v232, v232, v233
  v_cvt_pk_bf16_f32 v233, v234, v235
  v_cvt_pk_bf16_f32 v234, v236, v237
  v_cvt_pk_bf16_f32 v235, v238, v239
  v_cvt_pk_bf16_f32 v240, v240, v241
  v_cvt_pk_bf16_f32 v241, v242, v243
  v_cvt_pk_bf16_f32 v242, v244, v245
  v_cvt_pk_bf16_f32 v243, v246, v247
  v_cvt_pk_bf16_f32 v248, v248, v249
  v_cvt_pk_bf16_f32 v249, v250, v251
  v_cvt_pk_bf16_f32 v250, v252, v253
  v_cvt_pk_bf16_f32 v251, v254, v255
  v_mov_b32 v20, 0x3f803f80
  v_mov_b32 v21, 0x3f803f80
  v_mov_b32 v22, 0x3f803f80
  v_mov_b32 v23, 0x3f803f80
  v_mfma_f32_16x16x32_bf16 a[0:3], v[112:115], v[184:187], a[0:3]
  v_mfma_f32_16x16x32_bf16 a[4:7], v[120:123], v[192:195], a[4:7]
  v_mfma_f32_16x16x32_bf16 a[8:11], v[128:131], v[200:203], a[8:11]
  v_mfma_f32_16x16x32_bf16 a[12:15], v[136:139], v[208:211], a[12:15]
  v_mfma_f32_16x16x32_bf16 a[16:19], v[144:147], v[216:219], a[16:19]
  v_mfma_f32_16x16x32_bf16 a[20:23], v[152:155], v[224:227], a[20:23]
  v_mfma_f32_16x16x32_bf16 a[24:27], v[160:163], v[232:235], a[24:27]
  v_mfma_f32_16x16x32_bf16 a[28:31], v[168:171], v[240:243], a[28:31]
  v_mfma_f32_16x16x32_bf16 a[32:35], v[176:179], v[248:251], a[32:35]
  v_mfma_f32_16x16x32_bf16 a[36:39], v[112:115], v[192:195], a[36:39]
  v_mfma_f32_16x16x32_bf16 a[40:43], v[120:123], v[200:203], a[40:43]
  v_mfma_f32_16x16x32_bf16 a[44:47], v[128:131], v[208:211], a[44:47]
  v_mfma_f32_16x16x32_bf16 a[48:51], v[136:139], v[216:219], a[48:51]
  v_mfma_f32_16x16x32_bf16 a[52:55], v[144:147], v[224:227], a[52:55]
  v_mfma_f32_16x16x32_bf16 a[56:59], v[152:155], v[232:235], a[56:59]
  v_mfma_f32_16x16x32_bf16 a[60:63], v[160:163], v[240:243], a[60:63]
  v_mfma_f32_16x16x32_bf16 a[64:67], v[168:171], v[248:251], a[64:67]
  v_mfma_f32_16x16x32_bf16 a[68:71], v[120:123], v[184:187], a[68:71]
  v_mfma_f32_16x16x32_bf16 a[72:75], v[128:131], v[192:195], a[72:75]
  v_mfma_f32_16x16x32_bf16 a[76:79], v[136:139], v[200:203], a[76:79]
  v_mfma_f32_16x16x32_bf16 a[80:83], v[144:147], v[208:211], a[80:83]
  v_mfma_f32_16x16x32_bf16 a[84:87], v[152:155], v[216:219], a[84:87]
  v_mfma_f32_16x16x32_bf16 a[88:91], v[160:163], v[224:227], a[88:91]
  v_mfma_f32_16x16x32_bf16 a[92:95], v[168:171], v[232:235], a[92:95]
  v_mfma_f32_16x16x32_bf16 a[96:99], v[176:179], v[240:243], a[96:99]
  v_mfma_f32_16x16x32_bf16 a[100:103], v[112:115], v[20:23], a[100:103]
  v_mfma_f32_16x16x32_bf16 a[104:107], v[120:123], v[20:23], a[104:107]
  v_mfma_f32_16x16x32_bf16 a[108:111], v[128:131], v[20:23], a[108:111]
  v_mfma_f32_16x16x32_bf16 a[112:115], v[136:139], v[20:23], a[112:115]
  v_mfma_f32_16x16x32_bf16 a[116:119], v[144:147], v[20:23], a[116:119]
  v_mfma_f32_16x16x32_bf16 a[120:123], v[152:155], v[20:23], a[120:123]
  v_mfma_f32_16x16x32_bf16 a[124:127], v[160:163], v[20:23], a[124:127]
  v_mfma_f32_16x16x32_bf16 a[128:131], v[168:171], v[20:23], a[128:131]
  v_mfma_f32_16x16x32_bf16 a[132:135], v[176:179], v[20:23], a[132:135]
  s_add_u32 s45, s45, 1
  s_cmp_lt_u32 s45, 2
  s_cbranch_scc1 B1_RB
  s_mul_i32 s32, s29, 32
  s_lshl_b32 s33, s30, 2
  s_add_u32 s32, s32, s33
  s_add_u32 s32, s32, s28
  s_mul_i32 s32, s32, 34816
  s_add_u32 s32, s32, 88080384
  buffer_store_dwordx4 a[0:3], v1, s[16:19], s32 offen offset:0 sc1
  buffer_store_dwordx4 a[4:7], v1, s[16:19], s32 offen offset:1024 sc1
  buffer_store_dwordx4 a[8:11], v1, s[16:19], s32 offen offset:2048 sc1
  buffer_store_dwordx4 a[12:15], v1, s[16:19], s32 offen offset:3072 sc1
  s_add_u32 s32, s32, 4096
  buffer_store_dwordx4 a[16:19], v1, s[16:19], s32 offen offset:0 sc1
  buffer_store_dwordx4 a[20:23], v1, s[16:19], s32 offen offset:1024 sc1
  buffer_store_dwordx4 a[24:27], v1, s[16:19], s32 offen offset:2048 sc1
  buffer_store_dwordx4 a[28:31], v1, s[16:19], s32 offen offset:3072 sc1
  s_add_u32 s32, s32, 4096
  buffer_store_dwordx4 a[32:35], v1, s[16:19], s32 offen offset:0 sc1
  buffer_store_dwordx4 a[36:39], v1, s[16:19], s32 offen offset:1024 sc1
  buffer_store_dwordx4 a[40:43], v1, s[16:19], s32 offen offset:2048 sc1
  buffer_store_dwordx4 a[44:47], v1, s[16:19], s32 offen offset:3072 sc1
  s_add_u32 s32, s32, 4096
  buffer_store_dwordx4 a[48:51], v1, s[16:19], s32 offen offset:0 sc1
  buffer_store_dwordx4 a[52:55], v1, s[16:19], s32 offen offset:1024 sc1
  buffer_store_dwordx4 a[56:59], v1, s[16:19], s32 offen offset:2048 sc1
  buffer_store_dwordx4 a[60:63], v1, s[16:19], s32 offen offset:3072 sc1
  s_add_u32 s32, s32, 4096
  buffer_store_dwordx4 a[64:67], v1, s[16:19], s32 offen offset:0 sc1
  buffer_store_dwordx4 a[68:71], v1, s[16:19], s32 offen offset:1024 sc1
  buffer_store_dwordx4 a[72:75], v1, s[16:19], s32 offen offset:2048 sc1
  buffer_store_dwordx4 a[76:79], v1, s[16:19], s32 offen offset:3072 sc1
  s_add_u32 s32, s32, 4096
  buffer_store_dwordx4 a[80:83], v1, s[16:19], s32 offen offset:0 sc1
  buffer_store_dwordx4 a[84:87], v1, s[16:19], s32 offen offset:1024 sc1
  buffer_store_dwordx4 a[88:91], v1, s[16:19], s32 offen offset:2048 sc1
  buffer_store_dwordx4 a[92:95], v1, s[16:19], s32 offen offset:3072 sc1
  s_add_u32 s32, s32, 4096
  buffer_store_dwordx4 a[96:99], v1, s[16:19], s32 offen offset:0 sc1
  buffer_store_dwordx4 a[100:103], v1, s[16:19], s32 offen offset:1024 sc1
  buffer_store_dwordx4 a[104:107], v1, s[16:19], s32 offen offset:2048 sc1
  buffer_store_dwordx4 a[108:111], v1, s[16:19], s32 offen offset:3072 sc1
  s_add_u32 s32, s32, 4096
  buffer_store_dwordx4 a[112:115], v1, s[16:19], s32 offen offset:0 sc1
  buffer_store_dwordx4 a[116:119], v1, s[16:19], s32 offen offset:1024 sc1
  buffer_store_dwordx4 a[120:123], v1, s[16:19], s32 offen offset:2048 sc1
  buffer_store_dwordx4 a[124:127], v1, s[16:19], s32 offen offset:3072 sc1
  s_add_u32 s32, s32, 4096
  buffer_store_dwordx4 a[128:131], v1, s[16:19], s32 offen offset:0 sc1
  buffer_store_dwordx4 a[132:135], v1, s[16:19], s32 offen offset:1024 sc1
  s_waitcnt vmcnt(0)
  s_barrier
  s_cmp_eq_u32 s28, 0
  s_cbranch_scc0 B1sig_22
  v_mov_b32 v10, 72
  v_mov_b32 v11, 1
  s_mov_b64 exec, 1
  buffer_atomic_add v11, v10, s[20:23], 0 offen sc1
  s_mov_b64 exec, -1
B1sig_22:
  v_mbcnt_lo_u32_b32 v0, -1, 0
  v_mbcnt_hi_u32_b32 v0, -1, v0
  s_cmp_lt_u32 s94, 25
  s_cbranch_scc0 L_B2
  v_mov_b32 v10, 72
  s_mov_b32 s32, 0
BRW_23:
  s_mov_b64 exec, 1
  buffer_load_dword v11, v10, s[20:23], 0 offen sc1
  s_mov_b64 exec, -1
  s_waitcnt vmcnt(0)
  v_readfirstlane_b32 s33, v11
  s_add_u32 s32, s32, 1
  s_cmp_ge_u32 s32, 400000
  s_cbranch_scc1 BRW_23x
  s_cmp_ge_u32 s33, 32
  s_cbranch_scc1 BRW_23x
  s_sleep 64
  s_branch BRW_23
BRW_23x:
  s_mov_b32 s34, s94
  s_mov_b32 s35, s94
  s_cmp_lt_u32 s94, 9
  s_cbranch_scc1 BR_24
  s_sub_u32 s34, s94, 9
  s_sub_u32 s35, s94, 8
  s_cmp_lt_u32 s94, 17
  s_cbranch_scc1 BR_24
  s_sub_u32 s34, s94, 16
  s_sub_u32 s35, s94, 17
BR_24:
  v_lshlrev_b32 v1, 4, v0
  s_mul_i32 s32, s28, 1114112
  s_add_u32 s32, s32, 88080384
  s_lshl_b32 s33, s94, 10
  s_add_u32 s33, s33, s32
  s_add_u32 s36, s34, 25
  s_lshl_b32 s36, s36, 10
  s_add_u32 s36, s36, s32
  buffer_load_dwordx4 v[100:103], v1, s[16:19], s33 offen sc1
  s_add_u32 s33, s33, 34816
  buffer_load_dwordx4 v[104:107], v1, s[16:19], s33 offen sc1
  s_add_u32 s33, s33, 34816
  buffer_load_dwordx4 v[108:111], v1, s[16:19], s33 offen sc1
  s_add_u32 s33, s33, 34816
  buffer_load_dwordx4 v[112:115], v1, s[16:19], s33 offen sc1
  s_add_u32 s33, s33, 34816
  buffer_load_dwordx4 v[116:119], v1, s[16:19], s33 offen sc1
  s_add_u32 s33, s33, 34816
  buffer_load_dwordx4 v[120:123], v1, s[16:19], s33 offen sc1
  s_add_u32 s33, s33, 34816
  buffer_load_dwordx4 v[124:127], v1, s[16:19], s33 offen sc1
  s_add_u32 s33, s33, 34816
  buffer_load_dwordx4 v[128:131], v1, s[16:19], s33 offen sc1
  s_add_u32 s33, s33, 34816
  buffer_load_dwordx4 v[132:135], v1, s[16:19], s33 offen sc1
  s_add_u32 s33, s33, 34816
  buffer_load_dwordx4 v[136:139], v1, s[16:19], s33 offen sc1
  s_add_u32 s33, s33, 34816
  buffer_load_dwordx4 v[140:143], v1, s[16:19], s33 offen sc1
  s_add_u32 s33, s33, 34816
  buffer_load_dwordx4 v[144:147], v1, s[16:19], s33 offen sc1
  s_add_u32 s33, s33, 34816
  buffer_load_dwordx4 v[148:151], v1, s[16:19], s33 offen sc1
  s_add_u32 s33, s33, 34816
  buffer_load_dwordx4 v[152:155], v1, s[16:19], s33 offen sc1
  s_add_u32 s33, s33, 34816
  buffer_load_dwordx4 v[156:159], v1, s[16:19], s33 offen sc1
  s_add_u32 s33, s33, 34816
  buffer_load_dwordx4 v[160:163], v1, s[16:19], s33 offen sc1
  s_add_u32 s33, s33, 34816
  buffer_load_dwordx4 v[164:167], v1, s[16:19], s33 offen sc1
  s_add_u32 s33, s33, 34816
  buffer_load_dwordx4 v[168:171], v1, s[16:19], s33 offen sc1
  s_add_u32 s33, s33, 34816
  buffer_load_dwordx4 v[172:175], v1, s[16:19], s33 offen sc1
  s_add_u32 s33, s33, 34816
  buffer_load_dwordx4 v[176:179], v1, s[16:19], s33 offen sc1
  s_add_u32 s33, s33, 34816
  buffer_load_dwordx4 v[180:183], v1, s[16:19], s33 offen sc1
  s_add_u32 s33, s33, 34816
  buffer_load_dwordx4 v[184:187], v1, s[16:19], s33 offen sc1
  s_add_u32 s33, s33, 34816
  buffer_load_dwordx4 v[188:191], v1, s[16:19], s33 offen sc1
  s_add_u32 s33, s33, 34816
  buffer_load_dwordx4 v[192:195], v1, s[16:19], s33 offen sc1
  s_add_u32 s33, s33, 34816
  buffer_load_dwordx4 v[196:199], v1, s[16:19], s33 offen sc1
  s_add_u32 s33, s33, 34816
  buffer_load_dwordx4 v[200:203], v1, s[16:19], s33 offen sc1
  s_add_u32 s33, s33, 34816
  buffer_load_dwordx4 v[204:207], v1, s[16:19], s33 offen sc1
  s_add_u32 s33, s33, 34816
  buffer_load_dwordx4 v[208:211], v1, s[16:19], s33 offen sc1
  s_add_u32 s33, s33, 34816
  buffer_load_dwordx4 v[212:215], v1, s[16:19], s33 offen sc1
  s_add_u32 s33, s33, 34816
  buffer_load_dwordx4 v[216:219], v1, s[16:19], s33 offen sc1
  s_add_u32 s33, s33, 34816
  buffer_load_dwordx4 v[220:223], v1, s[16:19], s33 offen sc1
  s_add_u32 s33, s33, 34816
  buffer_load_dwordx4 v[224:227], v1, s[16:19], s33 offen sc1
  s_waitcnt vmcnt(31)
  v_mov_b64 v[16:17], v[100:101]
  v_mov_b64 v[18:19], v[102:103]
  s_waitcnt vmcnt(30)
  v_pk_add_f32 v[16:17], v[16:17], v[104:105]
  v_pk_add_f32 v[18:19], v[18:19], v[106:107]
  s_waitcnt vmcnt(29)
  v_pk_add_f32 v[16:17], v[16:17], v[108:109]
  v_pk_add_f32 v[18:19], v[18:19], v[110:111]
  s_waitcnt vmcnt(28)
  v_pk_add_f32 v[16:17], v[16:17], v[112:113]
  v_pk_add_f32 v[18:19], v[18:19], v[114:115]
  s_waitcnt vmcnt(27)
  v_pk_add_f32 v[16:17], v[16:17], v[116:117]
  v_pk_add_f32 v[18:19], v[18:19], v[118:119]
  s_waitcnt vmcnt(26)
  v_pk_add_f32 v[16:17], v[16:17], v[120:121]
  v_pk_add_f32 v[18:19], v[18:19], v[122:123]
  s_waitcnt vmcnt(25)
  v_pk_add_f32 v[16:17], v[16:17], v[124:125]
  v_pk_add_f32 v[18:19], v[18:19], v[126:127]
  s_waitcnt vmcnt(24)
  v_pk_add_f32 v[16:17], v[16:17], v[128:129]
  v_pk_add_f32 v[18:19], v[18:19], v[130:131]
  s_waitcnt vmcnt(23)
  v_pk_add_f32 v[16:17], v[16:17], v[132:133]
  v_pk_add_f32 v[18:19], v[18:19], v[134:135]
  s_waitcnt vmcnt(22)
  v_pk_add_f32 v[16:17], v[16:17], v[136:137]
  v_pk_add_f32 v[18:19], v[18:19], v[138:139]
  s_waitcnt vmcnt(21)
  v_pk_add_f32 v[16:17], v[16:17], v[140:141]
  v_pk_add_f32 v[18:19], v[18:19], v[142:143]
  s_waitcnt vmcnt(20)
  v_pk_add_f32 v[16:17], v[16:17], v[144:145]
  v_pk_add_f32 v[18:19], v[18:19], v[146:147]
  s_waitcnt vmcnt(19)
  v_pk_add_f32 v[16:17], v[16:17], v[148:149]
  v_pk_add_f32 v[18:19], v[18:19], v[150:151]
  s_waitcnt vmcnt(18)
  v_pk_add_f32 v[16:17], v[16:17], v[152:153]
  v_pk_add_f32 v[18:19], v[18:19], v[154:155]
  s_waitcnt vmcnt(17)
  v_pk_add_f32 v[16:17], v[16:17], v[156:157]
  v_pk_add_f32 v[18:19], v[18:19], v[158:159]
  s_waitcnt vmcnt(16)
  v_pk_add_f32 v[16:17], v[16:17], v[160:161]
  v_pk_add_f32 v[18:19], v[18:19], v[162:163]
  s_waitcnt vmcnt(15)
  v_pk_add_f32 v[16:17], v[16:17], v[164:165]
  v_pk_add_f32 v[18:19], v[18:19], v[166:167]
  s_waitcnt vmcnt(14)
  v_pk_add_f32 v[16:17], v[16:17], v[168:169]
  v_pk_add_f32 v[18:19], v[18:19], v[170:171]
  s_waitcnt vmcnt(13)
  v_pk_add_f32 v[16:17], v[16:17], v[172:173]
  v_pk_add_f32 v[18:19], v[18:19], v[174:175]
  s_waitcnt vmcnt(12)
  v_pk_add_f32 v[16:17], v[16:17], v[176:177]
  v_pk_add_f32 v[18:19], v[18:19], v[178:179]
  s_waitcnt vmcnt(11)
  v_pk_add_f32 v[16:17], v[16:17], v[180:181]
  v_pk_add_f32 v[18:19], v[18:19], v[182:183]
  s_waitcnt vmcnt(10)
  v_pk_add_f32 v[16:17], v[16:17], v[184:185]
  v_pk_add_f32 v[18:19], v[18:19], v[186:187]
  s_waitcnt vmcnt(9)
  v_pk_add_f32 v[16:17], v[16:17], v[188:189]
  v_pk_add_f32 v[18:19], v[18:19], v[190:191]
  s_waitcnt vmcnt(8)
  v_pk_add_f32 v[16:17], v[16:17], v[192:193]
  v_pk_add_f32 v[18:19], v[18:19], v[194:195]
  s_waitcnt vmcnt(7)
  v_pk_add_f32 v[16:17], v[16:17], v[196:197]
  v_pk_add_f32 v[18:19], v[18:19], v[198:199]
  s_waitcnt vmcnt(6)
  v_pk_add_f32 v[16:17], v[16:17], v[200:201]
  v_pk_add_f32 v[18:19], v[18:19], v[202:203]
  s_waitcnt vmcnt(5)
  v_pk_add_f32 v[16:17], v[16:17], v[204:205]
  v_pk_add_f32 v[18:19], v[18:19], v[206:207]
  s_waitcnt vmcnt(4)
  v_pk_add_f32 v[16:17], v[16:17], v[208:209]
  v_pk_add_f32 v[18:19], v[18:19], v[210:211]
  s_waitcnt vmcnt(3)
  v_pk_add_f32 v[16:17], v[16:17], v[212:213]
  v_pk_add_f32 v[18:19], v[18:19], v[214:215]
  s_waitcnt vmcnt(2)
  v_pk_add_f32 v[16:17], v[16:17], v[216:217]
  v_pk_add_f32 v[18:19], v[18:19], v[218:219]
  s_waitcnt vmcnt(1)
  v_pk_add_f32 v[16:17], v[16:17], v[220:221]
  v_pk_add_f32 v[18:19], v[18:19], v[222:223]
  s_waitcnt vmcnt(0)
  v_pk_add_f32 v[16:17], v[16:17], v[224:225]
  v_pk_add_f32 v[18:19], v[18:19], v[226:227]
  buffer_load_dwordx4 v[100:103], v1, s[16:19], s36 offen sc1
  s_add_u32 s36, s36, 34816
  buffer_load_dwordx4 v[104:107], v1, s[16:19], s36 offen sc1
  s_add_u32 s36, s36, 34816
  buffer_load_dwordx4 v[108:111], v1, s[16:19], s36 offen sc1
  s_add_u32 s36, s36, 34816
  buffer_load_dwordx4 v[112:115], v1, s[16:19], s36 offen sc1
  s_add_u32 s36, s36, 34816
  buffer_load_dwordx4 v[116:119], v1, s[16:19], s36 offen sc1
  s_add_u32 s36, s36, 34816
  buffer_load_dwordx4 v[120:123], v1, s[16:19], s36 offen sc1
  s_add_u32 s36, s36, 34816
  buffer_load_dwordx4 v[124:127], v1, s[16:19], s36 offen sc1
  s_add_u32 s36, s36, 34816
  buffer_load_dwordx4 v[128:131], v1, s[16:19], s36 offen sc1
  s_add_u32 s36, s36, 34816
  buffer_load_dwordx4 v[132:135], v1, s[16:19], s36 offen sc1
  s_add_u32 s36, s36, 34816
  buffer_load_dwordx4 v[136:139], v1, s[16:19], s36 offen sc1
  s_add_u32 s36, s36, 34816
  buffer_load_dwordx4 v[140:143], v1, s[16:19], s36 offen sc1
  s_add_u32 s36, s36, 34816
  buffer_load_dwordx4 v[144:147], v1, s[16:19], s36 offen sc1
  s_add_u32 s36, s36, 34816
  buffer_load_dwordx4 v[148:151], v1, s[16:19], s36 offen sc1
  s_add_u32 s36, s36, 34816
  buffer_load_dwordx4 v[152:155], v1, s[16:19], s36 offen sc1
  s_add_u32 s36, s36, 34816
  buffer_load_dwordx4 v[156:159], v1, s[16:19], s36 offen sc1
  s_add_u32 s36, s36, 34816
  buffer_load_dwordx4 v[160:163], v1, s[16:19], s36 offen sc1
  s_add_u32 s36, s36, 34816
  buffer_load_dwordx4 v[164:167], v1, s[16:19], s36 offen sc1
  s_add_u32 s36, s36, 34816
  buffer_load_dwordx4 v[168:171], v1, s[16:19], s36 offen sc1
  s_add_u32 s36, s36, 34816
  buffer_load_dwordx4 v[172:175], v1, s[16:19], s36 offen sc1
  s_add_u32 s36, s36, 34816
  buffer_load_dwordx4 v[176:179], v1, s[16:19], s36 offen sc1
  s_add_u32 s36, s36, 34816
  buffer_load_dwordx4 v[180:183], v1, s[16:19], s36 offen sc1
  s_add_u32 s36, s36, 34816
  buffer_load_dwordx4 v[184:187], v1, s[16:19], s36 offen sc1
  s_add_u32 s36, s36, 34816
  buffer_load_dwordx4 v[188:191], v1, s[16:19], s36 offen sc1
  s_add_u32 s36, s36, 34816
  buffer_load_dwordx4 v[192:195], v1, s[16:19], s36 offen sc1
  s_add_u32 s36, s36, 34816
  buffer_load_dwordx4 v[196:199], v1, s[16:19], s36 offen sc1
  s_add_u32 s36, s36, 34816
  buffer_load_dwordx4 v[200:203], v1, s[16:19], s36 offen sc1
  s_add_u32 s36, s36, 34816
  buffer_load_dwordx4 v[204:207], v1, s[16:19], s36 offen sc1
  s_add_u32 s36, s36, 34816
  buffer_load_dwordx4 v[208:211], v1, s[16:19], s36 offen sc1
  s_add_u32 s36, s36, 34816
  buffer_load_dwordx4 v[212:215], v1, s[16:19], s36 offen sc1
  s_add_u32 s36, s36, 34816
  buffer_load_dwordx4 v[216:219], v1, s[16:19], s36 offen sc1
  s_add_u32 s36, s36, 34816
  buffer_load_dwordx4 v[220:223], v1, s[16:19], s36 offen sc1
  s_add_u32 s36, s36, 34816
  buffer_load_dwordx4 v[224:227], v1, s[16:19], s36 offen sc1
  s_waitcnt vmcnt(31)
  v_mov_b64 v[80:81], v[100:101]
  v_mov_b64 v[82:83], v[102:103]
  s_waitcnt vmcnt(30)
  v_pk_add_f32 v[80:81], v[80:81], v[104:105]
  v_pk_add_f32 v[82:83], v[82:83], v[106:107]
  s_waitcnt vmcnt(29)
  v_pk_add_f32 v[80:81], v[80:81], v[108:109]
  v_pk_add_f32 v[82:83], v[82:83], v[110:111]
  s_waitcnt vmcnt(28)
  v_pk_add_f32 v[80:81], v[80:81], v[112:113]
  v_pk_add_f32 v[82:83], v[82:83], v[114:115]
  s_waitcnt vmcnt(27)
  v_pk_add_f32 v[80:81], v[80:81], v[116:117]
  v_pk_add_f32 v[82:83], v[82:83], v[118:119]
  s_waitcnt vmcnt(26)
  v_pk_add_f32 v[80:81], v[80:81], v[120:121]
  v_pk_add_f32 v[82:83], v[82:83], v[122:123]
  s_waitcnt vmcnt(25)
  v_pk_add_f32 v[80:81], v[80:81], v[124:125]
  v_pk_add_f32 v[82:83], v[82:83], v[126:127]
  s_waitcnt vmcnt(24)
  v_pk_add_f32 v[80:81], v[80:81], v[128:129]
  v_pk_add_f32 v[82:83], v[82:83], v[130:131]
  s_waitcnt vmcnt(23)
  v_pk_add_f32 v[80:81], v[80:81], v[132:133]
  v_pk_add_f32 v[82:83], v[82:83], v[134:135]
  s_waitcnt vmcnt(22)
  v_pk_add_f32 v[80:81], v[80:81], v[136:137]
  v_pk_add_f32 v[82:83], v[82:83], v[138:139]
  s_waitcnt vmcnt(21)
  v_pk_add_f32 v[80:81], v[80:81], v[140:141]
  v_pk_add_f32 v[82:83], v[82:83], v[142:143]
  s_waitcnt vmcnt(20)
  v_pk_add_f32 v[80:81], v[80:81], v[144:145]
  v_pk_add_f32 v[82:83], v[82:83], v[146:147]
  s_waitcnt vmcnt(19)
  v_pk_add_f32 v[80:81], v[80:81], v[148:149]
  v_pk_add_f32 v[82:83], v[82:83], v[150:151]
  s_waitcnt vmcnt(18)
  v_pk_add_f32 v[80:81], v[80:81], v[152:153]
  v_pk_add_f32 v[82:83], v[82:83], v[154:155]
  s_waitcnt vmcnt(17)
  v_pk_add_f32 v[80:81], v[80:81], v[156:157]
  v_pk_add_f32 v[82:83], v[82:83], v[158:159]
  s_waitcnt vmcnt(16)
  v_pk_add_f32 v[80:81], v[80:81], v[160:161]
  v_pk_add_f32 v[82:83], v[82:83], v[162:163]
  s_waitcnt vmcnt(15)
  v_pk_add_f32 v[80:81], v[80:81], v[164:165]
  v_pk_add_f32 v[82:83], v[82:83], v[166:167]
  s_waitcnt vmcnt(14)
  v_pk_add_f32 v[80:81], v[80:81], v[168:169]
  v_pk_add_f32 v[82:83], v[82:83], v[170:171]
  s_waitcnt vmcnt(13)
  v_pk_add_f32 v[80:81], v[80:81], v[172:173]
  v_pk_add_f32 v[82:83], v[82:83], v[174:175]
  s_waitcnt vmcnt(12)
  v_pk_add_f32 v[80:81], v[80:81], v[176:177]
  v_pk_add_f32 v[82:83], v[82:83], v[178:179]
  s_waitcnt vmcnt(11)
  v_pk_add_f32 v[80:81], v[80:81], v[180:181]
  v_pk_add_f32 v[82:83], v[82:83], v[182:183]
  s_waitcnt vmcnt(10)
  v_pk_add_f32 v[80:81], v[80:81], v[184:185]
  v_pk_add_f32 v[82:83], v[82:83], v[186:187]
  s_waitcnt vmcnt(9)
  v_pk_add_f32 v[80:81], v[80:81], v[188:189]
  v_pk_add_f32 v[82:83], v[82:83], v[190:191]
  s_waitcnt vmcnt(8)
  v_pk_add_f32 v[80:81], v[80:81], v[192:193]
  v_pk_add_f32 v[82:83], v[82:83], v[194:195]
  s_waitcnt vmcnt(7)
  v_pk_add_f32 v[80:81], v[80:81], v[196:197]
  v_pk_add_f32 v[82:83], v[82:83], v[198:199]
  s_waitcnt vmcnt(6)
  v_pk_add_f32 v[80:81], v[80:81], v[200:201]
  v_pk_add_f32 v[82:83], v[82:83], v[202:203]
  s_waitcnt vmcnt(5)
  v_pk_add_f32 v[80:81], v[80:81], v[204:205]
  v_pk_add_f32 v[82:83], v[82:83], v[206:207]
  s_waitcnt vmcnt(4)
  v_pk_add_f32 v[80:81], v[80:81], v[208:209]
  v_pk_add_f32 v[82:83], v[82:83], v[210:211]
  s_waitcnt vmcnt(3)
  v_pk_add_f32 v[80:81], v[80:81], v[212:213]
  v_pk_add_f32 v[82:83], v[82:83], v[214:215]
  s_waitcnt vmcnt(2)
  v_pk_add_f32 v[80:81], v[80:81], v[216:217]
  v_pk_add_f32 v[82:83], v[82:83], v[218:219]
  s_waitcnt vmcnt(1)
  v_pk_add_f32 v[80:81], v[80:81], v[220:221]
  v_pk_add_f32 v[82:83], v[82:83], v[222:223]
  s_waitcnt vmcnt(0)
  v_pk_add_f32 v[80:81], v[80:81], v[224:225]
  v_pk_add_f32 v[82:83], v[82:83], v[226:227]
  v_and_b32 v2, 15, v0
  s_lshl_b32 s32, s35, 4
  v_add_u32 v2, s32, v2
  v_mul_u32_u24 v2, 3641, v2
  v_lshrrev_b32 v2, 16, v2
  v_lshrrev_b32 v3, 4, v0
  v_lshlrev_b32 v3, 2, v3
  s_lshl_b32 s32, s34, 4
  v_add_u32 v3, s32, v3
  v_add_u32 v4, 0, v3
  v_mul_u32_u24 v4, 3641, v4
  v_lshrrev_b32 v4, 16, v4
  v_cmp_eq_u32 vcc, v4, v2
  s_nop 1
  v_cndmask_b32 v16, 0, v16, vcc
  v_cndmask_b32 v80, 0, v80, vcc
  v_add_u32 v4, 1, v3
  v_mul_u32_u24 v4, 3641, v4
  v_lshrrev_b32 v4, 16, v4
  v_cmp_eq_u32 vcc, v4, v2
  s_nop 1
  v_cndmask_b32 v17, 0, v17, vcc
  v_cndmask_b32 v81, 0, v81, vcc
  v_add_u32 v4, 2, v3
  v_mul_u32_u24 v4, 3641, v4
  v_lshrrev_b32 v4, 16, v4
  v_cmp_eq_u32 vcc, v4, v2
  s_nop 1
  v_cndmask_b32 v18, 0, v18, vcc
  v_cndmask_b32 v82, 0, v82, vcc
  v_add_u32 v4, 3, v3
  v_mul_u32_u24 v4, 3641, v4
  v_lshrrev_b32 v4, 16, v4
  v_cmp_eq_u32 vcc, v4, v2
  s_nop 1
  v_cndmask_b32 v19, 0, v19, vcc
  v_cndmask_b32 v83, 0, v83, vcc
  v_cvt_pk_bf16_f32 v16, v16, v17
  v_cvt_pk_bf16_f32 v17, v18, v19
  v_cvt_pk_bf16_f32 v18, v80, v81
  v_cvt_pk_bf16_f32 v19, v82, v83
  v_lshlrev_b32 v1, 3, v0
  s_mul_i32 s32, s28, 25
  s_add_u32 s32, s32, s94
  s_lshl_b32 s32, s32, 10
  s_add_u32 s32, s32, 93323264
  buffer_store_dwordx2 v[16:17], v1, s[16:19], s32 offen sc1
  buffer_store_dwordx2 v[18:19], v1, s[16:19], s32 offen offset:512 sc1
  s_waitcnt vmcnt(0)
  s_barrier
  s_cmp_eq_u32 s28, 0
  s_cbranch_scc0 BRsig_25
  v_mov_b32 v10, 76
  v_mov_b32 v11, 1
  s_mov_b64 exec, 1
  buffer_atomic_add v11, v10, s[20:23], 0 offen sc1
  s_mov_b64 exec, -1
BRsig_25:
L_B2:
  s_load_dwordx2 s[12:13], s[70:71], 72
  s_load_dwordx2 s[24:25], s[70:71], 80
  s_waitcnt lgkmcnt(0)
  s_mov_b32 s14, 663552
  s_mov_b32 s15, 0x00020000
  s_mov_b32 s26, 4718592
  s_mov_b32 s27, 0x00020000
  v_mbcnt_lo_u32_b32 v0, -1, 0
  v_mbcnt_hi_u32_b32 v0, -1, v0
  v_mov_b32 v10, 76
  s_mov_b32 s32, 0
B2W_26:
  s_mov_b64 exec, 1
  buffer_load_dword v11, v10, s[20:23], 0 offen sc1
  s_mov_b64 exec, -1
  s_waitcnt vmcnt(0)
  v_readfirstlane_b32 s33, v11
  s_add_u32 s32, s32, 1
  s_cmp_ge_u32 s32, 400000
  s_cbranch_scc1 B2W_26x
  s_cmp_ge_u32 s33, 25
  s_cbranch_scc1 B2W_26x
  s_sleep 64
  s_branch B2W_26
B2W_26x:
  v_lshlrev_b32 v1, 3, v0
  v_lshlrev_b32 v2, 4, v0
  s_lshl_b32 s32, s94, 2
  s_add_u32 s32, s32, s28
  s_mul_i32 s32, s32, 18432
  s_add_u32 s32, s32, 83886080
  buffer_load_dwordx2 v[16:17], v1, s[16:19], s32 offen offset:0 sc1
  buffer_load_dwordx2 v[18:19], v1, s[16:19], s32 offen offset:512 sc1
  buffer_load_dwordx2 v[20:21], v1, s[16:19], s32 offen offset:1024 sc1
  buffer_load_dwordx2 v[22:23], v1, s[16:19], s32 offen offset:1536 sc1
  buffer_load_dwordx2 v[24:25], v1, s[16:19], s32 offen offset:2048 sc1
  buffer_load_dwordx2 v[26:27], v1, s[16:19], s32 offen offset:2560 sc1
  buffer_load_dwordx2 v[28:29], v1, s[16:19], s32 offen offset:3072 sc1
  buffer_load_dwordx2 v[30:31], v1, s[16:19], s32 offen offset:3584 sc1
  s_add_u32 s32, s32, 4096
  buffer_load_dwordx2 v[32:33], v1, s[16:19], s32 offen offset:0 sc1
  buffer_load_dwordx2 v[34:35], v1, s[16:19], s32 offen offset:512 sc1
  buffer_load_dwordx2 v[36:37], v1, s[16:19], s32 offen offset:1024 sc1
  buffer_load_dwordx2 v[38:39], v1, s[16:19], s32 offen offset:1536 sc1
  buffer_load_dwordx2 v[40:41], v1, s[16:19], s32 offen offset:2048 sc1
  buffer_load_dwordx2 v[42:43], v1, s[16:19], s32 offen offset:2560 sc1
  buffer_load_dwordx2 v[44:45], v1, s[16:19], s32 offen offset:3072 sc1
  buffer_load_dwordx2 v[46:47], v1, s[16:19], s32 offen offset:3584 sc1
  s_add_u32 s32, s32, 4096
  buffer_load_dwordx2 v[48:49], v1, s[16:19], s32 offen offset:0 sc1
  buffer_load_dwordx2 v[50:51], v1, s[16:19], s32 offen offset:512 sc1
  buffer_load_dwordx2 v[52:53], v1, s[16:19], s32 offen offset:1024 sc1
  buffer_load_dwordx2 v[54:55], v1, s[16:19], s32 offen offset:1536 sc1
  buffer_load_dwordx2 v[56:57], v1, s[16:19], s32 offen offset:2048 sc1
  buffer_load_dwordx2 v[58:59], v1, s[16:19], s32 offen offset:2560 sc1
  buffer_load_dwordx2 v[60:61], v1, s[16:19], s32 offen offset:3072 sc1
  buffer_load_dwordx2 v[62:63], v1, s[16:19], s32 offen offset:3584 sc1
  s_add_u32 s32, s32, 4096
  buffer_load_dwordx2 v[64:65], v1, s[16:19], s32 offen offset:0 sc1
  buffer_load_dwordx2 v[66:67], v1, s[16:19], s32 offen offset:512 sc1
  buffer_load_dwordx2 v[68:69], v1, s[16:19], s32 offen offset:1024 sc1
  buffer_load_dwordx2 v[70:71], v1, s[16:19], s32 offen offset:1536 sc1
  buffer_load_dwordx2 v[72:73], v1, s[16:19], s32 offen offset:2048 sc1
  buffer_load_dwordx2 v[74:75], v1, s[16:19], s32 offen offset:2560 sc1
  buffer_load_dwordx2 v[76:77], v1, s[16:19], s32 offen offset:3072 sc1
  buffer_load_dwordx2 v[78:79], v1, s[16:19], s32 offen offset:3584 sc1
  s_add_u32 s32, s32, 4096
  buffer_load_dwordx2 v[80:81], v1, s[16:19], s32 offen offset:0 sc1
  buffer_load_dwordx2 v[82:83], v1, s[16:19], s32 offen offset:512 sc1
  buffer_load_dwordx2 v[84:85], v1, s[16:19], s32 offen offset:1024 sc1
  buffer_load_dwordx2 v[86:87], v1, s[16:19], s32 offen offset:1536 sc1
  s_lshl_b32 s32, s28, 10
  s_add_u32 s32, s32, 32768
  v_add_u32 v3, s32, v2
  s_barrier
  s_lshl_b32 s32, s28, 10
  s_add_u32 s33, s32, 93323264
  v_add_u32 v4, s32, v2
  buffer_load_dwordx4 v[192:195], v2, s[16:19], s33 offen sc1
  s_add_u32 s33, s33, 4096
  buffer_load_dwordx4 v[196:199], v2, s[16:19], s33 offen sc1
  s_add_u32 s33, s33, 4096
  buffer_load_dwordx4 v[200:203], v2, s[16:19], s33 offen sc1
  s_add_u32 s33, s33, 4096
  buffer_load_dwordx4 v[204:207], v2, s[16:19], s33 offen sc1
  s_add_u32 s33, s33, 4096
  buffer_load_dwordx4 v[208:211], v2, s[16:19], s33 offen sc1
  s_add_u32 s33, s33, 4096
  buffer_load_dwordx4 v[212:215], v2, s[16:19], s33 offen sc1
  s_add_u32 s33, s33, 4096
  s_cmp_eq_u32 s28, 0
  s_cbranch_scc0 B2k_27
  buffer_load_dwordx4 v[216:219], v2, s[16:19], s33 offen sc1
  s_waitcnt vmcnt(0)
  ds_write_b128 v4, v[216:219] offset:24576
B2k_27:
  s_waitcnt vmcnt(0)
  ds_write_b128 v4, v[192:195] offset:0
  ds_write_b128 v4, v[196:199] offset:4096
  ds_write_b128 v4, v[200:203] offset:8192
  ds_write_b128 v4, v[204:207] offset:12288
  ds_write_b128 v4, v[208:211] offset:16384
  ds_write_b128 v4, v[212:215] offset:20480
  s_waitcnt lgkmcnt(0)
  s_barrier
  ds_read_b64 v[88:89], v1 offset:0
  ds_read_b64 v[90:91], v1 offset:512
  ds_read_b64 v[92:93], v1 offset:17408
  ds_read_b64 v[94:95], v1 offset:17920
  s_waitcnt lgkmcnt(3)
  v_mfma_f32_16x16x16_bf16 v[120:123], v[88:89], v[16:17], 0
  s_waitcnt lgkmcnt(2)
  v_mfma_f32_16x16x16_bf16 v[124:127], v[90:91], v[16:17], 0
  s_waitcnt lgkmcnt(1)
  v_mfma_f32_16x16x16_bf16 v[120:123], v[92:93], v[18:19], v[120:123]
  s_waitcnt lgkmcnt(0)
  v_mfma_f32_16x16x16_bf16 v[124:127], v[94:95], v[18:19], v[124:127]
  s_nop 3
  v_cvt_pk_bf16_f32 v104, v120, v121
  v_cvt_pk_bf16_f32 v105, v122, v123
  v_lshlrev_b32 v120, 16, v104
  v_and_b32 v121, 0xffff0000, v104
  v_lshlrev_b32 v122, 16, v105
  v_and_b32 v123, 0xffff0000, v105
  v_cvt_pk_bf16_f32 v104, v124, v125
  v_cvt_pk_bf16_f32 v105, v126, v127
  v_lshlrev_b32 v124, 16, v104
  v_and_b32 v125, 0xffff0000, v104
  v_lshlrev_b32 v126, 16, v105
  v_and_b32 v127, 0xffff0000, v105
  v_add_f32 v124, 0x358637bd, v124
  v_add_f32 v125, 0x358637bd, v125
  v_add_f32 v126, 0x358637bd, v126
  v_add_f32 v127, 0x358637bd, v127
  v_cvt_pk_bf16_f32 v104, v124, v125
  v_cvt_pk_bf16_f32 v105, v126, v127
  v_lshlrev_b32 v124, 16, v104
  v_and_b32 v125, 0xffff0000, v104
  v_lshlrev_b32 v126, 16, v105
  v_and_b32 v127, 0xffff0000, v105
  v_rcp_f32 v124, v124
  v_rcp_f32 v125, v125
  v_rcp_f32 v126, v126
  v_rcp_f32 v127, v127
  v_mul_f32 v120, v120, v124
  v_mul_f32 v121, v121, v125
  v_mul_f32 v122, v122, v126
  v_mul_f32 v123, v123, v127
  v_cvt_pk_bf16_f32 v128, v120, v121
  v_cvt_pk_bf16_f32 v129, v122, v123
  ds_read_b64 v[88:89], v1 offset:9216
  ds_read_b64 v[90:91], v1 offset:9728
  ds_read_b64 v[92:93], v1 offset:1024
  ds_read_b64 v[94:95], v1 offset:1536
  ds_read_b64 v[96:97], v1 offset:18432
  ds_read_b64 v[98:99], v1 offset:18944
  s_waitcnt lgkmcnt(5)
  v_mfma_f32_16x16x16_bf16 v[120:123], v[88:89], v[16:17], 0
  s_waitcnt lgkmcnt(4)
  v_mfma_f32_16x16x16_bf16 v[124:127], v[90:91], v[16:17], 0
  s_waitcnt lgkmcnt(3)
  v_mfma_f32_16x16x16_bf16 v[120:123], v[92:93], v[18:19], v[120:123]
  s_waitcnt lgkmcnt(2)
  v_mfma_f32_16x16x16_bf16 v[124:127], v[94:95], v[18:19], v[124:127]
  s_waitcnt lgkmcnt(1)
  v_mfma_f32_16x16x16_bf16 v[120:123], v[96:97], v[20:21], v[120:123]
  s_waitcnt lgkmcnt(0)
  v_mfma_f32_16x16x16_bf16 v[124:127], v[98:99], v[20:21], v[124:127]
  s_nop 3
  v_cvt_pk_bf16_f32 v104, v120, v121
  v_cvt_pk_bf16_f32 v105, v122, v123
  v_lshlrev_b32 v120, 16, v104
  v_and_b32 v121, 0xffff0000, v104
  v_lshlrev_b32 v122, 16, v105
  v_and_b32 v123, 0xffff0000, v105
  v_cvt_pk_bf16_f32 v104, v124, v125
  v_cvt_pk_bf16_f32 v105, v126, v127
  v_lshlrev_b32 v124, 16, v104
  v_and_b32 v125, 0xffff0000, v104
  v_lshlrev_b32 v126, 16, v105
  v_and_b32 v127, 0xffff0000, v105
  v_add_f32 v124, 0x358637bd, v124
  v_add_f32 v125, 0x358637bd, v125
  v_add_f32 v126, 0x358637bd, v126
  v_add_f32 v127, 0x358637bd, v127
  v_cvt_pk_bf16_f32 v104, v124, v125
  v_cvt_pk_bf16_f32 v105, v126, v127
  v_lshlrev_b32 v124, 16, v104
  v_and_b32 v125, 0xffff0000, v104
  v_lshlrev_b32 v126, 16, v105
  v_and_b32 v127, 0xffff0000, v105
  v_rcp_f32 v124, v124
  v_rcp_f32 v125, v125
  v_rcp_f32 v126, v126
  v_rcp_f32 v127, v127
  v_mul_f32 v120, v120, v124
  v_mul_f32 v121, v121, v125
  v_mul_f32 v122, v122, v126
  v_mul_f32 v123, v123, v127
  v_cvt_pk_bf16_f32 v130, v120, v121
  v_cvt_pk_bf16_f32 v131, v122, v123
  ds_write_b128 v3, v[128:131] offset:0
  ds_read_b64 v[88:89], v1 offset:10240
  ds_read_b64 v[90:91], v1 offset:10752
  ds_read_b64 v[92:93], v1 offset:2048
  ds_read_b64 v[94:95], v1 offset:2560
  ds_read_b64 v[96:97], v1 offset:19456
  ds_read_b64 v[98:99], v1 offset:19968
  s_waitcnt lgkmcnt(5)
  v_mfma_f32_16x16x16_bf16 v[120:123], v[88:89], v[18:19], 0
  s_waitcnt lgkmcnt(4)
  v_mfma_f32_16x16x16_bf16 v[124:127], v[90:91], v[18:19], 0
  s_waitcnt lgkmcnt(3)
  v_mfma_f32_16x16x16_bf16 v[120:123], v[92:93], v[20:21], v[120:123]
  s_waitcnt lgkmcnt(2)
  v_mfma_f32_16x16x16_bf16 v[124:127], v[94:95], v[20:21], v[124:127]
  s_waitcnt lgkmcnt(1)
  v_mfma_f32_16x16x16_bf16 v[120:123], v[96:97], v[22:23], v[120:123]
  s_waitcnt lgkmcnt(0)
  v_mfma_f32_16x16x16_bf16 v[124:127], v[98:99], v[22:23], v[124:127]
  s_nop 3
  v_cvt_pk_bf16_f32 v104, v120, v121
  v_cvt_pk_bf16_f32 v105, v122, v123
  v_lshlrev_b32 v120, 16, v104
  v_and_b32 v121, 0xffff0000, v104
  v_lshlrev_b32 v122, 16, v105
  v_and_b32 v123, 0xffff0000, v105
  v_cvt_pk_bf16_f32 v104, v124, v125
  v_cvt_pk_bf16_f32 v105, v126, v127
  v_lshlrev_b32 v124, 16, v104
  v_and_b32 v125, 0xffff0000, v104
  v_lshlrev_b32 v126, 16, v105
  v_and_b32 v127, 0xffff0000, v105
  v_add_f32 v124, 0x358637bd, v124
  v_add_f32 v125, 0x358637bd, v125
  v_add_f32 v126, 0x358637bd, v126
  v_add_f32 v127, 0x358637bd, v127
  v_cvt_pk_bf16_f32 v104, v124, v125
  v_cvt_pk_bf16_f32 v105, v126, v127
  v_lshlrev_b32 v124, 16, v104
  v_and_b32 v125, 0xffff0000, v104
  v_lshlrev_b32 v126, 16, v105
  v_and_b32 v127, 0xffff0000, v105
  v_rcp_f32 v124, v124
  v_rcp_f32 v125, v125
  v_rcp_f32 v126, v126
  v_rcp_f32 v127, v127
  v_mul_f32 v120, v120, v124
  v_mul_f32 v121, v121, v125
  v_mul_f32 v122, v122, v126
  v_mul_f32 v123, v123, v127
  v_cvt_pk_bf16_f32 v128, v120, v121
  v_cvt_pk_bf16_f32 v129, v122, v123
  ds_read_b64 v[88:89], v1 offset:11264
  ds_read_b64 v[90:91], v1 offset:11776
  ds_read_b64 v[92:93], v1 offset:3072
  ds_read_b64 v[94:95], v1 offset:3584
  ds_read_b64 v[96:97], v1 offset:20480
  ds_read_b64 v[98:99], v1 offset:20992
  s_waitcnt lgkmcnt(5)
  v_mfma_f32_16x16x16_bf16 v[120:123], v[88:89], v[20:21], 0
  s_waitcnt lgkmcnt(4)
  v_mfma_f32_16x16x16_bf16 v[124:127], v[90:91], v[20:21], 0
  s_waitcnt lgkmcnt(3)
  v_mfma_f32_16x16x16_bf16 v[120:123], v[92:93], v[22:23], v[120:123]
  s_waitcnt lgkmcnt(2)
  v_mfma_f32_16x16x16_bf16 v[124:127], v[94:95], v[22:23], v[124:127]
  s_waitcnt lgkmcnt(1)
  v_mfma_f32_16x16x16_bf16 v[120:123], v[96:97], v[24:25], v[120:123]
  s_waitcnt lgkmcnt(0)
  v_mfma_f32_16x16x16_bf16 v[124:127], v[98:99], v[24:25], v[124:127]
  s_nop 3
  v_cvt_pk_bf16_f32 v104, v120, v121
  v_cvt_pk_bf16_f32 v105, v122, v123
  v_lshlrev_b32 v120, 16, v104
  v_and_b32 v121, 0xffff0000, v104
  v_lshlrev_b32 v122, 16, v105
  v_and_b32 v123, 0xffff0000, v105
  v_cvt_pk_bf16_f32 v104, v124, v125
  v_cvt_pk_bf16_f32 v105, v126, v127
  v_lshlrev_b32 v124, 16, v104
  v_and_b32 v125, 0xffff0000, v104
  v_lshlrev_b32 v126, 16, v105
  v_and_b32 v127, 0xffff0000, v105
  v_add_f32 v124, 0x358637bd, v124
  v_add_f32 v125, 0x358637bd, v125
  v_add_f32 v126, 0x358637bd, v126
  v_add_f32 v127, 0x358637bd, v127
  v_cvt_pk_bf16_f32 v104, v124, v125
  v_cvt_pk_bf16_f32 v105, v126, v127
  v_lshlrev_b32 v124, 16, v104
  v_and_b32 v125, 0xffff0000, v104
  v_lshlrev_b32 v126, 16, v105
  v_and_b32 v127, 0xffff0000, v105
  v_rcp_f32 v124, v124
  v_rcp_f32 v125, v125
  v_rcp_f32 v126, v126
  v_rcp_f32 v127, v127
  v_mul_f32 v120, v120, v124
  v_mul_f32 v121, v121, v125
  v_mul_f32 v122, v122, v126
  v_mul_f32 v123, v123, v127
  v_cvt_pk_bf16_f32 v130, v120, v121
  v_cvt_pk_bf16_f32 v131, v122, v123
  ds_write_b128 v3, v[128:131] offset:4096
  ds_read_b64 v[88:89], v1 offset:12288
  ds_read_b64 v[90:91], v1 offset:12800
  ds_read_b64 v[92:93], v1 offset:4096
  ds_read_b64 v[94:95], v1 offset:4608
  ds_read_b64 v[96:97], v1 offset:21504
  ds_read_b64 v[98:99], v1 offset:22016
  s_waitcnt lgkmcnt(5)
  v_mfma_f32_16x16x16_bf16 v[120:123], v[88:89], v[22:23], 0
  s_waitcnt lgkmcnt(4)
  v_mfma_f32_16x16x16_bf16 v[124:127], v[90:91], v[22:23], 0
  s_waitcnt lgkmcnt(3)
  v_mfma_f32_16x16x16_bf16 v[120:123], v[92:93], v[24:25], v[120:123]
  s_waitcnt lgkmcnt(2)
  v_mfma_f32_16x16x16_bf16 v[124:127], v[94:95], v[24:25], v[124:127]
  s_waitcnt lgkmcnt(1)
  v_mfma_f32_16x16x16_bf16 v[120:123], v[96:97], v[26:27], v[120:123]
  s_waitcnt lgkmcnt(0)
  v_mfma_f32_16x16x16_bf16 v[124:127], v[98:99], v[26:27], v[124:127]
  s_nop 3
  v_cvt_pk_bf16_f32 v104, v120, v121
  v_cvt_pk_bf16_f32 v105, v122, v123
  v_lshlrev_b32 v120, 16, v104
  v_and_b32 v121, 0xffff0000, v104
  v_lshlrev_b32 v122, 16, v105
  v_and_b32 v123, 0xffff0000, v105
  v_cvt_pk_bf16_f32 v104, v124, v125
  v_cvt_pk_bf16_f32 v105, v126, v127
  v_lshlrev_b32 v124, 16, v104
  v_and_b32 v125, 0xffff0000, v104
  v_lshlrev_b32 v126, 16, v105
  v_and_b32 v127, 0xffff0000, v105
  v_add_f32 v124, 0x358637bd, v124
  v_add_f32 v125, 0x358637bd, v125
  v_add_f32 v126, 0x358637bd, v126
  v_add_f32 v127, 0x358637bd, v127
  v_cvt_pk_bf16_f32 v104, v124, v125
  v_cvt_pk_bf16_f32 v105, v126, v127
  v_lshlrev_b32 v124, 16, v104
  v_and_b32 v125, 0xffff0000, v104
  v_lshlrev_b32 v126, 16, v105
  v_and_b32 v127, 0xffff0000, v105
  v_rcp_f32 v124, v124
  v_rcp_f32 v125, v125
  v_rcp_f32 v126, v126
  v_rcp_f32 v127, v127
  v_mul_f32 v120, v120, v124
  v_mul_f32 v121, v121, v125
  v_mul_f32 v122, v122, v126
  v_mul_f32 v123, v123, v127
  v_cvt_pk_bf16_f32 v128, v120, v121
  v_cvt_pk_bf16_f32 v129, v122, v123
  ds_read_b64 v[88:89], v1 offset:13312
  ds_read_b64 v[90:91], v1 offset:13824
  ds_read_b64 v[92:93], v1 offset:5120
  ds_read_b64 v[94:95], v1 offset:5632
  ds_read_b64 v[96:97], v1 offset:22528
  ds_read_b64 v[98:99], v1 offset:23040
  s_waitcnt lgkmcnt(5)
  v_mfma_f32_16x16x16_bf16 v[120:123], v[88:89], v[24:25], 0
  s_waitcnt lgkmcnt(4)
  v_mfma_f32_16x16x16_bf16 v[124:127], v[90:91], v[24:25], 0
  s_waitcnt lgkmcnt(3)
  v_mfma_f32_16x16x16_bf16 v[120:123], v[92:93], v[26:27], v[120:123]
  s_waitcnt lgkmcnt(2)
  v_mfma_f32_16x16x16_bf16 v[124:127], v[94:95], v[26:27], v[124:127]
  s_waitcnt lgkmcnt(1)
  v_mfma_f32_16x16x16_bf16 v[120:123], v[96:97], v[28:29], v[120:123]
  s_waitcnt lgkmcnt(0)
  v_mfma_f32_16x16x16_bf16 v[124:127], v[98:99], v[28:29], v[124:127]
  s_nop 3
  v_cvt_pk_bf16_f32 v104, v120, v121
  v_cvt_pk_bf16_f32 v105, v122, v123
  v_lshlrev_b32 v120, 16, v104
  v_and_b32 v121, 0xffff0000, v104
  v_lshlrev_b32 v122, 16, v105
  v_and_b32 v123, 0xffff0000, v105
  v_cvt_pk_bf16_f32 v104, v124, v125
  v_cvt_pk_bf16_f32 v105, v126, v127
  v_lshlrev_b32 v124, 16, v104
  v_and_b32 v125, 0xffff0000, v104
  v_lshlrev_b32 v126, 16, v105
  v_and_b32 v127, 0xffff0000, v105
  v_add_f32 v124, 0x358637bd, v124
  v_add_f32 v125, 0x358637bd, v125
  v_add_f32 v126, 0x358637bd, v126
  v_add_f32 v127, 0x358637bd, v127
  v_cvt_pk_bf16_f32 v104, v124, v125
  v_cvt_pk_bf16_f32 v105, v126, v127
  v_lshlrev_b32 v124, 16, v104
  v_and_b32 v125, 0xffff0000, v104
  v_lshlrev_b32 v126, 16, v105
  v_and_b32 v127, 0xffff0000, v105
  v_rcp_f32 v124, v124
  v_rcp_f32 v125, v125
  v_rcp_f32 v126, v126
  v_rcp_f32 v127, v127
  v_mul_f32 v120, v120, v124
  v_mul_f32 v121, v121, v125
  v_mul_f32 v122, v122, v126
  v_mul_f32 v123, v123, v127
  v_cvt_pk_bf16_f32 v130, v120, v121
  v_cvt_pk_bf16_f32 v131, v122, v123
  ds_write_b128 v3, v[128:131] offset:8192
  ds_read_b64 v[88:89], v1 offset:14336
  ds_read_b64 v[90:91], v1 offset:14848
  ds_read_b64 v[92:93], v1 offset:6144
  ds_read_b64 v[94:95], v1 offset:6656
  ds_read_b64 v[96:97], v1 offset:23552
  ds_read_b64 v[98:99], v1 offset:24064
  s_waitcnt lgkmcnt(5)
  v_mfma_f32_16x16x16_bf16 v[120:123], v[88:89], v[26:27], 0
  s_waitcnt lgkmcnt(4)
  v_mfma_f32_16x16x16_bf16 v[124:127], v[90:91], v[26:27], 0
  s_waitcnt lgkmcnt(3)
  v_mfma_f32_16x16x16_bf16 v[120:123], v[92:93], v[28:29], v[120:123]
  s_waitcnt lgkmcnt(2)
  v_mfma_f32_16x16x16_bf16 v[124:127], v[94:95], v[28:29], v[124:127]
  s_waitcnt lgkmcnt(1)
  v_mfma_f32_16x16x16_bf16 v[120:123], v[96:97], v[30:31], v[120:123]
  s_waitcnt lgkmcnt(0)
  v_mfma_f32_16x16x16_bf16 v[124:127], v[98:99], v[30:31], v[124:127]
  s_nop 3
  v_cvt_pk_bf16_f32 v104, v120, v121
  v_cvt_pk_bf16_f32 v105, v122, v123
  v_lshlrev_b32 v120, 16, v104
  v_and_b32 v121, 0xffff0000, v104
  v_lshlrev_b32 v122, 16, v105
  v_and_b32 v123, 0xffff0000, v105
  v_cvt_pk_bf16_f32 v104, v124, v125
  v_cvt_pk_bf16_f32 v105, v126, v127
  v_lshlrev_b32 v124, 16, v104
  v_and_b32 v125, 0xffff0000, v104
  v_lshlrev_b32 v126, 16, v105
  v_and_b32 v127, 0xffff0000, v105
  v_add_f32 v124, 0x358637bd, v124
  v_add_f32 v125, 0x358637bd, v125
  v_add_f32 v126, 0x358637bd, v126
  v_add_f32 v127, 0x358637bd, v127
  v_cvt_pk_bf16_f32 v104, v124, v125
  v_cvt_pk_bf16_f32 v105, v126, v127
  v_lshlrev_b32 v124, 16, v104
  v_and_b32 v125, 0xffff0000, v104
  v_lshlrev_b32 v126, 16, v105
  v_and_b32 v127, 0xffff0000, v105
  v_rcp_f32 v124, v124
  v_rcp_f32 v125, v125
  v_rcp_f32 v126, v126
  v_rcp_f32 v127, v127
  v_mul_f32 v120, v120, v124
  v_mul_f32 v121, v121, v125
  v_mul_f32 v122, v122, v126
  v_mul_f32 v123, v123, v127
  v_cvt_pk_bf16_f32 v128, v120, v121
  v_cvt_pk_bf16_f32 v129, v122, v123
  ds_read_b64 v[88:89], v1 offset:15360
  ds_read_b64 v[90:91], v1 offset:15872
  ds_read_b64 v[92:93], v1 offset:7168
  ds_read_b64 v[94:95], v1 offset:7680
  ds_read_b64 v[96:97], v1 offset:24576
  ds_read_b64 v[98:99], v1 offset:25088
  s_waitcnt lgkmcnt(5)
  v_mfma_f32_16x16x16_bf16 v[120:123], v[88:89], v[28:29], 0
  s_waitcnt lgkmcnt(4)
  v_mfma_f32_16x16x16_bf16 v[124:127], v[90:91], v[28:29], 0
  s_waitcnt lgkmcnt(3)
  v_mfma_f32_16x16x16_bf16 v[120:123], v[92:93], v[30:31], v[120:123]
  s_waitcnt lgkmcnt(2)
  v_mfma_f32_16x16x16_bf16 v[124:127], v[94:95], v[30:31], v[124:127]
  s_waitcnt lgkmcnt(1)
  v_mfma_f32_16x16x16_bf16 v[120:123], v[96:97], v[32:33], v[120:123]
  s_waitcnt lgkmcnt(0)
  v_mfma_f32_16x16x16_bf16 v[124:127], v[98:99], v[32:33], v[124:127]
  s_nop 3
  v_cvt_pk_bf16_f32 v104, v120, v121
  v_cvt_pk_bf16_f32 v105, v122, v123
  v_lshlrev_b32 v120, 16, v104
  v_and_b32 v121, 0xffff0000, v104
  v_lshlrev_b32 v122, 16, v105
  v_and_b32 v123, 0xffff0000, v105
  v_cvt_pk_bf16_f32 v104, v124, v125
  v_cvt_pk_bf16_f32 v105, v126, v127
  v_lshlrev_b32 v124, 16, v104
  v_and_b32 v125, 0xffff0000, v104
  v_lshlrev_b32 v126, 16, v105
  v_and_b32 v127, 0xffff0000, v105
  v_add_f32 v124, 0x358637bd, v124
  v_add_f32 v125, 0x358637bd, v125
  v_add_f32 v126, 0x358637bd, v126
  v_add_f32 v127, 0x358637bd, v127
  v_cvt_pk_bf16_f32 v104, v124, v125
  v_cvt_pk_bf16_f32 v105, v126, v127
  v_lshlrev_b32 v124, 16, v104
  v_and_b32 v125, 0xffff0000, v104
  v_lshlrev_b32 v126, 16, v105
  v_and_b32 v127, 0xffff0000, v105
  v_rcp_f32 v124, v124
  v_rcp_f32 v125, v125
  v_rcp_f32 v126, v126
  v_rcp_f32 v127, v127
  v_mul_f32 v120, v120, v124
  v_mul_f32 v121, v121, v125
  v_mul_f32 v122, v122, v126
  v_mul_f32 v123, v123, v127
  v_cvt_pk_bf16_f32 v130, v120, v121
  v_cvt_pk_bf16_f32 v131, v122, v123
  ds_write_b128 v3, v[128:131] offset:12288
  ds_read_b64 v[88:89], v1 offset:16384
  ds_read_b64 v[90:91], v1 offset:16896
  ds_read_b64 v[92:93], v1 offset:8192
  ds_read_b64 v[94:95], v1 offset:8704
  s_waitcnt lgkmcnt(3)
  v_mfma_f32_16x16x16_bf16 v[120:123], v[88:89], v[30:31], 0
  s_waitcnt lgkmcnt(2)
  v_mfma_f32_16x16x16_bf16 v[124:127], v[90:91], v[30:31], 0
  s_waitcnt lgkmcnt(1)
  v_mfma_f32_16x16x16_bf16 v[120:123], v[92:93], v[32:33], v[120:123]
  s_waitcnt lgkmcnt(0)
  v_mfma_f32_16x16x16_bf16 v[124:127], v[94:95], v[32:33], v[124:127]
  s_nop 3
  v_cvt_pk_bf16_f32 v104, v120, v121
  v_cvt_pk_bf16_f32 v105, v122, v123
  v_lshlrev_b32 v120, 16, v104
  v_and_b32 v121, 0xffff0000, v104
  v_lshlrev_b32 v122, 16, v105
  v_and_b32 v123, 0xffff0000, v105
  v_cvt_pk_bf16_f32 v104, v124, v125
  v_cvt_pk_bf16_f32 v105, v126, v127
  v_lshlrev_b32 v124, 16, v104
  v_and_b32 v125, 0xffff0000, v104
  v_lshlrev_b32 v126, 16, v105
  v_and_b32 v127, 0xffff0000, v105
  v_add_f32 v124, 0x358637bd, v124
  v_add_f32 v125, 0x358637bd, v125
  v_add_f32 v126, 0x358637bd, v126
  v_add_f32 v127, 0x358637bd, v127
  v_cvt_pk_bf16_f32 v104, v124, v125
  v_cvt_pk_bf16_f32 v105, v126, v127
  v_lshlrev_b32 v124, 16, v104
  v_and_b32 v125, 0xffff0000, v104
  v_lshlrev_b32 v126, 16, v105
  v_and_b32 v127, 0xffff0000, v105
  v_rcp_f32 v124, v124
  v_rcp_f32 v125, v125
  v_rcp_f32 v126, v126
  v_rcp_f32 v127, v127
  v_mul_f32 v120, v120, v124
  v_mul_f32 v121, v121, v125
  v_mul_f32 v122, v122, v126
  v_mul_f32 v123, v123, v127
  v_cvt_pk_bf16_f32 v128, v120, v121
  v_cvt_pk_bf16_f32 v129, v122, v123
  s_barrier
  s_lshl_b32 s32, s28, 10
  s_add_u32 s33, s32, 93348864
  v_add_u32 v4, s32, v2
  buffer_load_dwordx4 v[192:195], v2, s[16:19], s33 offen sc1
  s_add_u32 s33, s33, 4096
  buffer_load_dwordx4 v[196:199], v2, s[16:19], s33 offen sc1
  s_add_u32 s33, s33, 4096
  buffer_load_dwordx4 v[200:203], v2, s[16:19], s33 offen sc1
  s_add_u32 s33, s33, 4096
  buffer_load_dwordx4 v[204:207], v2, s[16:19], s33 offen sc1
  s_add_u32 s33, s33, 4096
  buffer_load_dwordx4 v[208:211], v2, s[16:19], s33 offen sc1
  s_add_u32 s33, s33, 4096
  buffer_load_dwordx4 v[212:215], v2, s[16:19], s33 offen sc1
  s_add_u32 s33, s33, 4096
  s_cmp_eq_u32 s28, 0
  s_cbranch_scc0 B2k_28
  buffer_load_dwordx4 v[216:219], v2, s[16:19], s33 offen sc1
  s_waitcnt vmcnt(0)
  ds_write_b128 v4, v[216:219] offset:24576
B2k_28:
  s_waitcnt vmcnt(0)
  ds_write_b128 v4, v[192:195] offset:0
  ds_write_b128 v4, v[196:199] offset:4096
  ds_write_b128 v4, v[200:203] offset:8192
  ds_write_b128 v4, v[204:207] offset:12288
  ds_write_b128 v4, v[208:211] offset:16384
  ds_write_b128 v4, v[212:215] offset:20480
  s_waitcnt lgkmcnt(0)
  s_barrier
  ds_read_b64 v[88:89], v1 offset:0
  ds_read_b64 v[90:91], v1 offset:512
  ds_read_b64 v[92:93], v1 offset:17408
  ds_read_b64 v[94:95], v1 offset:17920
  s_waitcnt lgkmcnt(3)
  v_mfma_f32_16x16x16_bf16 v[120:123], v[88:89], v[34:35], 0
  s_waitcnt lgkmcnt(2)
  v_mfma_f32_16x16x16_bf16 v[124:127], v[90:91], v[34:35], 0
  s_waitcnt lgkmcnt(1)
  v_mfma_f32_16x16x16_bf16 v[120:123], v[92:93], v[36:37], v[120:123]
  s_waitcnt lgkmcnt(0)
  v_mfma_f32_16x16x16_bf16 v[124:127], v[94:95], v[36:37], v[124:127]
  s_nop 3
  v_cvt_pk_bf16_f32 v104, v120, v121
  v_cvt_pk_bf16_f32 v105, v122, v123
  v_lshlrev_b32 v120, 16, v104
  v_and_b32 v121, 0xffff0000, v104
  v_lshlrev_b32 v122, 16, v105
  v_and_b32 v123, 0xffff0000, v105
  v_cvt_pk_bf16_f32 v104, v124, v125
  v_cvt_pk_bf16_f32 v105, v126, v127
  v_lshlrev_b32 v124, 16, v104
  v_and_b32 v125, 0xffff0000, v104
  v_lshlrev_b32 v126, 16, v105
  v_and_b32 v127, 0xffff0000, v105
  v_add_f32 v124, 0x358637bd, v124
  v_add_f32 v125, 0x358637bd, v125
  v_add_f32 v126, 0x358637bd, v126
  v_add_f32 v127, 0x358637bd, v127
  v_cvt_pk_bf16_f32 v104, v124, v125
  v_cvt_pk_bf16_f32 v105, v126, v127
  v_lshlrev_b32 v124, 16, v104
  v_and_b32 v125, 0xffff0000, v104
  v_lshlrev_b32 v126, 16, v105
  v_and_b32 v127, 0xffff0000, v105
  v_rcp_f32 v124, v124
  v_rcp_f32 v125, v125
  v_rcp_f32 v126, v126
  v_rcp_f32 v127, v127
  v_mul_f32 v120, v120, v124
  v_mul_f32 v121, v121, v125
  v_mul_f32 v122, v122, v126
  v_mul_f32 v123, v123, v127
  v_cvt_pk_bf16_f32 v130, v120, v121
  v_cvt_pk_bf16_f32 v131, v122, v123
  ds_write_b128 v3, v[128:131] offset:16384
  ds_read_b64 v[88:89], v1 offset:9216
  ds_read_b64 v[90:91], v1 offset:9728
  ds_read_b64 v[92:93], v1 offset:1024
  ds_read_b64 v[94:95], v1 offset:1536
  ds_read_b64 v[96:97], v1 offset:18432
  ds_read_b64 v[98:99], v1 offset:18944
  s_waitcnt lgkmcnt(5)
  v_mfma_f32_16x16x16_bf16 v[120:123], v[88:89], v[34:35], 0
  s_waitcnt lgkmcnt(4)
  v_mfma_f32_16x16x16_bf16 v[124:127], v[90:91], v[34:35], 0
  s_waitcnt lgkmcnt(3)
  v_mfma_f32_16x16x16_bf16 v[120:123], v[92:93], v[36:37], v[120:123]
  s_waitcnt lgkmcnt(2)
  v_mfma_f32_16x16x16_bf16 v[124:127], v[94:95], v[36:37], v[124:127]
  s_waitcnt lgkmcnt(1)
  v_mfma_f32_16x16x16_bf16 v[120:123], v[96:97], v[38:39], v[120:123]
  s_waitcnt lgkmcnt(0)
  v_mfma_f32_16x16x16_bf16 v[124:127], v[98:99], v[38:39], v[124:127]
  s_nop 3
  v_cvt_pk_bf16_f32 v104, v120, v121
  v_cvt_pk_bf16_f32 v105, v122, v123
  v_lshlrev_b32 v120, 16, v104
  v_and_b32 v121, 0xffff0000, v104
  v_lshlrev_b32 v122, 16, v105
  v_and_b32 v123, 0xffff0000, v105
  v_cvt_pk_bf16_f32 v104, v124, v125
  v_cvt_pk_bf16_f32 v105, v126, v127
  v_lshlrev_b32 v124, 16, v104
  v_and_b32 v125, 0xffff0000, v104
  v_lshlrev_b32 v126, 16, v105
  v_and_b32 v127, 0xffff0000, v105
  v_add_f32 v124, 0x358637bd, v124
  v_add_f32 v125, 0x358637bd, v125
  v_add_f32 v126, 0x358637bd, v126
  v_add_f32 v127, 0x358637bd, v127
  v_cvt_pk_bf16_f32 v104, v124, v125
  v_cvt_pk_bf16_f32 v105, v126, v127
  v_lshlrev_b32 v124, 16, v104
  v_and_b32 v125, 0xffff0000, v104
  v_lshlrev_b32 v126, 16, v105
  v_and_b32 v127, 0xffff0000, v105
  v_rcp_f32 v124, v124
  v_rcp_f32 v125, v125
  v_rcp_f32 v126, v126
  v_rcp_f32 v127, v127
  v_mul_f32 v120, v120, v124
  v_mul_f32 v121, v121, v125
  v_mul_f32 v122, v122, v126
  v_mul_f32 v123, v123, v127
  v_cvt_pk_bf16_f32 v128, v120, v121
  v_cvt_pk_bf16_f32 v129, v122, v123
  ds_read_b64 v[88:89], v1 offset:10240
  ds_read_b64 v[90:91], v1 offset:10752
  ds_read_b64 v[92:93], v1 offset:2048
  ds_read_b64 v[94:95], v1 offset:2560
  ds_read_b64 v[96:97], v1 offset:19456
  ds_read_b64 v[98:99], v1 offset:19968
  s_waitcnt lgkmcnt(5)
  v_mfma_f32_16x16x16_bf16 v[120:123], v[88:89], v[36:37], 0
  s_waitcnt lgkmcnt(4)
  v_mfma_f32_16x16x16_bf16 v[124:127], v[90:91], v[36:37], 0
  s_waitcnt lgkmcnt(3)
  v_mfma_f32_16x16x16_bf16 v[120:123], v[92:93], v[38:39], v[120:123]
  s_waitcnt lgkmcnt(2)
  v_mfma_f32_16x16x16_bf16 v[124:127], v[94:95], v[38:39], v[124:127]
  s_waitcnt lgkmcnt(1)
  v_mfma_f32_16x16x16_bf16 v[120:123], v[96:97], v[40:41], v[120:123]
  s_waitcnt lgkmcnt(0)
  v_mfma_f32_16x16x16_bf16 v[124:127], v[98:99], v[40:41], v[124:127]
  s_nop 3
  v_cvt_pk_bf16_f32 v104, v120, v121
  v_cvt_pk_bf16_f32 v105, v122, v123
  v_lshlrev_b32 v120, 16, v104
  v_and_b32 v121, 0xffff0000, v104
  v_lshlrev_b32 v122, 16, v105
  v_and_b32 v123, 0xffff0000, v105
  v_cvt_pk_bf16_f32 v104, v124, v125
  v_cvt_pk_bf16_f32 v105, v126, v127
  v_lshlrev_b32 v124, 16, v104
  v_and_b32 v125, 0xffff0000, v104
  v_lshlrev_b32 v126, 16, v105
  v_and_b32 v127, 0xffff0000, v105
  v_add_f32 v124, 0x358637bd, v124
  v_add_f32 v125, 0x358637bd, v125
  v_add_f32 v126, 0x358637bd, v126
  v_add_f32 v127, 0x358637bd, v127
  v_cvt_pk_bf16_f32 v104, v124, v125
  v_cvt_pk_bf16_f32 v105, v126, v127
  v_lshlrev_b32 v124, 16, v104
  v_and_b32 v125, 0xffff0000, v104
  v_lshlrev_b32 v126, 16, v105
  v_and_b32 v127, 0xffff0000, v105
  v_rcp_f32 v124, v124
  v_rcp_f32 v125, v125
  v_rcp_f32 v126, v126
  v_rcp_f32 v127, v127
  v_mul_f32 v120, v120, v124
  v_mul_f32 v121, v121, v125
  v_mul_f32 v122, v122, v126
  v_mul_f32 v123, v123, v127
  v_cvt_pk_bf16_f32 v130, v120, v121
  v_cvt_pk_bf16_f32 v131, v122, v123
  ds_write_b128 v3, v[128:131] offset:20480
  ds_read_b64 v[88:89], v1 offset:11264
  ds_read_b64 v[90:91], v1 offset:11776
  ds_read_b64 v[92:93], v1 offset:3072
  ds_read_b64 v[94:95], v1 offset:3584
  ds_read_b64 v[96:97], v1 offset:20480
  ds_read_b64 v[98:99], v1 offset:20992
  s_waitcnt lgkmcnt(5)
  v_mfma_f32_16x16x16_bf16 v[120:123], v[88:89], v[38:39], 0
  s_waitcnt lgkmcnt(4)
  v_mfma_f32_16x16x16_bf16 v[124:127], v[90:91], v[38:39], 0
  s_waitcnt lgkmcnt(3)
  v_mfma_f32_16x16x16_bf16 v[120:123], v[92:93], v[40:41], v[120:123]
  s_waitcnt lgkmcnt(2)
  v_mfma_f32_16x16x16_bf16 v[124:127], v[94:95], v[40:41], v[124:127]
  s_waitcnt lgkmcnt(1)
  v_mfma_f32_16x16x16_bf16 v[120:123], v[96:97], v[42:43], v[120:123]
  s_waitcnt lgkmcnt(0)
  v_mfma_f32_16x16x16_bf16 v[124:127], v[98:99], v[42:43], v[124:127]
  s_nop 3
  v_cvt_pk_bf16_f32 v104, v120, v121
  v_cvt_pk_bf16_f32 v105, v122, v123
  v_lshlrev_b32 v120, 16, v104
  v_and_b32 v121, 0xffff0000, v104
  v_lshlrev_b32 v122, 16, v105
  v_and_b32 v123, 0xffff0000, v105
  v_cvt_pk_bf16_f32 v104, v124, v125
  v_cvt_pk_bf16_f32 v105, v126, v127
  v_lshlrev_b32 v124, 16, v104
  v_and_b32 v125, 0xffff0000, v104
  v_lshlrev_b32 v126, 16, v105
  v_and_b32 v127, 0xffff0000, v105
  v_add_f32 v124, 0x358637bd, v124
  v_add_f32 v125, 0x358637bd, v125
  v_add_f32 v126, 0x358637bd, v126
  v_add_f32 v127, 0x358637bd, v127
  v_cvt_pk_bf16_f32 v104, v124, v125
  v_cvt_pk_bf16_f32 v105, v126, v127
  v_lshlrev_b32 v124, 16, v104
  v_and_b32 v125, 0xffff0000, v104
  v_lshlrev_b32 v126, 16, v105
  v_and_b32 v127, 0xffff0000, v105
  v_rcp_f32 v124, v124
  v_rcp_f32 v125, v125
  v_rcp_f32 v126, v126
  v_rcp_f32 v127, v127
  v_mul_f32 v120, v120, v124
  v_mul_f32 v121, v121, v125
  v_mul_f32 v122, v122, v126
  v_mul_f32 v123, v123, v127
  v_cvt_pk_bf16_f32 v128, v120, v121
  v_cvt_pk_bf16_f32 v129, v122, v123
  ds_read_b64 v[88:89], v1 offset:12288
  ds_read_b64 v[90:91], v1 offset:12800
  ds_read_b64 v[92:93], v1 offset:4096
  ds_read_b64 v[94:95], v1 offset:4608
  ds_read_b64 v[96:97], v1 offset:21504
  ds_read_b64 v[98:99], v1 offset:22016
  s_waitcnt lgkmcnt(5)
  v_mfma_f32_16x16x16_bf16 v[120:123], v[88:89], v[40:41], 0
  s_waitcnt lgkmcnt(4)
  v_mfma_f32_16x16x16_bf16 v[124:127], v[90:91], v[40:41], 0
  s_waitcnt lgkmcnt(3)
  v_mfma_f32_16x16x16_bf16 v[120:123], v[92:93], v[42:43], v[120:123]
  s_waitcnt lgkmcnt(2)
  v_mfma_f32_16x16x16_bf16 v[124:127], v[94:95], v[42:43], v[124:127]
  s_waitcnt lgkmcnt(1)
  v_mfma_f32_16x16x16_bf16 v[120:123], v[96:97], v[44:45], v[120:123]
  s_waitcnt lgkmcnt(0)
  v_mfma_f32_16x16x16_bf16 v[124:127], v[98:99], v[44:45], v[124:127]
  s_nop 3
  v_cvt_pk_bf16_f32 v104, v120, v121
  v_cvt_pk_bf16_f32 v105, v122, v123
  v_lshlrev_b32 v120, 16, v104
  v_and_b32 v121, 0xffff0000, v104
  v_lshlrev_b32 v122, 16, v105
  v_and_b32 v123, 0xffff0000, v105
  v_cvt_pk_bf16_f32 v104, v124, v125
  v_cvt_pk_bf16_f32 v105, v126, v127
  v_lshlrev_b32 v124, 16, v104
  v_and_b32 v125, 0xffff0000, v104
  v_lshlrev_b32 v126, 16, v105
  v_and_b32 v127, 0xffff0000, v105
  v_add_f32 v124, 0x358637bd, v124
  v_add_f32 v125, 0x358637bd, v125
  v_add_f32 v126, 0x358637bd, v126
  v_add_f32 v127, 0x358637bd, v127
  v_cvt_pk_bf16_f32 v104, v124, v125
  v_cvt_pk_bf16_f32 v105, v126, v127
  v_lshlrev_b32 v124, 16, v104
  v_and_b32 v125, 0xffff0000, v104
  v_lshlrev_b32 v126, 16, v105
  v_and_b32 v127, 0xffff0000, v105
  v_rcp_f32 v124, v124
  v_rcp_f32 v125, v125
  v_rcp_f32 v126, v126
  v_rcp_f32 v127, v127
  v_mul_f32 v120, v120, v124
  v_mul_f32 v121, v121, v125
  v_mul_f32 v122, v122, v126
  v_mul_f32 v123, v123, v127
  v_cvt_pk_bf16_f32 v130, v120, v121
  v_cvt_pk_bf16_f32 v131, v122, v123
  ds_write_b128 v3, v[128:131] offset:24576
  ds_read_b64 v[88:89], v1 offset:13312
  ds_read_b64 v[90:91], v1 offset:13824
  ds_read_b64 v[92:93], v1 offset:5120
  ds_read_b64 v[94:95], v1 offset:5632
  ds_read_b64 v[96:97], v1 offset:22528
  ds_read_b64 v[98:99], v1 offset:23040
  s_waitcnt lgkmcnt(5)
  v_mfma_f32_16x16x16_bf16 v[120:123], v[88:89], v[42:43], 0
  s_waitcnt lgkmcnt(4)
  v_mfma_f32_16x16x16_bf16 v[124:127], v[90:91], v[42:43], 0
  s_waitcnt lgkmcnt(3)
  v_mfma_f32_16x16x16_bf16 v[120:123], v[92:93], v[44:45], v[120:123]
  s_waitcnt lgkmcnt(2)
  v_mfma_f32_16x16x16_bf16 v[124:127], v[94:95], v[44:45], v[124:127]
  s_waitcnt lgkmcnt(1)
  v_mfma_f32_16x16x16_bf16 v[120:123], v[96:97], v[46:47], v[120:123]
  s_waitcnt lgkmcnt(0)
  v_mfma_f32_16x16x16_bf16 v[124:127], v[98:99], v[46:47], v[124:127]
  s_nop 3
  v_cvt_pk_bf16_f32 v104, v120, v121
  v_cvt_pk_bf16_f32 v105, v122, v123
  v_lshlrev_b32 v120, 16, v104
  v_and_b32 v121, 0xffff0000, v104
  v_lshlrev_b32 v122, 16, v105
  v_and_b32 v123, 0xffff0000, v105
  v_cvt_pk_bf16_f32 v104, v124, v125
  v_cvt_pk_bf16_f32 v105, v126, v127
  v_lshlrev_b32 v124, 16, v104
  v_and_b32 v125, 0xffff0000, v104
  v_lshlrev_b32 v126, 16, v105
  v_and_b32 v127, 0xffff0000, v105
  v_add_f32 v124, 0x358637bd, v124
  v_add_f32 v125, 0x358637bd, v125
  v_add_f32 v126, 0x358637bd, v126
  v_add_f32 v127, 0x358637bd, v127
  v_cvt_pk_bf16_f32 v104, v124, v125
  v_cvt_pk_bf16_f32 v105, v126, v127
  v_lshlrev_b32 v124, 16, v104
  v_and_b32 v125, 0xffff0000, v104
  v_lshlrev_b32 v126, 16, v105
  v_and_b32 v127, 0xffff0000, v105
  v_rcp_f32 v124, v124
  v_rcp_f32 v125, v125
  v_rcp_f32 v126, v126
  v_rcp_f32 v127, v127
  v_mul_f32 v120, v120, v124
  v_mul_f32 v121, v121, v125
  v_mul_f32 v122, v122, v126
  v_mul_f32 v123, v123, v127
  v_cvt_pk_bf16_f32 v128, v120, v121
  v_cvt_pk_bf16_f32 v129, v122, v123
  ds_read_b64 v[88:89], v1 offset:14336
  ds_read_b64 v[90:91], v1 offset:14848
  ds_read_b64 v[92:93], v1 offset:6144
  ds_read_b64 v[94:95], v1 offset:6656
  ds_read_b64 v[96:97], v1 offset:23552
  ds_read_b64 v[98:99], v1 offset:24064
  s_waitcnt lgkmcnt(5)
  v_mfma_f32_16x16x16_bf16 v[120:123], v[88:89], v[44:45], 0
  s_waitcnt lgkmcnt(4)
  v_mfma_f32_16x16x16_bf16 v[124:127], v[90:91], v[44:45], 0
  s_waitcnt lgkmcnt(3)
  v_mfma_f32_16x16x16_bf16 v[120:123], v[92:93], v[46:47], v[120:123]
  s_waitcnt lgkmcnt(2)
  v_mfma_f32_16x16x16_bf16 v[124:127], v[94:95], v[46:47], v[124:127]
  s_waitcnt lgkmcnt(1)
  v_mfma_f32_16x16x16_bf16 v[120:123], v[96:97], v[48:49], v[120:123]
  s_waitcnt lgkmcnt(0)
  v_mfma_f32_16x16x16_bf16 v[124:127], v[98:99], v[48:49], v[124:127]
  s_nop 3
  v_cvt_pk_bf16_f32 v104, v120, v121
  v_cvt_pk_bf16_f32 v105, v122, v123
  v_lshlrev_b32 v120, 16, v104
  v_and_b32 v121, 0xffff0000, v104
  v_lshlrev_b32 v122, 16, v105
  v_and_b32 v123, 0xffff0000, v105
  v_cvt_pk_bf16_f32 v104, v124, v125
  v_cvt_pk_bf16_f32 v105, v126, v127
  v_lshlrev_b32 v124, 16, v104
  v_and_b32 v125, 0xffff0000, v104
  v_lshlrev_b32 v126, 16, v105
  v_and_b32 v127, 0xffff0000, v105
  v_add_f32 v124, 0x358637bd, v124
  v_add_f32 v125, 0x358637bd, v125
  v_add_f32 v126, 0x358637bd, v126
  v_add_f32 v127, 0x358637bd, v127
  v_cvt_pk_bf16_f32 v104, v124, v125
  v_cvt_pk_bf16_f32 v105, v126, v127
  v_lshlrev_b32 v124, 16, v104
  v_and_b32 v125, 0xffff0000, v104
  v_lshlrev_b32 v126, 16, v105
  v_and_b32 v127, 0xffff0000, v105
  v_rcp_f32 v124, v124
  v_rcp_f32 v125, v125
  v_rcp_f32 v126, v126
  v_rcp_f32 v127, v127
  v_mul_f32 v120, v120, v124
  v_mul_f32 v121, v121, v125
  v_mul_f32 v122, v122, v126
  v_mul_f32 v123, v123, v127
  v_cvt_pk_bf16_f32 v130, v120, v121
  v_cvt_pk_bf16_f32 v131, v122, v123
  ds_write_b128 v3, v[128:131] offset:28672
  ds_read_b64 v[88:89], v1 offset:15360
  ds_read_b64 v[90:91], v1 offset:15872
  ds_read_b64 v[92:93], v1 offset:7168
  ds_read_b64 v[94:95], v1 offset:7680
  ds_read_b64 v[96:97], v1 offset:24576
  ds_read_b64 v[98:99], v1 offset:25088
  s_waitcnt lgkmcnt(5)
  v_mfma_f32_16x16x16_bf16 v[120:123], v[88:89], v[46:47], 0
  s_waitcnt lgkmcnt(4)
  v_mfma_f32_16x16x16_bf16 v[124:127], v[90:91], v[46:47], 0
  s_waitcnt lgkmcnt(3)
  v_mfma_f32_16x16x16_bf16 v[120:123], v[92:93], v[48:49], v[120:123]
  s_waitcnt lgkmcnt(2)
  v_mfma_f32_16x16x16_bf16 v[124:127], v[94:95], v[48:49], v[124:127]
  s_waitcnt lgkmcnt(1)
  v_mfma_f32_16x16x16_bf16 v[120:123], v[96:97], v[50:51], v[120:123]
  s_waitcnt lgkmcnt(0)
  v_mfma_f32_16x16x16_bf16 v[124:127], v[98:99], v[50:51], v[124:127]
  s_nop 3
  v_cvt_pk_bf16_f32 v104, v120, v121
  v_cvt_pk_bf16_f32 v105, v122, v123
  v_lshlrev_b32 v120, 16, v104
  v_and_b32 v121, 0xffff0000, v104
  v_lshlrev_b32 v122, 16, v105
  v_and_b32 v123, 0xffff0000, v105
  v_cvt_pk_bf16_f32 v104, v124, v125
  v_cvt_pk_bf16_f32 v105, v126, v127
  v_lshlrev_b32 v124, 16, v104
  v_and_b32 v125, 0xffff0000, v104
  v_lshlrev_b32 v126, 16, v105
  v_and_b32 v127, 0xffff0000, v105
  v_add_f32 v124, 0x358637bd, v124
  v_add_f32 v125, 0x358637bd, v125
  v_add_f32 v126, 0x358637bd, v126
  v_add_f32 v127, 0x358637bd, v127
  v_cvt_pk_bf16_f32 v104, v124, v125
  v_cvt_pk_bf16_f32 v105, v126, v127
  v_lshlrev_b32 v124, 16, v104
  v_and_b32 v125, 0xffff0000, v104
  v_lshlrev_b32 v126, 16, v105
  v_and_b32 v127, 0xffff0000, v105
  v_rcp_f32 v124, v124
  v_rcp_f32 v125, v125
  v_rcp_f32 v126, v126
  v_rcp_f32 v127, v127
  v_mul_f32 v120, v120, v124
  v_mul_f32 v121, v121, v125
  v_mul_f32 v122, v122, v126
  v_mul_f32 v123, v123, v127
  v_cvt_pk_bf16_f32 v128, v120, v121
  v_cvt_pk_bf16_f32 v129, v122, v123
  ds_read_b64 v[88:89], v1 offset:16384
  ds_read_b64 v[90:91], v1 offset:16896
  ds_read_b64 v[92:93], v1 offset:8192
  ds_read_b64 v[94:95], v1 offset:8704
  s_waitcnt lgkmcnt(3)
  v_mfma_f32_16x16x16_bf16 v[120:123], v[88:89], v[48:49], 0
  s_waitcnt lgkmcnt(2)
  v_mfma_f32_16x16x16_bf16 v[124:127], v[90:91], v[48:49], 0
  s_waitcnt lgkmcnt(1)
  v_mfma_f32_16x16x16_bf16 v[120:123], v[92:93], v[50:51], v[120:123]
  s_waitcnt lgkmcnt(0)
  v_mfma_f32_16x16x16_bf16 v[124:127], v[94:95], v[50:51], v[124:127]
  s_nop 3
  v_cvt_pk_bf16_f32 v104, v120, v121
  v_cvt_pk_bf16_f32 v105, v122, v123
  v_lshlrev_b32 v120, 16, v104
  v_and_b32 v121, 0xffff0000, v104
  v_lshlrev_b32 v122, 16, v105
  v_and_b32 v123, 0xffff0000, v105
  v_cvt_pk_bf16_f32 v104, v124, v125
  v_cvt_pk_bf16_f32 v105, v126, v127
  v_lshlrev_b32 v124, 16, v104
  v_and_b32 v125, 0xffff0000, v104
  v_lshlrev_b32 v126, 16, v105
  v_and_b32 v127, 0xffff0000, v105
  v_add_f32 v124, 0x358637bd, v124
  v_add_f32 v125, 0x358637bd, v125
  v_add_f32 v126, 0x358637bd, v126
  v_add_f32 v127, 0x358637bd, v127
  v_cvt_pk_bf16_f32 v104, v124, v125
  v_cvt_pk_bf16_f32 v105, v126, v127
  v_lshlrev_b32 v124, 16, v104
  v_and_b32 v125, 0xffff0000, v104
  v_lshlrev_b32 v126, 16, v105
  v_and_b32 v127, 0xffff0000, v105
  v_rcp_f32 v124, v124
  v_rcp_f32 v125, v125
  v_rcp_f32 v126, v126
  v_rcp_f32 v127, v127
  v_mul_f32 v120, v120, v124
  v_mul_f32 v121, v121, v125
  v_mul_f32 v122, v122, v126
  v_mul_f32 v123, v123, v127
  v_cvt_pk_bf16_f32 v130, v120, v121
  v_cvt_pk_bf16_f32 v131, v122, v123
  ds_write_b128 v3, v[128:131] offset:32768
  s_barrier
  s_lshl_b32 s32, s28, 10
  s_add_u32 s33, s32, 93374464
  v_add_u32 v4, s32, v2
  buffer_load_dwordx4 v[192:195], v2, s[16:19], s33 offen sc1
  s_add_u32 s33, s33, 4096
  buffer_load_dwordx4 v[196:199], v2, s[16:19], s33 offen sc1
  s_add_u32 s33, s33, 4096
  buffer_load_dwordx4 v[200:203], v2, s[16:19], s33 offen sc1
  s_add_u32 s33, s33, 4096
  buffer_load_dwordx4 v[204:207], v2, s[16:19], s33 offen sc1
  s_add_u32 s33, s33, 4096
  buffer_load_dwordx4 v[208:211], v2, s[16:19], s33 offen sc1
  s_add_u32 s33, s33, 4096
  buffer_load_dwordx4 v[212:215], v2, s[16:19], s33 offen sc1
  s_add_u32 s33, s33, 4096
  s_cmp_eq_u32 s28, 0
  s_cbranch_scc0 B2k_29
  buffer_load_dwordx4 v[216:219], v2, s[16:19], s33 offen sc1
  s_waitcnt vmcnt(0)
  ds_write_b128 v4, v[216:219] offset:24576
B2k_29:
  s_waitcnt vmcnt(0)
  ds_write_b128 v4, v[192:195] offset:0
  ds_write_b128 v4, v[196:199] offset:4096
  ds_write_b128 v4, v[200:203] offset:8192
  ds_write_b128 v4, v[204:207] offset:12288
  ds_write_b128 v4, v[208:211] offset:16384
  ds_write_b128 v4, v[212:215] offset:20480
  s_waitcnt lgkmcnt(0)
  s_barrier
  ds_read_b64 v[88:89], v1 offset:0
  ds_read_b64 v[90:91], v1 offset:512
  ds_read_b64 v[92:93], v1 offset:17408
  ds_read_b64 v[94:95], v1 offset:17920
  s_waitcnt lgkmcnt(3)
  v_mfma_f32_16x16x16_bf16 v[120:123], v[88:89], v[52:53], 0
  s_waitcnt lgkmcnt(2)
  v_mfma_f32_16x16x16_bf16 v[124:127], v[90:91], v[52:53], 0
  s_waitcnt lgkmcnt(1)
  v_mfma_f32_16x16x16_bf16 v[120:123], v[92:93], v[54:55], v[120:123]
  s_waitcnt lgkmcnt(0)
  v_mfma_f32_16x16x16_bf16 v[124:127], v[94:95], v[54:55], v[124:127]
  s_nop 3
  v_cvt_pk_bf16_f32 v104, v120, v121
  v_cvt_pk_bf16_f32 v105, v122, v123
  v_lshlrev_b32 v120, 16, v104
  v_and_b32 v121, 0xffff0000, v104
  v_lshlrev_b32 v122, 16, v105
  v_and_b32 v123, 0xffff0000, v105
  v_cvt_pk_bf16_f32 v104, v124, v125
  v_cvt_pk_bf16_f32 v105, v126, v127
  v_lshlrev_b32 v124, 16, v104
  v_and_b32 v125, 0xffff0000, v104
  v_lshlrev_b32 v126, 16, v105
  v_and_b32 v127, 0xffff0000, v105
  v_add_f32 v124, 0x358637bd, v124
  v_add_f32 v125, 0x358637bd, v125
  v_add_f32 v126, 0x358637bd, v126
  v_add_f32 v127, 0x358637bd, v127
  v_cvt_pk_bf16_f32 v104, v124, v125
  v_cvt_pk_bf16_f32 v105, v126, v127
  v_lshlrev_b32 v124, 16, v104
  v_and_b32 v125, 0xffff0000, v104
  v_lshlrev_b32 v126, 16, v105
  v_and_b32 v127, 0xffff0000, v105
  v_rcp_f32 v124, v124
  v_rcp_f32 v125, v125
  v_rcp_f32 v126, v126
  v_rcp_f32 v127, v127
  v_mul_f32 v120, v120, v124
  v_mul_f32 v121, v121, v125
  v_mul_f32 v122, v122, v126
  v_mul_f32 v123, v123, v127
  v_cvt_pk_bf16_f32 v128, v120, v121
  v_cvt_pk_bf16_f32 v129, v122, v123
  ds_read_b64 v[88:89], v1 offset:9216
  ds_read_b64 v[90:91], v1 offset:9728
  ds_read_b64 v[92:93], v1 offset:1024
  ds_read_b64 v[94:95], v1 offset:1536
  ds_read_b64 v[96:97], v1 offset:18432
  ds_read_b64 v[98:99], v1 offset:18944
  s_waitcnt lgkmcnt(5)
  v_mfma_f32_16x16x16_bf16 v[120:123], v[88:89], v[52:53], 0
  s_waitcnt lgkmcnt(4)
  v_mfma_f32_16x16x16_bf16 v[124:127], v[90:91], v[52:53], 0
  s_waitcnt lgkmcnt(3)
  v_mfma_f32_16x16x16_bf16 v[120:123], v[92:93], v[54:55], v[120:123]
  s_waitcnt lgkmcnt(2)
  v_mfma_f32_16x16x16_bf16 v[124:127], v[94:95], v[54:55], v[124:127]
  s_waitcnt lgkmcnt(1)
  v_mfma_f32_16x16x16_bf16 v[120:123], v[96:97], v[56:57], v[120:123]
  s_waitcnt lgkmcnt(0)
  v_mfma_f32_16x16x16_bf16 v[124:127], v[98:99], v[56:57], v[124:127]
  s_nop 3
  v_cvt_pk_bf16_f32 v104, v120, v121
  v_cvt_pk_bf16_f32 v105, v122, v123
  v_lshlrev_b32 v120, 16, v104
  v_and_b32 v121, 0xffff0000, v104
  v_lshlrev_b32 v122, 16, v105
  v_and_b32 v123, 0xffff0000, v105
  v_cvt_pk_bf16_f32 v104, v124, v125
  v_cvt_pk_bf16_f32 v105, v126, v127
  v_lshlrev_b32 v124, 16, v104
  v_and_b32 v125, 0xffff0000, v104
  v_lshlrev_b32 v126, 16, v105
  v_and_b32 v127, 0xffff0000, v105
  v_add_f32 v124, 0x358637bd, v124
  v_add_f32 v125, 0x358637bd, v125
  v_add_f32 v126, 0x358637bd, v126
  v_add_f32 v127, 0x358637bd, v127
  v_cvt_pk_bf16_f32 v104, v124, v125
  v_cvt_pk_bf16_f32 v105, v126, v127
  v_lshlrev_b32 v124, 16, v104
  v_and_b32 v125, 0xffff0000, v104
  v_lshlrev_b32 v126, 16, v105
  v_and_b32 v127, 0xffff0000, v105
  v_rcp_f32 v124, v124
  v_rcp_f32 v125, v125
  v_rcp_f32 v126, v126
  v_rcp_f32 v127, v127
  v_mul_f32 v120, v120, v124
  v_mul_f32 v121, v121, v125
  v_mul_f32 v122, v122, v126
  v_mul_f32 v123, v123, v127
  v_cvt_pk_bf16_f32 v130, v120, v121
  v_cvt_pk_bf16_f32 v131, v122, v123
  ds_write_b128 v3, v[128:131] offset:36864
  ds_read_b64 v[88:89], v1 offset:10240
  ds_read_b64 v[90:91], v1 offset:10752
  ds_read_b64 v[92:93], v1 offset:2048
  ds_read_b64 v[94:95], v1 offset:2560
  ds_read_b64 v[96:97], v1 offset:19456
  ds_read_b64 v[98:99], v1 offset:19968
  s_waitcnt lgkmcnt(5)
  v_mfma_f32_16x16x16_bf16 v[120:123], v[88:89], v[54:55], 0
  s_waitcnt lgkmcnt(4)
  v_mfma_f32_16x16x16_bf16 v[124:127], v[90:91], v[54:55], 0
  s_waitcnt lgkmcnt(3)
  v_mfma_f32_16x16x16_bf16 v[120:123], v[92:93], v[56:57], v[120:123]
  s_waitcnt lgkmcnt(2)
  v_mfma_f32_16x16x16_bf16 v[124:127], v[94:95], v[56:57], v[124:127]
  s_waitcnt lgkmcnt(1)
  v_mfma_f32_16x16x16_bf16 v[120:123], v[96:97], v[58:59], v[120:123]
  s_waitcnt lgkmcnt(0)
  v_mfma_f32_16x16x16_bf16 v[124:127], v[98:99], v[58:59], v[124:127]
  s_nop 3
  v_cvt_pk_bf16_f32 v104, v120, v121
  v_cvt_pk_bf16_f32 v105, v122, v123
  v_lshlrev_b32 v120, 16, v104
  v_and_b32 v121, 0xffff0000, v104
  v_lshlrev_b32 v122, 16, v105
  v_and_b32 v123, 0xffff0000, v105
  v_cvt_pk_bf16_f32 v104, v124, v125
  v_cvt_pk_bf16_f32 v105, v126, v127
  v_lshlrev_b32 v124, 16, v104
  v_and_b32 v125, 0xffff0000, v104
  v_lshlrev_b32 v126, 16, v105
  v_and_b32 v127, 0xffff0000, v105
  v_add_f32 v124, 0x358637bd, v124
  v_add_f32 v125, 0x358637bd, v125
  v_add_f32 v126, 0x358637bd, v126
  v_add_f32 v127, 0x358637bd, v127
  v_cvt_pk_bf16_f32 v104, v124, v125
  v_cvt_pk_bf16_f32 v105, v126, v127
  v_lshlrev_b32 v124, 16, v104
  v_and_b32 v125, 0xffff0000, v104
  v_lshlrev_b32 v126, 16, v105
  v_and_b32 v127, 0xffff0000, v105
  v_rcp_f32 v124, v124
  v_rcp_f32 v125, v125
  v_rcp_f32 v126, v126
  v_rcp_f32 v127, v127
  v_mul_f32 v120, v120, v124
  v_mul_f32 v121, v121, v125
  v_mul_f32 v122, v122, v126
  v_mul_f32 v123, v123, v127
  v_cvt_pk_bf16_f32 v128, v120, v121
  v_cvt_pk_bf16_f32 v129, v122, v123
  ds_read_b64 v[88:89], v1 offset:11264
  ds_read_b64 v[90:91], v1 offset:11776
  ds_read_b64 v[92:93], v1 offset:3072
  ds_read_b64 v[94:95], v1 offset:3584
  ds_read_b64 v[96:97], v1 offset:20480
  ds_read_b64 v[98:99], v1 offset:20992
  s_waitcnt lgkmcnt(5)
  v_mfma_f32_16x16x16_bf16 v[120:123], v[88:89], v[56:57], 0
  s_waitcnt lgkmcnt(4)
  v_mfma_f32_16x16x16_bf16 v[124:127], v[90:91], v[56:57], 0
  s_waitcnt lgkmcnt(3)
  v_mfma_f32_16x16x16_bf16 v[120:123], v[92:93], v[58:59], v[120:123]
  s_waitcnt lgkmcnt(2)
  v_mfma_f32_16x16x16_bf16 v[124:127], v[94:95], v[58:59], v[124:127]
  s_waitcnt lgkmcnt(1)
  v_mfma_f32_16x16x16_bf16 v[120:123], v[96:97], v[60:61], v[120:123]
  s_waitcnt lgkmcnt(0)
  v_mfma_f32_16x16x16_bf16 v[124:127], v[98:99], v[60:61], v[124:127]
  s_nop 3
  v_cvt_pk_bf16_f32 v104, v120, v121
  v_cvt_pk_bf16_f32 v105, v122, v123
  v_lshlrev_b32 v120, 16, v104
  v_and_b32 v121, 0xffff0000, v104
  v_lshlrev_b32 v122, 16, v105
  v_and_b32 v123, 0xffff0000, v105
  v_cvt_pk_bf16_f32 v104, v124, v125
  v_cvt_pk_bf16_f32 v105, v126, v127
  v_lshlrev_b32 v124, 16, v104
  v_and_b32 v125, 0xffff0000, v104
  v_lshlrev_b32 v126, 16, v105
  v_and_b32 v127, 0xffff0000, v105
  v_add_f32 v124, 0x358637bd, v124
  v_add_f32 v125, 0x358637bd, v125
  v_add_f32 v126, 0x358637bd, v126
  v_add_f32 v127, 0x358637bd, v127
  v_cvt_pk_bf16_f32 v104, v124, v125
  v_cvt_pk_bf16_f32 v105, v126, v127
  v_lshlrev_b32 v124, 16, v104
  v_and_b32 v125, 0xffff0000, v104
  v_lshlrev_b32 v126, 16, v105
  v_and_b32 v127, 0xffff0000, v105
  v_rcp_f32 v124, v124
  v_rcp_f32 v125, v125
  v_rcp_f32 v126, v126
  v_rcp_f32 v127, v127
  v_mul_f32 v120, v120, v124
  v_mul_f32 v121, v121, v125
  v_mul_f32 v122, v122, v126
  v_mul_f32 v123, v123, v127
  v_cvt_pk_bf16_f32 v130, v120, v121
  v_cvt_pk_bf16_f32 v131, v122, v123
  ds_write_b128 v3, v[128:131] offset:40960
  ds_read_b64 v[88:89], v1 offset:12288
  ds_read_b64 v[90:91], v1 offset:12800
  ds_read_b64 v[92:93], v1 offset:4096
  ds_read_b64 v[94:95], v1 offset:4608
  ds_read_b64 v[96:97], v1 offset:21504
  ds_read_b64 v[98:99], v1 offset:22016
  s_waitcnt lgkmcnt(5)
  v_mfma_f32_16x16x16_bf16 v[120:123], v[88:89], v[58:59], 0
  s_waitcnt lgkmcnt(4)
  v_mfma_f32_16x16x16_bf16 v[124:127], v[90:91], v[58:59], 0
  s_waitcnt lgkmcnt(3)
  v_mfma_f32_16x16x16_bf16 v[120:123], v[92:93], v[60:61], v[120:123]
  s_waitcnt lgkmcnt(2)
  v_mfma_f32_16x16x16_bf16 v[124:127], v[94:95], v[60:61], v[124:127]
  s_waitcnt lgkmcnt(1)
  v_mfma_f32_16x16x16_bf16 v[120:123], v[96:97], v[62:63], v[120:123]
  s_waitcnt lgkmcnt(0)
  v_mfma_f32_16x16x16_bf16 v[124:127], v[98:99], v[62:63], v[124:127]
  s_nop 3
  v_cvt_pk_bf16_f32 v104, v120, v121
  v_cvt_pk_bf16_f32 v105, v122, v123
  v_lshlrev_b32 v120, 16, v104
  v_and_b32 v121, 0xffff0000, v104
  v_lshlrev_b32 v122, 16, v105
  v_and_b32 v123, 0xffff0000, v105
  v_cvt_pk_bf16_f32 v104, v124, v125
  v_cvt_pk_bf16_f32 v105, v126, v127
  v_lshlrev_b32 v124, 16, v104
  v_and_b32 v125, 0xffff0000, v104
  v_lshlrev_b32 v126, 16, v105
  v_and_b32 v127, 0xffff0000, v105
  v_add_f32 v124, 0x358637bd, v124
  v_add_f32 v125, 0x358637bd, v125
  v_add_f32 v126, 0x358637bd, v126
  v_add_f32 v127, 0x358637bd, v127
  v_cvt_pk_bf16_f32 v104, v124, v125
  v_cvt_pk_bf16_f32 v105, v126, v127
  v_lshlrev_b32 v124, 16, v104
  v_and_b32 v125, 0xffff0000, v104
  v_lshlrev_b32 v126, 16, v105
  v_and_b32 v127, 0xffff0000, v105
  v_rcp_f32 v124, v124
  v_rcp_f32 v125, v125
  v_rcp_f32 v126, v126
  v_rcp_f32 v127, v127
  v_mul_f32 v120, v120, v124
  v_mul_f32 v121, v121, v125
  v_mul_f32 v122, v122, v126
  v_mul_f32 v123, v123, v127
  v_cvt_pk_bf16_f32 v128, v120, v121
  v_cvt_pk_bf16_f32 v129, v122, v123
  ds_read_b64 v[88:89], v1 offset:13312
  ds_read_b64 v[90:91], v1 offset:13824
  ds_read_b64 v[92:93], v1 offset:5120
  ds_read_b64 v[94:95], v1 offset:5632
  ds_read_b64 v[96:97], v1 offset:22528
  ds_read_b64 v[98:99], v1 offset:23040
  s_waitcnt lgkmcnt(5)
  v_mfma_f32_16x16x16_bf16 v[120:123], v[88:89], v[60:61], 0
  s_waitcnt lgkmcnt(4)
  v_mfma_f32_16x16x16_bf16 v[124:127], v[90:91], v[60:61], 0
  s_waitcnt lgkmcnt(3)
  v_mfma_f32_16x16x16_bf16 v[120:123], v[92:93], v[62:63], v[120:123]
  s_waitcnt lgkmcnt(2)
  v_mfma_f32_16x16x16_bf16 v[124:127], v[94:95], v[62:63], v[124:127]
  s_waitcnt lgkmcnt(1)
  v_mfma_f32_16x16x16_bf16 v[120:123], v[96:97], v[64:65], v[120:123]
  s_waitcnt lgkmcnt(0)
  v_mfma_f32_16x16x16_bf16 v[124:127], v[98:99], v[64:65], v[124:127]
  s_nop 3
  v_cvt_pk_bf16_f32 v104, v120, v121
  v_cvt_pk_bf16_f32 v105, v122, v123
  v_lshlrev_b32 v120, 16, v104
  v_and_b32 v121, 0xffff0000, v104
  v_lshlrev_b32 v122, 16, v105
  v_and_b32 v123, 0xffff0000, v105
  v_cvt_pk_bf16_f32 v104, v124, v125
  v_cvt_pk_bf16_f32 v105, v126, v127
  v_lshlrev_b32 v124, 16, v104
  v_and_b32 v125, 0xffff0000, v104
  v_lshlrev_b32 v126, 16, v105
  v_and_b32 v127, 0xffff0000, v105
  v_add_f32 v124, 0x358637bd, v124
  v_add_f32 v125, 0x358637bd, v125
  v_add_f32 v126, 0x358637bd, v126
  v_add_f32 v127, 0x358637bd, v127
  v_cvt_pk_bf16_f32 v104, v124, v125
  v_cvt_pk_bf16_f32 v105, v126, v127
  v_lshlrev_b32 v124, 16, v104
  v_and_b32 v125, 0xffff0000, v104
  v_lshlrev_b32 v126, 16, v105
  v_and_b32 v127, 0xffff0000, v105
  v_rcp_f32 v124, v124
  v_rcp_f32 v125, v125
  v_rcp_f32 v126, v126
  v_rcp_f32 v127, v127
  v_mul_f32 v120, v120, v124
  v_mul_f32 v121, v121, v125
  v_mul_f32 v122, v122, v126
  v_mul_f32 v123, v123, v127
  v_cvt_pk_bf16_f32 v130, v120, v121
  v_cvt_pk_bf16_f32 v131, v122, v123
  ds_write_b128 v3, v[128:131] offset:45056
  ds_read_b64 v[88:89], v1 offset:14336
  ds_read_b64 v[90:91], v1 offset:14848
  ds_read_b64 v[92:93], v1 offset:6144
  ds_read_b64 v[94:95], v1 offset:6656
  ds_read_b64 v[96:97], v1 offset:23552
  ds_read_b64 v[98:99], v1 offset:24064
  s_waitcnt lgkmcnt(5)
  v_mfma_f32_16x16x16_bf16 v[120:123], v[88:89], v[62:63], 0
  s_waitcnt lgkmcnt(4)
  v_mfma_f32_16x16x16_bf16 v[124:127], v[90:91], v[62:63], 0
  s_waitcnt lgkmcnt(3)
  v_mfma_f32_16x16x16_bf16 v[120:123], v[92:93], v[64:65], v[120:123]
  s_waitcnt lgkmcnt(2)
  v_mfma_f32_16x16x16_bf16 v[124:127], v[94:95], v[64:65], v[124:127]
  s_waitcnt lgkmcnt(1)
  v_mfma_f32_16x16x16_bf16 v[120:123], v[96:97], v[66:67], v[120:123]
  s_waitcnt lgkmcnt(0)
  v_mfma_f32_16x16x16_bf16 v[124:127], v[98:99], v[66:67], v[124:127]
  s_nop 3
  v_cvt_pk_bf16_f32 v104, v120, v121
  v_cvt_pk_bf16_f32 v105, v122, v123
  v_lshlrev_b32 v120, 16, v104
  v_and_b32 v121, 0xffff0000, v104
  v_lshlrev_b32 v122, 16, v105
  v_and_b32 v123, 0xffff0000, v105
  v_cvt_pk_bf16_f32 v104, v124, v125
  v_cvt_pk_bf16_f32 v105, v126, v127
  v_lshlrev_b32 v124, 16, v104
  v_and_b32 v125, 0xffff0000, v104
  v_lshlrev_b32 v126, 16, v105
  v_and_b32 v127, 0xffff0000, v105
  v_add_f32 v124, 0x358637bd, v124
  v_add_f32 v125, 0x358637bd, v125
  v_add_f32 v126, 0x358637bd, v126
  v_add_f32 v127, 0x358637bd, v127
  v_cvt_pk_bf16_f32 v104, v124, v125
  v_cvt_pk_bf16_f32 v105, v126, v127
  v_lshlrev_b32 v124, 16, v104
  v_and_b32 v125, 0xffff0000, v104
  v_lshlrev_b32 v126, 16, v105
  v_and_b32 v127, 0xffff0000, v105
  v_rcp_f32 v124, v124
  v_rcp_f32 v125, v125
  v_rcp_f32 v126, v126
  v_rcp_f32 v127, v127
  v_mul_f32 v120, v120, v124
  v_mul_f32 v121, v121, v125
  v_mul_f32 v122, v122, v126
  v_mul_f32 v123, v123, v127
  v_cvt_pk_bf16_f32 v128, v120, v121
  v_cvt_pk_bf16_f32 v129, v122, v123
  ds_read_b64 v[88:89], v1 offset:15360
  ds_read_b64 v[90:91], v1 offset:15872
  ds_read_b64 v[92:93], v1 offset:7168
  ds_read_b64 v[94:95], v1 offset:7680
  ds_read_b64 v[96:97], v1 offset:24576
  ds_read_b64 v[98:99], v1 offset:25088
  s_waitcnt lgkmcnt(5)
  v_mfma_f32_16x16x16_bf16 v[120:123], v[88:89], v[64:65], 0
  s_waitcnt lgkmcnt(4)
  v_mfma_f32_16x16x16_bf16 v[124:127], v[90:91], v[64:65], 0
  s_waitcnt lgkmcnt(3)
  v_mfma_f32_16x16x16_bf16 v[120:123], v[92:93], v[66:67], v[120:123]
  s_waitcnt lgkmcnt(2)
  v_mfma_f32_16x16x16_bf16 v[124:127], v[94:95], v[66:67], v[124:127]
  s_waitcnt lgkmcnt(1)
  v_mfma_f32_16x16x16_bf16 v[120:123], v[96:97], v[68:69], v[120:123]
  s_waitcnt lgkmcnt(0)
  v_mfma_f32_16x16x16_bf16 v[124:127], v[98:99], v[68:69], v[124:127]
  s_nop 3
  v_cvt_pk_bf16_f32 v104, v120, v121
  v_cvt_pk_bf16_f32 v105, v122, v123
  v_lshlrev_b32 v120, 16, v104
  v_and_b32 v121, 0xffff0000, v104
  v_lshlrev_b32 v122, 16, v105
  v_and_b32 v123, 0xffff0000, v105
  v_cvt_pk_bf16_f32 v104, v124, v125
  v_cvt_pk_bf16_f32 v105, v126, v127
  v_lshlrev_b32 v124, 16, v104
  v_and_b32 v125, 0xffff0000, v104
  v_lshlrev_b32 v126, 16, v105
  v_and_b32 v127, 0xffff0000, v105
  v_add_f32 v124, 0x358637bd, v124
  v_add_f32 v125, 0x358637bd, v125
  v_add_f32 v126, 0x358637bd, v126
  v_add_f32 v127, 0x358637bd, v127
  v_cvt_pk_bf16_f32 v104, v124, v125
  v_cvt_pk_bf16_f32 v105, v126, v127
  v_lshlrev_b32 v124, 16, v104
  v_and_b32 v125, 0xffff0000, v104
  v_lshlrev_b32 v126, 16, v105
  v_and_b32 v127, 0xffff0000, v105
  v_rcp_f32 v124, v124
  v_rcp_f32 v125, v125
  v_rcp_f32 v126, v126
  v_rcp_f32 v127, v127
  v_mul_f32 v120, v120, v124
  v_mul_f32 v121, v121, v125
  v_mul_f32 v122, v122, v126
  v_mul_f32 v123, v123, v127
  v_cvt_pk_bf16_f32 v130, v120, v121
  v_cvt_pk_bf16_f32 v131, v122, v123
  ds_write_b128 v3, v[128:131] offset:49152
  ds_read_b64 v[88:89], v1 offset:16384
  ds_read_b64 v[90:91], v1 offset:16896
  ds_read_b64 v[92:93], v1 offset:8192
  ds_read_b64 v[94:95], v1 offset:8704
  s_waitcnt lgkmcnt(3)
  v_mfma_f32_16x16x16_bf16 v[120:123], v[88:89], v[66:67], 0
  s_waitcnt lgkmcnt(2)
  v_mfma_f32_16x16x16_bf16 v[124:127], v[90:91], v[66:67], 0
  s_waitcnt lgkmcnt(1)
  v_mfma_f32_16x16x16_bf16 v[120:123], v[92:93], v[68:69], v[120:123]
  s_waitcnt lgkmcnt(0)
  v_mfma_f32_16x16x16_bf16 v[124:127], v[94:95], v[68:69], v[124:127]
  s_nop 3
  v_cvt_pk_bf16_f32 v104, v120, v121
  v_cvt_pk_bf16_f32 v105, v122, v123
  v_lshlrev_b32 v120, 16, v104
  v_and_b32 v121, 0xffff0000, v104
  v_lshlrev_b32 v122, 16, v105
  v_and_b32 v123, 0xffff0000, v105
  v_cvt_pk_bf16_f32 v104, v124, v125
  v_cvt_pk_bf16_f32 v105, v126, v127
  v_lshlrev_b32 v124, 16, v104
  v_and_b32 v125, 0xffff0000, v104
  v_lshlrev_b32 v126, 16, v105
  v_and_b32 v127, 0xffff0000, v105
  v_add_f32 v124, 0x358637bd, v124
  v_add_f32 v125, 0x358637bd, v125
  v_add_f32 v126, 0x358637bd, v126
  v_add_f32 v127, 0x358637bd, v127
  v_cvt_pk_bf16_f32 v104, v124, v125
  v_cvt_pk_bf16_f32 v105, v126, v127
  v_lshlrev_b32 v124, 16, v104
  v_and_b32 v125, 0xffff0000, v104
  v_lshlrev_b32 v126, 16, v105
  v_and_b32 v127, 0xffff0000, v105
  v_rcp_f32 v124, v124
  v_rcp_f32 v125, v125
  v_rcp_f32 v126, v126
  v_rcp_f32 v127, v127
  v_mul_f32 v120, v120, v124
  v_mul_f32 v121, v121, v125
  v_mul_f32 v122, v122, v126
  v_mul_f32 v123, v123, v127
  v_cvt_pk_bf16_f32 v128, v120, v121
  v_cvt_pk_bf16_f32 v129, v122, v123
  s_barrier
  s_lshl_b32 s32, s28, 10
  s_add_u32 s33, s32, 93400064
  v_add_u32 v4, s32, v2
  buffer_load_dwordx4 v[192:195], v2, s[16:19], s33 offen sc1
  s_add_u32 s33, s33, 4096
  buffer_load_dwordx4 v[196:199], v2, s[16:19], s33 offen sc1
  s_add_u32 s33, s33, 4096
  buffer_load_dwordx4 v[200:203], v2, s[16:19], s33 offen sc1
  s_add_u32 s33, s33, 4096
  buffer_load_dwordx4 v[204:207], v2, s[16:19], s33 offen sc1
  s_add_u32 s33, s33, 4096
  buffer_load_dwordx4 v[208:211], v2, s[16:19], s33 offen sc1
  s_add_u32 s33, s33, 4096
  buffer_load_dwordx4 v[212:215], v2, s[16:19], s33 offen sc1
  s_add_u32 s33, s33, 4096
  s_cmp_eq_u32 s28, 0
  s_cbranch_scc0 B2k_30
  buffer_load_dwordx4 v[216:219], v2, s[16:19], s33 offen sc1
  s_waitcnt vmcnt(0)
  ds_write_b128 v4, v[216:219] offset:24576
B2k_30:
  s_waitcnt vmcnt(0)
  ds_write_b128 v4, v[192:195] offset:0
  ds_write_b128 v4, v[196:199] offset:4096
  ds_write_b128 v4, v[200:203] offset:8192
  ds_write_b128 v4, v[204:207] offset:12288
  ds_write_b128 v4, v[208:211] offset:16384
  ds_write_b128 v4, v[212:215] offset:20480
  s_waitcnt lgkmcnt(0)
  s_barrier
  ds_read_b64 v[88:89], v1 offset:0
  ds_read_b64 v[90:91], v1 offset:512
  ds_read_b64 v[92:93], v1 offset:17408
  ds_read_b64 v[94:95], v1 offset:17920
  s_waitcnt lgkmcnt(3)
  v_mfma_f32_16x16x16_bf16 v[120:123], v[88:89], v[70:71], 0
  s_waitcnt lgkmcnt(2)
  v_mfma_f32_16x16x16_bf16 v[124:127], v[90:91], v[70:71], 0
  s_waitcnt lgkmcnt(1)
  v_mfma_f32_16x16x16_bf16 v[120:123], v[92:93], v[72:73], v[120:123]
  s_waitcnt lgkmcnt(0)
  v_mfma_f32_16x16x16_bf16 v[124:127], v[94:95], v[72:73], v[124:127]
  s_nop 3
  v_cvt_pk_bf16_f32 v104, v120, v121
  v_cvt_pk_bf16_f32 v105, v122, v123
  v_lshlrev_b32 v120, 16, v104
  v_and_b32 v121, 0xffff0000, v104
  v_lshlrev_b32 v122, 16, v105
  v_and_b32 v123, 0xffff0000, v105
  v_cvt_pk_bf16_f32 v104, v124, v125
  v_cvt_pk_bf16_f32 v105, v126, v127
  v_lshlrev_b32 v124, 16, v104
  v_and_b32 v125, 0xffff0000, v104
  v_lshlrev_b32 v126, 16, v105
  v_and_b32 v127, 0xffff0000, v105
  v_add_f32 v124, 0x358637bd, v124
  v_add_f32 v125, 0x358637bd, v125
  v_add_f32 v126, 0x358637bd, v126
  v_add_f32 v127, 0x358637bd, v127
  v_cvt_pk_bf16_f32 v104, v124, v125
  v_cvt_pk_bf16_f32 v105, v126, v127
  v_lshlrev_b32 v124, 16, v104
  v_and_b32 v125, 0xffff0000, v104
  v_lshlrev_b32 v126, 16, v105
  v_and_b32 v127, 0xffff0000, v105
  v_rcp_f32 v124, v124
  v_rcp_f32 v125, v125
  v_rcp_f32 v126, v126
  v_rcp_f32 v127, v127
  v_mul_f32 v120, v120, v124
  v_mul_f32 v121, v121, v125
  v_mul_f32 v122, v122, v126
  v_mul_f32 v123, v123, v127
  v_cvt_pk_bf16_f32 v130, v120, v121
  v_cvt_pk_bf16_f32 v131, v122, v123
  ds_write_b128 v3, v[128:131] offset:53248
  ds_read_b64 v[88:89], v1 offset:9216
  ds_read_b64 v[90:91], v1 offset:9728
  ds_read_b64 v[92:93], v1 offset:1024
  ds_read_b64 v[94:95], v1 offset:1536
  ds_read_b64 v[96:97], v1 offset:18432
  ds_read_b64 v[98:99], v1 offset:18944
  s_waitcnt lgkmcnt(5)
  v_mfma_f32_16x16x16_bf16 v[120:123], v[88:89], v[70:71], 0
  s_waitcnt lgkmcnt(4)
  v_mfma_f32_16x16x16_bf16 v[124:127], v[90:91], v[70:71], 0
  s_waitcnt lgkmcnt(3)
  v_mfma_f32_16x16x16_bf16 v[120:123], v[92:93], v[72:73], v[120:123]
  s_waitcnt lgkmcnt(2)
  v_mfma_f32_16x16x16_bf16 v[124:127], v[94:95], v[72:73], v[124:127]
  s_waitcnt lgkmcnt(1)
  v_mfma_f32_16x16x16_bf16 v[120:123], v[96:97], v[74:75], v[120:123]
  s_waitcnt lgkmcnt(0)
  v_mfma_f32_16x16x16_bf16 v[124:127], v[98:99], v[74:75], v[124:127]
  s_nop 3
  v_cvt_pk_bf16_f32 v104, v120, v121
  v_cvt_pk_bf16_f32 v105, v122, v123
  v_lshlrev_b32 v120, 16, v104
  v_and_b32 v121, 0xffff0000, v104
  v_lshlrev_b32 v122, 16, v105
  v_and_b32 v123, 0xffff0000, v105
  v_cvt_pk_bf16_f32 v104, v124, v125
  v_cvt_pk_bf16_f32 v105, v126, v127
  v_lshlrev_b32 v124, 16, v104
  v_and_b32 v125, 0xffff0000, v104
  v_lshlrev_b32 v126, 16, v105
  v_and_b32 v127, 0xffff0000, v105
  v_add_f32 v124, 0x358637bd, v124
  v_add_f32 v125, 0x358637bd, v125
  v_add_f32 v126, 0x358637bd, v126
  v_add_f32 v127, 0x358637bd, v127
  v_cvt_pk_bf16_f32 v104, v124, v125
  v_cvt_pk_bf16_f32 v105, v126, v127
  v_lshlrev_b32 v124, 16, v104
  v_and_b32 v125, 0xffff0000, v104
  v_lshlrev_b32 v126, 16, v105
  v_and_b32 v127, 0xffff0000, v105
  v_rcp_f32 v124, v124
  v_rcp_f32 v125, v125
  v_rcp_f32 v126, v126
  v_rcp_f32 v127, v127
  v_mul_f32 v120, v120, v124
  v_mul_f32 v121, v121, v125
  v_mul_f32 v122, v122, v126
  v_mul_f32 v123, v123, v127
  v_cvt_pk_bf16_f32 v128, v120, v121
  v_cvt_pk_bf16_f32 v129, v122, v123
  ds_read_b64 v[88:89], v1 offset:10240
  ds_read_b64 v[90:91], v1 offset:10752
  ds_read_b64 v[92:93], v1 offset:2048
  ds_read_b64 v[94:95], v1 offset:2560
  ds_read_b64 v[96:97], v1 offset:19456
  ds_read_b64 v[98:99], v1 offset:19968
  s_waitcnt lgkmcnt(5)
  v_mfma_f32_16x16x16_bf16 v[120:123], v[88:89], v[72:73], 0
  s_waitcnt lgkmcnt(4)
  v_mfma_f32_16x16x16_bf16 v[124:127], v[90:91], v[72:73], 0
  s_waitcnt lgkmcnt(3)
  v_mfma_f32_16x16x16_bf16 v[120:123], v[92:93], v[74:75], v[120:123]
  s_waitcnt lgkmcnt(2)
  v_mfma_f32_16x16x16_bf16 v[124:127], v[94:95], v[74:75], v[124:127]
  s_waitcnt lgkmcnt(1)
  v_mfma_f32_16x16x16_bf16 v[120:123], v[96:97], v[76:77], v[120:123]
  s_waitcnt lgkmcnt(0)
  v_mfma_f32_16x16x16_bf16 v[124:127], v[98:99], v[76:77], v[124:127]
  s_nop 3
  v_cvt_pk_bf16_f32 v104, v120, v121
  v_cvt_pk_bf16_f32 v105, v122, v123
  v_lshlrev_b32 v120, 16, v104
  v_and_b32 v121, 0xffff0000, v104
  v_lshlrev_b32 v122, 16, v105
  v_and_b32 v123, 0xffff0000, v105
  v_cvt_pk_bf16_f32 v104, v124, v125
  v_cvt_pk_bf16_f32 v105, v126, v127
  v_lshlrev_b32 v124, 16, v104
  v_and_b32 v125, 0xffff0000, v104
  v_lshlrev_b32 v126, 16, v105
  v_and_b32 v127, 0xffff0000, v105
  v_add_f32 v124, 0x358637bd, v124
  v_add_f32 v125, 0x358637bd, v125
  v_add_f32 v126, 0x358637bd, v126
  v_add_f32 v127, 0x358637bd, v127
  v_cvt_pk_bf16_f32 v104, v124, v125
  v_cvt_pk_bf16_f32 v105, v126, v127
  v_lshlrev_b32 v124, 16, v104
  v_and_b32 v125, 0xffff0000, v104
  v_lshlrev_b32 v126, 16, v105
  v_and_b32 v127, 0xffff0000, v105
  v_rcp_f32 v124, v124
  v_rcp_f32 v125, v125
  v_rcp_f32 v126, v126
  v_rcp_f32 v127, v127
  v_mul_f32 v120, v120, v124
  v_mul_f32 v121, v121, v125
  v_mul_f32 v122, v122, v126
  v_mul_f32 v123, v123, v127
  v_cvt_pk_bf16_f32 v130, v120, v121
  v_cvt_pk_bf16_f32 v131, v122, v123
  ds_write_b128 v3, v[128:131] offset:57344
  ds_read_b64 v[88:89], v1 offset:11264
  ds_read_b64 v[90:91], v1 offset:11776
  ds_read_b64 v[92:93], v1 offset:3072
  ds_read_b64 v[94:95], v1 offset:3584
  ds_read_b64 v[96:97], v1 offset:20480
  ds_read_b64 v[98:99], v1 offset:20992
  s_waitcnt lgkmcnt(5)
  v_mfma_f32_16x16x16_bf16 v[120:123], v[88:89], v[74:75], 0
  s_waitcnt lgkmcnt(4)
  v_mfma_f32_16x16x16_bf16 v[124:127], v[90:91], v[74:75], 0
  s_waitcnt lgkmcnt(3)
  v_mfma_f32_16x16x16_bf16 v[120:123], v[92:93], v[76:77], v[120:123]
  s_waitcnt lgkmcnt(2)
  v_mfma_f32_16x16x16_bf16 v[124:127], v[94:95], v[76:77], v[124:127]
  s_waitcnt lgkmcnt(1)
  v_mfma_f32_16x16x16_bf16 v[120:123], v[96:97], v[78:79], v[120:123]
  s_waitcnt lgkmcnt(0)
  v_mfma_f32_16x16x16_bf16 v[124:127], v[98:99], v[78:79], v[124:127]
  s_nop 3
  v_cvt_pk_bf16_f32 v104, v120, v121
  v_cvt_pk_bf16_f32 v105, v122, v123
  v_lshlrev_b32 v120, 16, v104
  v_and_b32 v121, 0xffff0000, v104
  v_lshlrev_b32 v122, 16, v105
  v_and_b32 v123, 0xffff0000, v105
  v_cvt_pk_bf16_f32 v104, v124, v125
  v_cvt_pk_bf16_f32 v105, v126, v127
  v_lshlrev_b32 v124, 16, v104
  v_and_b32 v125, 0xffff0000, v104
  v_lshlrev_b32 v126, 16, v105
  v_and_b32 v127, 0xffff0000, v105
  v_add_f32 v124, 0x358637bd, v124
  v_add_f32 v125, 0x358637bd, v125
  v_add_f32 v126, 0x358637bd, v126
  v_add_f32 v127, 0x358637bd, v127
  v_cvt_pk_bf16_f32 v104, v124, v125
  v_cvt_pk_bf16_f32 v105, v126, v127
  v_lshlrev_b32 v124, 16, v104
  v_and_b32 v125, 0xffff0000, v104
  v_lshlrev_b32 v126, 16, v105
  v_and_b32 v127, 0xffff0000, v105
  v_rcp_f32 v124, v124
  v_rcp_f32 v125, v125
  v_rcp_f32 v126, v126
  v_rcp_f32 v127, v127
  v_mul_f32 v120, v120, v124
  v_mul_f32 v121, v121, v125
  v_mul_f32 v122, v122, v126
  v_mul_f32 v123, v123, v127
  v_cvt_pk_bf16_f32 v128, v120, v121
  v_cvt_pk_bf16_f32 v129, v122, v123
  ds_read_b64 v[88:89], v1 offset:12288
  ds_read_b64 v[90:91], v1 offset:12800
  ds_read_b64 v[92:93], v1 offset:4096
  ds_read_b64 v[94:95], v1 offset:4608
  ds_read_b64 v[96:97], v1 offset:21504
  ds_read_b64 v[98:99], v1 offset:22016
  s_waitcnt lgkmcnt(5)
  v_mfma_f32_16x16x16_bf16 v[120:123], v[88:89], v[76:77], 0
  s_waitcnt lgkmcnt(4)
  v_mfma_f32_16x16x16_bf16 v[124:127], v[90:91], v[76:77], 0
  s_waitcnt lgkmcnt(3)
  v_mfma_f32_16x16x16_bf16 v[120:123], v[92:93], v[78:79], v[120:123]
  s_waitcnt lgkmcnt(2)
  v_mfma_f32_16x16x16_bf16 v[124:127], v[94:95], v[78:79], v[124:127]
  s_waitcnt lgkmcnt(1)
  v_mfma_f32_16x16x16_bf16 v[120:123], v[96:97], v[80:81], v[120:123]
  s_waitcnt lgkmcnt(0)
  v_mfma_f32_16x16x16_bf16 v[124:127], v[98:99], v[80:81], v[124:127]
  s_nop 3
  v_cvt_pk_bf16_f32 v104, v120, v121
  v_cvt_pk_bf16_f32 v105, v122, v123
  v_lshlrev_b32 v120, 16, v104
  v_and_b32 v121, 0xffff0000, v104
  v_lshlrev_b32 v122, 16, v105
  v_and_b32 v123, 0xffff0000, v105
  v_cvt_pk_bf16_f32 v104, v124, v125
  v_cvt_pk_bf16_f32 v105, v126, v127
  v_lshlrev_b32 v124, 16, v104
  v_and_b32 v125, 0xffff0000, v104
  v_lshlrev_b32 v126, 16, v105
  v_and_b32 v127, 0xffff0000, v105
  v_add_f32 v124, 0x358637bd, v124
  v_add_f32 v125, 0x358637bd, v125
  v_add_f32 v126, 0x358637bd, v126
  v_add_f32 v127, 0x358637bd, v127
  v_cvt_pk_bf16_f32 v104, v124, v125
  v_cvt_pk_bf16_f32 v105, v126, v127
  v_lshlrev_b32 v124, 16, v104
  v_and_b32 v125, 0xffff0000, v104
  v_lshlrev_b32 v126, 16, v105
  v_and_b32 v127, 0xffff0000, v105
  v_rcp_f32 v124, v124
  v_rcp_f32 v125, v125
  v_rcp_f32 v126, v126
  v_rcp_f32 v127, v127
  v_mul_f32 v120, v120, v124
  v_mul_f32 v121, v121, v125
  v_mul_f32 v122, v122, v126
  v_mul_f32 v123, v123, v127
  v_cvt_pk_bf16_f32 v130, v120, v121
  v_cvt_pk_bf16_f32 v131, v122, v123
  ds_write_b128 v3, v[128:131] offset:61440
  ds_read_b64 v[88:89], v1 offset:13312
  ds_read_b64 v[90:91], v1 offset:13824
  ds_read_b64 v[92:93], v1 offset:5120
  ds_read_b64 v[94:95], v1 offset:5632
  ds_read_b64 v[96:97], v1 offset:22528
  ds_read_b64 v[98:99], v1 offset:23040
  s_waitcnt lgkmcnt(5)
  v_mfma_f32_16x16x16_bf16 v[120:123], v[88:89], v[78:79], 0
  s_waitcnt lgkmcnt(4)
  v_mfma_f32_16x16x16_bf16 v[124:127], v[90:91], v[78:79], 0
  s_waitcnt lgkmcnt(3)
  v_mfma_f32_16x16x16_bf16 v[120:123], v[92:93], v[80:81], v[120:123]
  s_waitcnt lgkmcnt(2)
  v_mfma_f32_16x16x16_bf16 v[124:127], v[94:95], v[80:81], v[124:127]
  s_waitcnt lgkmcnt(1)
  v_mfma_f32_16x16x16_bf16 v[120:123], v[96:97], v[82:83], v[120:123]
  s_waitcnt lgkmcnt(0)
  v_mfma_f32_16x16x16_bf16 v[124:127], v[98:99], v[82:83], v[124:127]
  s_nop 3
  v_cvt_pk_bf16_f32 v104, v120, v121
  v_cvt_pk_bf16_f32 v105, v122, v123
  v_lshlrev_b32 v120, 16, v104
  v_and_b32 v121, 0xffff0000, v104
  v_lshlrev_b32 v122, 16, v105
  v_and_b32 v123, 0xffff0000, v105
  v_cvt_pk_bf16_f32 v104, v124, v125
  v_cvt_pk_bf16_f32 v105, v126, v127
  v_lshlrev_b32 v124, 16, v104
  v_and_b32 v125, 0xffff0000, v104
  v_lshlrev_b32 v126, 16, v105
  v_and_b32 v127, 0xffff0000, v105
  v_add_f32 v124, 0x358637bd, v124
  v_add_f32 v125, 0x358637bd, v125
  v_add_f32 v126, 0x358637bd, v126
  v_add_f32 v127, 0x358637bd, v127
  v_cvt_pk_bf16_f32 v104, v124, v125
  v_cvt_pk_bf16_f32 v105, v126, v127
  v_lshlrev_b32 v124, 16, v104
  v_and_b32 v125, 0xffff0000, v104
  v_lshlrev_b32 v126, 16, v105
  v_and_b32 v127, 0xffff0000, v105
  v_rcp_f32 v124, v124
  v_rcp_f32 v125, v125
  v_rcp_f32 v126, v126
  v_rcp_f32 v127, v127
  v_mul_f32 v120, v120, v124
  v_mul_f32 v121, v121, v125
  v_mul_f32 v122, v122, v126
  v_mul_f32 v123, v123, v127
  v_cvt_pk_bf16_f32 v128, v120, v121
  v_cvt_pk_bf16_f32 v129, v122, v123
  ds_read_b64 v[88:89], v1 offset:14336
  ds_read_b64 v[90:91], v1 offset:14848
  ds_read_b64 v[92:93], v1 offset:6144
  ds_read_b64 v[94:95], v1 offset:6656
  ds_read_b64 v[96:97], v1 offset:23552
  ds_read_b64 v[98:99], v1 offset:24064
  s_waitcnt lgkmcnt(5)
  v_mfma_f32_16x16x16_bf16 v[120:123], v[88:89], v[80:81], 0
  s_waitcnt lgkmcnt(4)
  v_mfma_f32_16x16x16_bf16 v[124:127], v[90:91], v[80:81], 0
  s_waitcnt lgkmcnt(3)
  v_mfma_f32_16x16x16_bf16 v[120:123], v[92:93], v[82:83], v[120:123]
  s_waitcnt lgkmcnt(2)
  v_mfma_f32_16x16x16_bf16 v[124:127], v[94:95], v[82:83], v[124:127]
  s_waitcnt lgkmcnt(1)
  v_mfma_f32_16x16x16_bf16 v[120:123], v[96:97], v[84:85], v[120:123]
  s_waitcnt lgkmcnt(0)
  v_mfma_f32_16x16x16_bf16 v[124:127], v[98:99], v[84:85], v[124:127]
  s_nop 3
  v_cvt_pk_bf16_f32 v104, v120, v121
  v_cvt_pk_bf16_f32 v105, v122, v123
  v_lshlrev_b32 v120, 16, v104
  v_and_b32 v121, 0xffff0000, v104
  v_lshlrev_b32 v122, 16, v105
  v_and_b32 v123, 0xffff0000, v105
  v_cvt_pk_bf16_f32 v104, v124, v125
  v_cvt_pk_bf16_f32 v105, v126, v127
  v_lshlrev_b32 v124, 16, v104
  v_and_b32 v125, 0xffff0000, v104
  v_lshlrev_b32 v126, 16, v105
  v_and_b32 v127, 0xffff0000, v105
  v_add_f32 v124, 0x358637bd, v124
  v_add_f32 v125, 0x358637bd, v125
  v_add_f32 v126, 0x358637bd, v126
  v_add_f32 v127, 0x358637bd, v127
  v_cvt_pk_bf16_f32 v104, v124, v125
  v_cvt_pk_bf16_f32 v105, v126, v127
  v_lshlrev_b32 v124, 16, v104
  v_and_b32 v125, 0xffff0000, v104
  v_lshlrev_b32 v126, 16, v105
  v_and_b32 v127, 0xffff0000, v105
  v_rcp_f32 v124, v124
  v_rcp_f32 v125, v125
  v_rcp_f32 v126, v126
  v_rcp_f32 v127, v127
  v_mul_f32 v120, v120, v124
  v_mul_f32 v121, v121, v125
  v_mul_f32 v122, v122, v126
  v_mul_f32 v123, v123, v127
  v_cvt_pk_bf16_f32 v130, v120, v121
  v_cvt_pk_bf16_f32 v131, v122, v123
  v_add_u32 v4, 65536, v3
  ds_write_b128 v4, v[128:131]
  ds_read_b64 v[88:89], v1 offset:15360
  ds_read_b64 v[90:91], v1 offset:15872
  ds_read_b64 v[92:93], v1 offset:7168
  ds_read_b64 v[94:95], v1 offset:7680
  ds_read_b64 v[96:97], v1 offset:24576
  ds_read_b64 v[98:99], v1 offset:25088
  s_waitcnt lgkmcnt(5)
  v_mfma_f32_16x16x16_bf16 v[120:123], v[88:89], v[82:83], 0
  s_waitcnt lgkmcnt(4)
  v_mfma_f32_16x16x16_bf16 v[124:127], v[90:91], v[82:83], 0
  s_waitcnt lgkmcnt(3)
  v_mfma_f32_16x16x16_bf16 v[120:123], v[92:93], v[84:85], v[120:123]
  s_waitcnt lgkmcnt(2)
  v_mfma_f32_16x16x16_bf16 v[124:127], v[94:95], v[84:85], v[124:127]
  s_waitcnt lgkmcnt(1)
  v_mfma_f32_16x16x16_bf16 v[120:123], v[96:97], v[86:87], v[120:123]
  s_waitcnt lgkmcnt(0)
  v_mfma_f32_16x16x16_bf16 v[124:127], v[98:99], v[86:87], v[124:127]
  s_nop 3
  v_cvt_pk_bf16_f32 v104, v120, v121
  v_cvt_pk_bf16_f32 v105, v122, v123
  v_lshlrev_b32 v120, 16, v104
  v_and_b32 v121, 0xffff0000, v104
  v_lshlrev_b32 v122, 16, v105
  v_and_b32 v123, 0xffff0000, v105
  v_cvt_pk_bf16_f32 v104, v124, v125
  v_cvt_pk_bf16_f32 v105, v126, v127
  v_lshlrev_b32 v124, 16, v104
  v_and_b32 v125, 0xffff0000, v104
  v_lshlrev_b32 v126, 16, v105
  v_and_b32 v127, 0xffff0000, v105
  v_add_f32 v124, 0x358637bd, v124
  v_add_f32 v125, 0x358637bd, v125
  v_add_f32 v126, 0x358637bd, v126
  v_add_f32 v127, 0x358637bd, v127
  v_cvt_pk_bf16_f32 v104, v124, v125
  v_cvt_pk_bf16_f32 v105, v126, v127
  v_lshlrev_b32 v124, 16, v104
  v_and_b32 v125, 0xffff0000, v104
  v_lshlrev_b32 v126, 16, v105
  v_and_b32 v127, 0xffff0000, v105
  v_rcp_f32 v124, v124
  v_rcp_f32 v125, v125
  v_rcp_f32 v126, v126
  v_rcp_f32 v127, v127
  v_mul_f32 v120, v120, v124
  v_mul_f32 v121, v121, v125
  v_mul_f32 v122, v122, v126
  v_mul_f32 v123, v123, v127
  v_cvt_pk_bf16_f32 v128, v120, v121
  v_cvt_pk_bf16_f32 v129, v122, v123
  ds_read_b64 v[88:89], v1 offset:16384
  ds_read_b64 v[90:91], v1 offset:16896
  ds_read_b64 v[92:93], v1 offset:8192
  ds_read_b64 v[94:95], v1 offset:8704
  s_waitcnt lgkmcnt(3)
  v_mfma_f32_16x16x16_bf16 v[120:123], v[88:89], v[84:85], 0
  s_waitcnt lgkmcnt(2)
  v_mfma_f32_16x16x16_bf16 v[124:127], v[90:91], v[84:85], 0
  s_waitcnt lgkmcnt(1)
  v_mfma_f32_16x16x16_bf16 v[120:123], v[92:93], v[86:87], v[120:123]
  s_waitcnt lgkmcnt(0)
  v_mfma_f32_16x16x16_bf16 v[124:127], v[94:95], v[86:87], v[124:127]
  s_nop 3
  v_cvt_pk_bf16_f32 v104, v120, v121
  v_cvt_pk_bf16_f32 v105, v122, v123
  v_lshlrev_b32 v120, 16, v104
  v_and_b32 v121, 0xffff0000, v104
  v_lshlrev_b32 v122, 16, v105
  v_and_b32 v123, 0xffff0000, v105
  v_cvt_pk_bf16_f32 v104, v124, v125
  v_cvt_pk_bf16_f32 v105, v126, v127
  v_lshlrev_b32 v124, 16, v104
  v_and_b32 v125, 0xffff0000, v104
  v_lshlrev_b32 v126, 16, v105
  v_and_b32 v127, 0xffff0000, v105
  v_add_f32 v124, 0x358637bd, v124
  v_add_f32 v125, 0x358637bd, v125
  v_add_f32 v126, 0x358637bd, v126
  v_add_f32 v127, 0x358637bd, v127
  v_cvt_pk_bf16_f32 v104, v124, v125
  v_cvt_pk_bf16_f32 v105, v126, v127
  v_lshlrev_b32 v124, 16, v104
  v_and_b32 v125, 0xffff0000, v104
  v_lshlrev_b32 v126, 16, v105
  v_and_b32 v127, 0xffff0000, v105
  v_rcp_f32 v124, v124
  v_rcp_f32 v125, v125
  v_rcp_f32 v126, v126
  v_rcp_f32 v127, v127
  v_mul_f32 v120, v120, v124
  v_mul_f32 v121, v121, v125
  v_mul_f32 v122, v122, v126
  v_mul_f32 v123, v123, v127
  v_cvt_pk_bf16_f32 v130, v120, v121
  v_cvt_pk_bf16_f32 v131, v122, v123
  v_add_u32 v4, 69632, v3
  ds_write_b128 v4, v[128:131]
  v_lshrrev_b32 v6, 4, v0
  v_bfe_u32 v7, v0, 2, 2
  v_and_b32 v8, 3, v0
  v_lshlrev_b32 v6, 2, v6
  v_add_u32 v6, v6, v7
  v_mul_u32_u24 v6, 1152, v6
  v_lshlrev_b32 v8, 3, v8
  v_add_u32 v6, v6, v8
  s_mul_i32 s32, s28, 288
  s_add_u32 s32, s32, 106496
  v_add_u32 v6, s32, v6
  v_add_u32 v7, 32768, v2
  v_and_b32 v8, 15, v0
  v_mul_u32_u24 v8, 2304, v8
  v_lshrrev_b32 v9, 4, v0
  v_lshlrev_b32 v9, 3, v9
  v_add_u32 v8, v8, v9
  s_mov_b32 s44, 0
  s_lshl_b32 s41, s28, 10
  v_mov_b64 v[16:17], 0
  v_mov_b64 v[18:19], 0
  v_mov_b64 v[20:21], 0
  v_mov_b64 v[22:23], 0
  v_mov_b64 v[24:25], 0
  v_mov_b64 v[26:27], 0
  v_mov_b64 v[28:29], 0
  v_mov_b64 v[30:31], 0
  v_mov_b64 v[32:33], 0
  v_mov_b64 v[34:35], 0
  v_mov_b64 v[36:37], 0
  v_mov_b64 v[38:39], 0
  v_mov_b64 v[40:41], 0
  v_mov_b64 v[42:43], 0
  v_mov_b64 v[44:45], 0
  v_mov_b64 v[46:47], 0
  v_mov_b64 v[48:49], 0
  v_mov_b64 v[50:51], 0
  v_mov_b64 v[52:53], 0
  v_mov_b64 v[54:55], 0
  v_mov_b64 v[56:57], 0
  v_mov_b64 v[58:59], 0
  v_mov_b64 v[60:61], 0
  v_mov_b64 v[62:63], 0
  v_mov_b64 v[64:65], 0
  v_mov_b64 v[66:67], 0
  v_mov_b64 v[68:69], 0
  v_mov_b64 v[70:71], 0
  v_mov_b64 v[72:73], 0
  v_mov_b64 v[74:75], 0
  v_mov_b64 v[76:77], 0
  v_mov_b64 v[78:79], 0
  v_mov_b64 v[80:81], 0
  v_mov_b64 v[82:83], 0
  v_mov_b64 v[84:85], 0
  v_mov_b64 v[86:87], 0
  v_mov_b64 v[88:89], 0
  v_mov_b64 v[90:91], 0
  v_mov_b64 v[92:93], 0
  v_mov_b64 v[94:95], 0
  v_mov_b64 v[96:97], 0
  v_mov_b64 v[98:99], 0
  v_mov_b64 v[100:101], 0
  v_mov_b64 v[102:103], 0
  v_mov_b64 v[104:105], 0
  v_mov_b64 v[106:107], 0
  v_mov_b64 v[108:109], 0
  v_mov_b64 v[110:111], 0
  v_mov_b64 v[112:113], 0
  v_mov_b64 v[114:115], 0
  v_mov_b64 v[116:117], 0
  v_mov_b64 v[118:119], 0
  v_mov_b64 v[120:121], 0
  v_mov_b64 v[122:123], 0
  v_mov_b64 v[124:125], 0
  v_mov_b64 v[126:127], 0
  v_mov_b64 v[128:129], 0
  v_mov_b64 v[130:131], 0
  v_mov_b64 v[132:133], 0
  v_mov_b64 v[134:135], 0
  v_mov_b64 v[136:137], 0
  v_mov_b64 v[138:139], 0
  v_mov_b64 v[140:141], 0
  v_mov_b64 v[142:143], 0
  v_mov_b64 v[144:145], 0
  v_mov_b64 v[146:147], 0
  v_mov_b64 v[148:149], 0
  v_mov_b64 v[150:151], 0
  v_mov_b64 v[152:153], 0
  v_mov_b64 v[154:155], 0
  v_mov_b64 v[156:157], 0
  v_mov_b64 v[158:159], 0
B2_KL:
  s_waitcnt lgkmcnt(0)
  s_barrier
  s_lshl_b32 s32, s28, 10
  s_add_u32 s32, s32, 106496
  s_mov_b32 s33, s41
  s_add_u32 m0, s32, 0
  s_nop 0
  buffer_load_dwordx4 v2, s[12:15], s33 offen lds
  s_add_u32 s33, s33, 4096
  s_add_u32 m0, s32, 4096
  s_nop 0
  buffer_load_dwordx4 v2, s[12:15], s33 offen lds
  s_add_u32 s33, s33, 4096
  s_add_u32 m0, s32, 8192
  s_nop 0
  buffer_load_dwordx4 v2, s[12:15], s33 offen lds
  s_add_u32 s33, s33, 4096
  s_add_u32 m0, s32, 12288
  s_nop 0
  buffer_load_dwordx4 v2, s[12:15], s33 offen lds
  s_add_u32 s33, s33, 4096
  s_add_u32 m0, s32, 16384
  s_nop 0
  buffer_load_dwordx4 v2, s[12:15], s33 offen lds
  s_add_u32 s33, s33, 4096
  s_add_u32 m0, s32, 20480
  s_nop 0
  buffer_load_dwordx4 v2, s[12:15], s33 offen lds
  s_add_u32 s33, s33, 4096
  s_add_u32 m0, s32, 24576
  s_nop 0
  buffer_load_dwordx4 v2, s[12:15], s33 offen lds
  s_add_u32 s33, s33, 4096
  s_add_u32 m0, s32, 28672
  s_nop 0
  buffer_load_dwordx4 v2, s[12:15], s33 offen lds
  s_add_u32 s33, s33, 4096
  s_add_u32 m0, s32, 32768
  s_nop 0
  buffer_load_dwordx4 v2, s[12:15], s33 offen lds
  s_add_u32 s41, s41, 36864
  s_waitcnt vmcnt(0)
  s_barrier
  ds_read_b128 v[160:163], v7 offset:0
  ds_read_b128 v[164:167], v7 offset:1024
  ds_read_b128 v[168:171], v7 offset:2048
  ds_read_b128 v[172:175], v7 offset:3072
  ds_read_b64_tr_b16 v[176:177], v6 offset:0
  ds_read_b64_tr_b16 v[178:179], v6 offset:18432
  ds_read_b64_tr_b16 v[180:181], v6 offset:32
  ds_read_b64_tr_b16 v[182:183], v6 offset:18464
  ds_read_b64_tr_b16 v[184:185], v6 offset:64
  ds_read_b64_tr_b16 v[186:187], v6 offset:18496
  s_waitcnt lgkmcnt(4)
  v_mfma_f32_16x16x32_bf16 v[16:19], v[176:179], v[160:163], v[16:19]
  v_mfma_f32_16x16x32_bf16 v[20:23], v[176:179], v[164:167], v[20:23]
  v_mfma_f32_16x16x32_bf16 v[24:27], v[176:179], v[168:171], v[24:27]
  v_mfma_f32_16x16x32_bf16 v[28:31], v[176:179], v[172:175], v[28:31]
  ds_read_b64_tr_b16 v[188:189], v6 offset:96
  ds_read_b64_tr_b16 v[190:191], v6 offset:18528
  s_waitcnt lgkmcnt(4)
  v_mfma_f32_16x16x32_bf16 v[32:35], v[180:183], v[160:163], v[32:35]
  v_mfma_f32_16x16x32_bf16 v[36:39], v[180:183], v[164:167], v[36:39]
  v_mfma_f32_16x16x32_bf16 v[40:43], v[180:183], v[168:171], v[40:43]
  v_mfma_f32_16x16x32_bf16 v[44:47], v[180:183], v[172:175], v[44:47]
  ds_read_b64_tr_b16 v[176:177], v6 offset:128
  ds_read_b64_tr_b16 v[178:179], v6 offset:18560
  s_waitcnt lgkmcnt(4)
  v_mfma_f32_16x16x32_bf16 v[48:51], v[184:187], v[160:163], v[48:51]
  v_mfma_f32_16x16x32_bf16 v[52:55], v[184:187], v[164:167], v[52:55]
  v_mfma_f32_16x16x32_bf16 v[56:59], v[184:187], v[168:171], v[56:59]
  v_mfma_f32_16x16x32_bf16 v[60:63], v[184:187], v[172:175], v[60:63]
  ds_read_b64_tr_b16 v[180:181], v6 offset:160
  ds_read_b64_tr_b16 v[182:183], v6 offset:18592
  s_waitcnt lgkmcnt(4)
  v_mfma_f32_16x16x32_bf16 v[64:67], v[188:191], v[160:163], v[64:67]
  v_mfma_f32_16x16x32_bf16 v[68:71], v[188:191], v[164:167], v[68:71]
  v_mfma_f32_16x16x32_bf16 v[72:75], v[188:191], v[168:171], v[72:75]
  v_mfma_f32_16x16x32_bf16 v[76:79], v[188:191], v[172:175], v[76:79]
  ds_read_b64_tr_b16 v[184:185], v6 offset:192
  ds_read_b64_tr_b16 v[186:187], v6 offset:18624
  s_waitcnt lgkmcnt(4)
  v_mfma_f32_16x16x32_bf16 v[80:83], v[176:179], v[160:163], v[80:83]
  v_mfma_f32_16x16x32_bf16 v[84:87], v[176:179], v[164:167], v[84:87]
  v_mfma_f32_16x16x32_bf16 v[88:91], v[176:179], v[168:171], v[88:91]
  v_mfma_f32_16x16x32_bf16 v[92:95], v[176:179], v[172:175], v[92:95]
  ds_read_b64_tr_b16 v[188:189], v6 offset:224
  ds_read_b64_tr_b16 v[190:191], v6 offset:18656
  s_waitcnt lgkmcnt(4)
  v_mfma_f32_16x16x32_bf16 v[96:99], v[180:183], v[160:163], v[96:99]
  v_mfma_f32_16x16x32_bf16 v[100:103], v[180:183], v[164:167], v[100:103]
  v_mfma_f32_16x16x32_bf16 v[104:107], v[180:183], v[168:171], v[104:107]
  v_mfma_f32_16x16x32_bf16 v[108:111], v[180:183], v[172:175], v[108:111]
  ds_read_b64_tr_b16 v[176:177], v6 offset:256
  ds_read_b64_tr_b16 v[178:179], v6 offset:18688
  s_waitcnt lgkmcnt(4)
  v_mfma_f32_16x16x32_bf16 v[112:115], v[184:187], v[160:163], v[112:115]
  v_mfma_f32_16x16x32_bf16 v[116:119], v[184:187], v[164:167], v[116:119]
  v_mfma_f32_16x16x32_bf16 v[120:123], v[184:187], v[168:171], v[120:123]
  v_mfma_f32_16x16x32_bf16 v[124:127], v[184:187], v[172:175], v[124:127]
  s_waitcnt lgkmcnt(2)
  v_mfma_f32_16x16x32_bf16 v[128:131], v[188:191], v[160:163], v[128:131]
  v_mfma_f32_16x16x32_bf16 v[132:135], v[188:191], v[164:167], v[132:135]
  v_mfma_f32_16x16x32_bf16 v[136:139], v[188:191], v[168:171], v[136:139]
  v_mfma_f32_16x16x32_bf16 v[140:143], v[188:191], v[172:175], v[140:143]
  s_waitcnt lgkmcnt(0)
  v_mfma_f32_16x16x32_bf16 v[144:147], v[176:179], v[160:163], v[144:147]
  v_mfma_f32_16x16x32_bf16 v[148:151], v[176:179], v[164:167], v[148:151]
  v_mfma_f32_16x16x32_bf16 v[152:155], v[176:179], v[168:171], v[152:155]
  v_mfma_f32_16x16x32_bf16 v[156:159], v[176:179], v[172:175], v[156:159]
  v_add_u32 v7, 4096, v7
  s_add_u32 s44, s44, 1
  s_cmp_lt_u32 s44, 18
  s_cbranch_scc1 B2_KL
  s_lshl_b32 s32, s94, 6
  s_mul_i32 s32, s32, 2304
  s_mul_i32 s33, s28, 288
  s_add_u32 s32, s32, s33
  s_add_u32 s32, s32, 1152
  v_cvt_pk_bf16_f32 v16, v16, v17
  v_cvt_pk_bf16_f32 v17, v18, v19
  buffer_store_dwordx2 v[16:17], v8, s[24:27], s32 offen offset:0
  v_cvt_pk_bf16_f32 v32, v32, v33
  v_cvt_pk_bf16_f32 v33, v34, v35
  buffer_store_dwordx2 v[32:33], v8, s[24:27], s32 offen offset:32
  v_cvt_pk_bf16_f32 v48, v48, v49
  v_cvt_pk_bf16_f32 v49, v50, v51
  buffer_store_dwordx2 v[48:49], v8, s[24:27], s32 offen offset:64
  v_cvt_pk_bf16_f32 v64, v64, v65
  v_cvt_pk_bf16_f32 v65, v66, v67
  buffer_store_dwordx2 v[64:65], v8, s[24:27], s32 offen offset:96
  v_cvt_pk_bf16_f32 v80, v80, v81
  v_cvt_pk_bf16_f32 v81, v82, v83
  buffer_store_dwordx2 v[80:81], v8, s[24:27], s32 offen offset:128
  v_cvt_pk_bf16_f32 v96, v96, v97
  v_cvt_pk_bf16_f32 v97, v98, v99
  buffer_store_dwordx2 v[96:97], v8, s[24:27], s32 offen offset:160
  v_cvt_pk_bf16_f32 v112, v112, v113
  v_cvt_pk_bf16_f32 v113, v114, v115
  buffer_store_dwordx2 v[112:113], v8, s[24:27], s32 offen offset:192
  v_cvt_pk_bf16_f32 v128, v128, v129
  v_cvt_pk_bf16_f32 v129, v130, v131
  buffer_store_dwordx2 v[128:129], v8, s[24:27], s32 offen offset:224
  v_cvt_pk_bf16_f32 v144, v144, v145
  v_cvt_pk_bf16_f32 v145, v146, v147
  buffer_store_dwordx2 v[144:145], v8, s[24:27], s32 offen offset:256
  s_add_u32 s32, s32, 36864
  v_cvt_pk_bf16_f32 v20, v20, v21
  v_cvt_pk_bf16_f32 v21, v22, v23
  buffer_store_dwordx2 v[20:21], v8, s[24:27], s32 offen offset:0
  v_cvt_pk_bf16_f32 v36, v36, v37
  v_cvt_pk_bf16_f32 v37, v38, v39
  buffer_store_dwordx2 v[36:37], v8, s[24:27], s32 offen offset:32
  v_cvt_pk_bf16_f32 v52, v52, v53
  v_cvt_pk_bf16_f32 v53, v54, v55
  buffer_store_dwordx2 v[52:53], v8, s[24:27], s32 offen offset:64
  v_cvt_pk_bf16_f32 v68, v68, v69
  v_cvt_pk_bf16_f32 v69, v70, v71
  buffer_store_dwordx2 v[68:69], v8, s[24:27], s32 offen offset:96
  v_cvt_pk_bf16_f32 v84, v84, v85
  v_cvt_pk_bf16_f32 v85, v86, v87
  buffer_store_dwordx2 v[84:85], v8, s[24:27], s32 offen offset:128
  v_cvt_pk_bf16_f32 v100, v100, v101
  v_cvt_pk_bf16_f32 v101, v102, v103
  buffer_store_dwordx2 v[100:101], v8, s[24:27], s32 offen offset:160
  v_cvt_pk_bf16_f32 v116, v116, v117
  v_cvt_pk_bf16_f32 v117, v118, v119
  buffer_store_dwordx2 v[116:117], v8, s[24:27], s32 offen offset:192
  v_cvt_pk_bf16_f32 v132, v132, v133
  v_cvt_pk_bf16_f32 v133, v134, v135
  buffer_store_dwordx2 v[132:133], v8, s[24:27], s32 offen offset:224
  v_cvt_pk_bf16_f32 v148, v148, v149
  v_cvt_pk_bf16_f32 v149, v150, v151
  buffer_store_dwordx2 v[148:149], v8, s[24:27], s32 offen offset:256
  s_add_u32 s32, s32, 36864
  v_cvt_pk_bf16_f32 v24, v24, v25
  v_cvt_pk_bf16_f32 v25, v26, v27
  buffer_store_dwordx2 v[24:25], v8, s[24:27], s32 offen offset:0
  v_cvt_pk_bf16_f32 v40, v40, v41
  v_cvt_pk_bf16_f32 v41, v42, v43
  buffer_store_dwordx2 v[40:41], v8, s[24:27], s32 offen offset:32
  v_cvt_pk_bf16_f32 v56, v56, v57
  v_cvt_pk_bf16_f32 v57, v58, v59
  buffer_store_dwordx2 v[56:57], v8, s[24:27], s32 offen offset:64
  v_cvt_pk_bf16_f32 v72, v72, v73
  v_cvt_pk_bf16_f32 v73, v74, v75
  buffer_store_dwordx2 v[72:73], v8, s[24:27], s32 offen offset:96
  v_cvt_pk_bf16_f32 v88, v88, v89
  v_cvt_pk_bf16_f32 v89, v90, v91
  buffer_store_dwordx2 v[88:89], v8, s[24:27], s32 offen offset:128
  v_cvt_pk_bf16_f32 v104, v104, v105
  v_cvt_pk_bf16_f32 v105, v106, v107
  buffer_store_dwordx2 v[104:105], v8, s[24:27], s32 offen offset:160
  v_cvt_pk_bf16_f32 v120, v120, v121
  v_cvt_pk_bf16_f32 v121, v122, v123
  buffer_store_dwordx2 v[120:121], v8, s[24:27], s32 offen offset:192
  v_cvt_pk_bf16_f32 v136, v136, v137
  v_cvt_pk_bf16_f32 v137, v138, v139
  buffer_store_dwordx2 v[136:137], v8, s[24:27], s32 offen offset:224
  v_cvt_pk_bf16_f32 v152, v152, v153
  v_cvt_pk_bf16_f32 v153, v154, v155
  buffer_store_dwordx2 v[152:153], v8, s[24:27], s32 offen offset:256
  s_add_u32 s32, s32, 36864
  v_cvt_pk_bf16_f32 v28, v28, v29
  v_cvt_pk_bf16_f32 v29, v30, v31
  buffer_store_dwordx2 v[28:29], v8, s[24:27], s32 offen offset:0
  v_cvt_pk_bf16_f32 v44, v44, v45
  v_cvt_pk_bf16_f32 v45, v46, v47
  buffer_store_dwordx2 v[44:45], v8, s[24:27], s32 offen offset:32
  v_cvt_pk_bf16_f32 v60, v60, v61
  v_cvt_pk_bf16_f32 v61, v62, v63
  buffer_store_dwordx2 v[60:61], v8, s[24:27], s32 offen offset:64
  v_cvt_pk_bf16_f32 v76, v76, v77
  v_cvt_pk_bf16_f32 v77, v78, v79
  buffer_store_dwordx2 v[76:77], v8, s[24:27], s32 offen offset:96
  v_cvt_pk_bf16_f32 v92, v92, v93
  v_cvt_pk_bf16_f32 v93, v94, v95
  buffer_store_dwordx2 v[92:93], v8, s[24:27], s32 offen offset:128
  v_cvt_pk_bf16_f32 v108, v108, v109
  v_cvt_pk_bf16_f32 v109, v110, v111
  buffer_store_dwordx2 v[108:109], v8, s[24:27], s32 offen offset:160
  v_cvt_pk_bf16_f32 v124, v124, v125
  v_cvt_pk_bf16_f32 v125, v126, v127
  buffer_store_dwordx2 v[124:125], v8, s[24:27], s32 offen offset:192
  v_cvt_pk_bf16_f32 v140, v140, v141
  v_cvt_pk_bf16_f32 v141, v142, v143
  buffer_store_dwordx2 v[140:141], v8, s[24:27], s32 offen offset:224
  v_cvt_pk_bf16_f32 v156, v156, v157
  v_cvt_pk_bf16_f32 v157, v158, v159
  buffer_store_dwordx2 v[156:157], v8, s[24:27], s32 offen offset:256
  s_add_u32 s99, s94, 96
  s_branch L_SPL
L_WA:
  s_sub_u32 s98, s98, s95
  s_sub_u32 s94, 32, s95
  s_mov_b32 s93, 5
  s_cmp_ge_u32 s96, 5
  s_cselect_b32 s93, 4, 5
  s_mov_b32 s33, s98
  s_load_dwordx2 s[8:9], s[70:71], 0
  s_load_dwordx2 s[12:13], s[70:71], 16
  s_load_dwordx2 s[16:17], s[70:71], 24
  s_load_dwordx2 s[20:21], s[70:71], 32
  s_load_dwordx2 s[24:25], s[70:71], 96
  s_load_dwordx2 s[28:29], s[70:71], 88
  s_waitcnt lgkmcnt(0)
  s_mov_b32 s10, 2359296
  s_mov_b32 s11, 0x00020000
  s_mov_b32 s14, 4718592
  s_mov_b32 s15, 0x00020000
  s_mov_b32 s18, 4718592
  s_mov_b32 s19, 0x00020000
  s_mov_b32 s22, 4718592
  s_mov_b32 s23, 0x00020000
  s_mov_b32 s26, 268435456
  s_mov_b32 s27, 0x00020000
  s_mov_b32 s30, 256
  s_mov_b32 s31, 0x00020000
  v_lshrrev_b32 v10, 6, v0
  s_nop 0
  v_readfirstlane_b32 s32, v10
  v_and_b32 v0, 63, v0
  v_lshlrev_b32 v8, 4, v0
  v_lshrrev_b32 v10, 3, v0
  v_and_b32 v11, 7, v0
  v_xor_b32 v11, v11, v10
  v_lshlrev_b32 v11, 4, v11
  v_mul_u32_u24 v10, 1152, v10
  v_add_u32 v1, v10, v11
  v_lshrrev_b32 v10, 4, v0
  v_bfe_u32 v11, v0, 1, 3
  v_xor_b32 v11, v11, v10
  v_lshlrev_b32 v12, 5, v11
  v_and_b32 v13, 1, v0
  v_lshlrev_b32 v13, 4, v13
  v_add_u32 v12, v12, v13
  v_lshlrev_b32 v10, 13, v10
  v_add_u32 v2, v10, v12
  v_xor_b32 v12, 128, v12
  v_add_u32 v3, v10, v12
  v_and_b32 v10, 15, v0
  v_lshrrev_b32 v11, 4, v0
  v_and_b32 v12, 7, v0
  v_xor_b32 v12, v12, v11
  v_lshlrev_b32 v12, 4, v12
  v_lshlrev_b32 v13, 7, v10
  v_add_u32 v4, v13, v12
  v_xor_b32 v5, 64, v4
  v_bfe_u32 v12, v0, 2, 2
  v_and_b32 v13, 3, v0
  v_lshlrev_b32 v14, 3, v11
  v_add_u32 v14, v14, v12
  v_lshlrev_b32 v14, 8, v14
  v_and_b32 v15, 1, v11
  v_lshlrev_b32 v15, 2, v15
  v_or_b32 v15, v15, v12
  s_lshl_b32 s37, s32, 1
  v_xor_b32 v15, s37, v15
  v_lshlrev_b32 v15, 5, v15
  v_lshlrev_b32 v13, 3, v13
  v_add3_u32 v6, v14, v15, v13
  v_xor_b32 v7, 32, v6
  s_mov_b32 s33, s98
L_UNITKV:
  s_mul_i32 s34, s33, 13108
  s_lshr_b32 s34, s34, 16
  s_lshr_b32 s92, s33, 2
  s_cmp_eq_u32 s93, 4
  s_cselect_b32 s34, s92, s34
  s_mul_i32 s92, s34, s93
  s_sub_u32 s92, s33, s92
  s_lshl_b32 s91, s92, 1
  s_add_u32 s91, s91, s34
  s_mul_i32 s90, s91, 7282
  s_lshr_b32 s90, s90, 16
  s_mul_i32 s90, s90, 9
  s_sub_u32 s48, s91, s90
  s_mul_i32 s92, s92, 7
  s_add_u32 s92, s92, s96
  s_sub_u32 s35, s92, 1
  s_lshl_b32 s45, s34, 7
  s_lshl_b32 s37, s32, 5
  s_add_u32 s45, s45, s37
  s_mul_i32 s45, s45, 1152
  s_lshl_b32 s46, s32, 17
  s_lshl_b32 s37, s35, 8
  s_add_u32 s46, s46, s37
  s_lshl_b32 s36, s48, 6
  s_mov_b32 s44, 0
  s_barrier
  s_lshl_b32 s37, s32, 12
  s_add_u32 s37, s37, s44
  s_lshl_b32 s38, s36, 1
  s_add_u32 s38, s38, s45
  s_add_u32 m0, s37, 0
  s_nop 0
  buffer_load_dwordx4 v1, s[8:11], s38 offen lds
  s_add_u32 s38, s38, 9216
  s_add_u32 m0, s37, 1024
  s_nop 0
  buffer_load_dwordx4 v1, s[8:11], s38 offen lds
  s_add_u32 s38, s38, 9216
  s_add_u32 m0, s37, 2048
  s_nop 0
  buffer_load_dwordx4 v1, s[8:11], s38 offen lds
  s_add_u32 s38, s38, 9216
  s_add_u32 m0, s37, 3072
  s_nop 0
  buffer_load_dwordx4 v1, s[8:11], s38 offen lds
  s_lshl_b32 s38, s36, 13
  s_add_u32 s38, s38, s46
  s_add_u32 m0, s37, 16384
  s_nop 0
  buffer_load_dwordx4 v2, s[16:19], s38 offen lds
  s_add_u32 m0, s37, 32768
  s_nop 0
  buffer_load_dwordx4 v2, s[20:23], s38 offen lds
  s_add_u32 s38, s38, 32768
  s_add_u32 m0, s37, 17408
  s_nop 0
  buffer_load_dwordx4 v2, s[16:19], s38 offen lds
  s_add_u32 m0, s37, 33792
  s_nop 0
  buffer_load_dwordx4 v2, s[20:23], s38 offen lds
  s_add_u32 s38, s38, 32768
  s_add_u32 m0, s37, 18432
  s_nop 0
  buffer_load_dwordx4 v3, s[16:19], s38 offen lds
  s_add_u32 m0, s37, 34816
  s_nop 0
  buffer_load_dwordx4 v3, s[20:23], s38 offen lds
  s_add_u32 s38, s38, 32768
  s_add_u32 m0, s37, 19456
  s_nop 0
  buffer_load_dwordx4 v3, s[16:19], s38 offen lds
  s_add_u32 m0, s37, 35840
  s_nop 0
  buffer_load_dwordx4 v3, s[20:23], s38 offen lds
  s_add_u32 s36, s36, 64
  s_cmp_ge_u32 s36, 576
  s_cselect_b32 s36, 0, s36
  s_mov_b32 s44, 65536
  s_waitcnt vmcnt(0)
  s_barrier
  s_lshl_b32 s37, s32, 12
  s_add_u32 s37, s37, s44
  s_lshl_b32 s38, s36, 1
  s_add_u32 s38, s38, s45
  s_add_u32 m0, s37, 0
  s_nop 0
  buffer_load_dwordx4 v1, s[8:11], s38 offen lds
  s_add_u32 s38, s38, 9216
  s_add_u32 m0, s37, 1024
  s_nop 0
  buffer_load_dwordx4 v1, s[8:11], s38 offen lds
  s_add_u32 s38, s38, 9216
  s_add_u32 m0, s37, 2048
  s_nop 0
  buffer_load_dwordx4 v1, s[8:11], s38 offen lds
  s_add_u32 s38, s38, 9216
  s_add_u32 m0, s37, 3072
  s_nop 0
  buffer_load_dwordx4 v1, s[8:11], s38 offen lds
  s_lshl_b32 s38, s36, 13
  s_add_u32 s38, s38, s46
  s_add_u32 m0, s37, 16384
  s_nop 0
  buffer_load_dwordx4 v2, s[16:19], s38 offen lds
  s_add_u32 m0, s37, 32768
  s_nop 0
  buffer_load_dwordx4 v2, s[20:23], s38 offen lds
  s_add_u32 s38, s38, 32768
  s_add_u32 m0, s37, 17408
  s_nop 0
  buffer_load_dwordx4 v2, s[16:19], s38 offen lds
  s_add_u32 m0, s37, 33792
  s_nop 0
  buffer_load_dwordx4 v2, s[20:23], s38 offen lds
  s_add_u32 s38, s38, 32768
  s_add_u32 m0, s37, 18432
  s_nop 0
  buffer_load_dwordx4 v3, s[16:19], s38 offen lds
  s_add_u32 m0, s37, 34816
  s_nop 0
  buffer_load_dwordx4 v3, s[20:23], s38 offen lds
  s_add_u32 s38, s38, 32768
  s_add_u32 m0, s37, 19456
  s_nop 0
  buffer_load_dwordx4 v3, s[16:19], s38 offen lds
  s_add_u32 m0, s37, 35840
  s_nop 0
  buffer_load_dwordx4 v3, s[20:23], s38 offen lds
  ds_read_b128 a[0:3], v4 offset:0
  ds_read_b64_tr_b16 a[32:33], v6 offset:16384
  ds_read_b64_tr_b16 a[34:35], v6 offset:17408
  ds_read_b64_tr_b16 a[36:37], v7 offset:16384
  ds_read_b64_tr_b16 a[38:39], v7 offset:17408
  ds_read_b128 a[4:7], v4 offset:2048
  ds_read_b64_tr_b16 a[40:41], v6 offset:32768
  ds_read_b64_tr_b16 a[42:43], v6 offset:33792
  ds_read_b64_tr_b16 a[44:45], v7 offset:32768
  ds_read_b64_tr_b16 a[46:47], v7 offset:33792
  ds_read_b128 a[8:11], v4 offset:4096
  ds_read_b128 a[12:15], v4 offset:6144
  ds_read_b128 a[16:19], v4 offset:8192
  ds_read_b128 a[20:23], v4 offset:10240
  ds_read_b128 a[24:27], v4 offset:12288
  ds_read_b128 a[28:31], v4 offset:14336
  s_waitcnt lgkmcnt(13)
  v_mfma_f32_16x16x32_bf16 v[64:67], a[32:35], a[0:3], 0
  s_waitcnt lgkmcnt(11)
  v_mfma_f32_16x16x32_bf16 v[68:71], a[36:39], a[0:3], 0
  ds_read_b128 a[64:67], v5 offset:0
  s_waitcnt lgkmcnt(9)
  v_mfma_f32_16x16x32_bf16 v[72:75], a[0:3], a[40:43], 0
  s_waitcnt lgkmcnt(7)
  v_mfma_f32_16x16x32_bf16 v[76:79], a[0:3], a[44:47], 0
  ds_read_b64_tr_b16 a[96:97], v6 offset:24576
  v_mfma_f32_16x16x32_bf16 v[80:83], a[32:35], a[4:7], 0
  v_mfma_f32_16x16x32_bf16 v[84:87], a[36:39], a[4:7], 0
  ds_read_b64_tr_b16 a[98:99], v6 offset:25600
  v_mfma_f32_16x16x32_bf16 v[88:91], a[4:7], a[40:43], 0
  v_mfma_f32_16x16x32_bf16 v[92:95], a[4:7], a[44:47], 0
  ds_read_b64_tr_b16 a[100:101], v7 offset:24576
  s_waitcnt lgkmcnt(9)
  v_mfma_f32_16x16x32_bf16 v[96:99], a[32:35], a[8:11], 0
  v_mfma_f32_16x16x32_bf16 v[100:103], a[36:39], a[8:11], 0
  ds_read_b64_tr_b16 a[102:103], v7 offset:25600
  v_mfma_f32_16x16x32_bf16 v[104:107], a[8:11], a[40:43], 0
  v_mfma_f32_16x16x32_bf16 v[108:111], a[8:11], a[44:47], 0
  ds_read_b128 a[68:71], v5 offset:2048
  s_waitcnt lgkmcnt(10)
  v_mfma_f32_16x16x32_bf16 v[112:115], a[32:35], a[12:15], 0
  v_mfma_f32_16x16x32_bf16 v[116:119], a[36:39], a[12:15], 0
  ds_read_b64_tr_b16 a[104:105], v6 offset:40960
  v_mfma_f32_16x16x32_bf16 v[120:123], a[12:15], a[40:43], 0
  v_mfma_f32_16x16x32_bf16 v[124:127], a[12:15], a[44:47], 0
  ds_read_b64_tr_b16 a[106:107], v6 offset:41984
  s_waitcnt lgkmcnt(11)
  v_mfma_f32_16x16x32_bf16 v[128:131], a[32:35], a[16:19], 0
  v_mfma_f32_16x16x32_bf16 v[132:135], a[36:39], a[16:19], 0
  ds_read_b64_tr_b16 a[108:109], v7 offset:40960
  v_mfma_f32_16x16x32_bf16 v[136:139], a[16:19], a[40:43], 0
  v_mfma_f32_16x16x32_bf16 v[140:143], a[16:19], a[44:47], 0
  ds_read_b64_tr_b16 a[110:111], v7 offset:41984
  s_waitcnt lgkmcnt(12)
  v_mfma_f32_16x16x32_bf16 v[144:147], a[32:35], a[20:23], 0
  v_mfma_f32_16x16x32_bf16 v[148:151], a[36:39], a[20:23], 0
  ds_read_b128 a[72:75], v5 offset:4096
  v_mfma_f32_16x16x32_bf16 v[152:155], a[20:23], a[40:43], 0
  v_mfma_f32_16x16x32_bf16 v[156:159], a[20:23], a[44:47], 0
  ds_read_b128 a[76:79], v5 offset:6144
  s_waitcnt lgkmcnt(13)
  v_mfma_f32_16x16x32_bf16 v[160:163], a[32:35], a[24:27], 0
  v_mfma_f32_16x16x32_bf16 v[164:167], a[36:39], a[24:27], 0
  ds_read_b128 a[80:83], v5 offset:8192
  v_mfma_f32_16x16x32_bf16 v[168:171], a[24:27], a[40:43], 0
  v_mfma_f32_16x16x32_bf16 v[172:175], a[24:27], a[44:47], 0
  ds_read_b128 a[84:87], v5 offset:10240
  s_waitcnt lgkmcnt(14)
  v_mfma_f32_16x16x32_bf16 v[176:179], a[32:35], a[28:31], 0
  v_mfma_f32_16x16x32_bf16 v[180:183], a[36:39], a[28:31], 0
  ds_read_b128 a[88:91], v5 offset:12288
  v_mfma_f32_16x16x32_bf16 v[184:187], a[28:31], a[40:43], 0
  v_mfma_f32_16x16x32_bf16 v[188:191], a[28:31], a[44:47], 0
  ds_read_b128 a[92:95], v5 offset:14336
  s_waitcnt lgkmcnt(13)
  v_mfma_f32_16x16x32_bf16 v[64:67], a[96:99], a[64:67], v[64:67]
  s_waitcnt lgkmcnt(11)
  v_mfma_f32_16x16x32_bf16 v[68:71], a[100:103], a[64:67], v[68:71]
  s_waitcnt lgkmcnt(8)
  v_mfma_f32_16x16x32_bf16 v[72:75], a[64:67], a[104:107], v[72:75]
  s_waitcnt lgkmcnt(6)
  v_mfma_f32_16x16x32_bf16 v[76:79], a[64:67], a[108:111], v[76:79]
  v_mfma_f32_16x16x32_bf16 v[80:83], a[96:99], a[68:71], v[80:83]
  v_mfma_f32_16x16x32_bf16 v[84:87], a[100:103], a[68:71], v[84:87]
  v_mfma_f32_16x16x32_bf16 v[88:91], a[68:71], a[104:107], v[88:91]
  v_mfma_f32_16x16x32_bf16 v[92:95], a[68:71], a[108:111], v[92:95]
  s_waitcnt lgkmcnt(5)
  v_mfma_f32_16x16x32_bf16 v[96:99], a[96:99], a[72:75], v[96:99]
  v_mfma_f32_16x16x32_bf16 v[100:103], a[100:103], a[72:75], v[100:103]
  v_mfma_f32_16x16x32_bf16 v[104:107], a[72:75], a[104:107], v[104:107]
  v_mfma_f32_16x16x32_bf16 v[108:111], a[72:75], a[108:111], v[108:111]
  s_waitcnt lgkmcnt(4)
  v_mfma_f32_16x16x32_bf16 v[112:115], a[96:99], a[76:79], v[112:115]
  v_mfma_f32_16x16x32_bf16 v[116:119], a[100:103], a[76:79], v[116:119]
  v_mfma_f32_16x16x32_bf16 v[120:123], a[76:79], a[104:107], v[120:123]
  v_mfma_f32_16x16x32_bf16 v[124:127], a[76:79], a[108:111], v[124:127]
  s_waitcnt lgkmcnt(3)
  v_mfma_f32_16x16x32_bf16 v[128:131], a[96:99], a[80:83], v[128:131]
  v_mfma_f32_16x16x32_bf16 v[132:135], a[100:103], a[80:83], v[132:135]
  v_mfma_f32_16x16x32_bf16 v[136:139], a[80:83], a[104:107], v[136:139]
  v_mfma_f32_16x16x32_bf16 v[140:143], a[80:83], a[108:111], v[140:143]
  s_waitcnt lgkmcnt(2)
  v_mfma_f32_16x16x32_bf16 v[144:147], a[96:99], a[84:87], v[144:147]
  v_mfma_f32_16x16x32_bf16 v[148:151], a[100:103], a[84:87], v[148:151]
  v_mfma_f32_16x16x32_bf16 v[152:155], a[84:87], a[104:107], v[152:155]
  v_mfma_f32_16x16x32_bf16 v[156:159], a[84:87], a[108:111], v[156:159]
  s_waitcnt lgkmcnt(1)
  v_mfma_f32_16x16x32_bf16 v[160:163], a[96:99], a[88:91], v[160:163]
  v_mfma_f32_16x16x32_bf16 v[164:167], a[100:103], a[88:91], v[164:167]
  v_mfma_f32_16x16x32_bf16 v[168:171], a[88:91], a[104:107], v[168:171]
  v_mfma_f32_16x16x32_bf16 v[172:175], a[88:91], a[108:111], v[172:175]
  s_waitcnt lgkmcnt(0)
  v_mfma_f32_16x16x32_bf16 v[176:179], a[96:99], a[92:95], v[176:179]
  v_mfma_f32_16x16x32_bf16 v[180:183], a[100:103], a[92:95], v[180:183]
  v_mfma_f32_16x16x32_bf16 v[184:187], a[92:95], a[104:107], v[184:187]
  v_mfma_f32_16x16x32_bf16 v[188:191], a[92:95], a[108:111], v[188:191]
  s_mov_b32 s47, 1
GAKV_KL:
  v_xor_b32 v4, 0x10000, v4
  v_xor_b32 v5, 0x10000, v5
  v_xor_b32 v6, 0x10000, v6
  v_xor_b32 v7, 0x10000, v7
  s_xor_b32 s44, s44, 65536
  s_add_u32 s36, s36, 64
  s_cmp_ge_u32 s36, 576
  s_cselect_b32 s36, 0, s36
  s_waitcnt vmcnt(0) lgkmcnt(0)
  s_barrier
  s_cmp_lt_u32 s47, 8
  s_cbranch_scc0 GAKV_NODMA
  s_lshl_b32 s37, s32, 12
  s_add_u32 s37, s37, s44
  s_lshl_b32 s38, s36, 1
  s_add_u32 s38, s38, s45
  s_add_u32 m0, s37, 0
  s_nop 0
  buffer_load_dwordx4 v1, s[8:11], s38 offen lds
  s_add_u32 s38, s38, 9216
  s_add_u32 m0, s37, 1024
  s_nop 0
  buffer_load_dwordx4 v1, s[8:11], s38 offen lds
  s_add_u32 s38, s38, 9216
  s_add_u32 m0, s37, 2048
  s_nop 0
  buffer_load_dwordx4 v1, s[8:11], s38 offen lds
  s_add_u32 s38, s38, 9216
  s_add_u32 m0, s37, 3072
  s_nop 0
  buffer_load_dwordx4 v1, s[8:11], s38 offen lds
  s_lshl_b32 s38, s36, 13
  s_add_u32 s38, s38, s46
  s_add_u32 m0, s37, 16384
  s_nop 0
  buffer_load_dwordx4 v2, s[16:19], s38 offen lds
  s_add_u32 m0, s37, 32768
  s_nop 0
  buffer_load_dwordx4 v2, s[20:23], s38 offen lds
  s_add_u32 s38, s38, 32768
  s_add_u32 m0, s37, 17408
  s_nop 0
  buffer_load_dwordx4 v2, s[16:19], s38 offen lds
  s_add_u32 m0, s37, 33792
  s_nop 0
  buffer_load_dwordx4 v2, s[20:23], s38 offen lds
  s_add_u32 s38, s38, 32768
  s_add_u32 m0, s37, 18432
  s_nop 0
  buffer_load_dwordx4 v3, s[16:19], s38 offen lds
  s_add_u32 m0, s37, 34816
  s_nop 0
  buffer_load_dwordx4 v3, s[20:23], s38 offen lds
  s_add_u32 s38, s38, 32768
  s_add_u32 m0, s37, 19456
  s_nop 0
  buffer_load_dwordx4 v3, s[16:19], s38 offen lds
  s_add_u32 m0, s37, 35840
  s_nop 0
  buffer_load_dwordx4 v3, s[20:23], s38 offen lds
GAKV_NODMA:
  ds_read_b128 a[0:3], v4 offset:0
  ds_read_b64_tr_b16 a[32:33], v6 offset:16384
  ds_read_b64_tr_b16 a[34:35], v6 offset:17408
  ds_read_b64_tr_b16 a[36:37], v7 offset:16384
  ds_read_b64_tr_b16 a[38:39], v7 offset:17408
  ds_read_b128 a[4:7], v4 offset:2048
  ds_read_b64_tr_b16 a[40:41], v6 offset:32768
  ds_read_b64_tr_b16 a[42:43], v6 offset:33792
  ds_read_b64_tr_b16 a[44:45], v7 offset:32768
  ds_read_b64_tr_b16 a[46:47], v7 offset:33792
  ds_read_b128 a[8:11], v4 offset:4096
  ds_read_b128 a[12:15], v4 offset:6144
  ds_read_b128 a[16:19], v4 offset:8192
  ds_read_b128 a[20:23], v4 offset:10240
  ds_read_b128 a[24:27], v4 offset:12288
  ds_read_b128 a[28:31], v4 offset:14336
  s_waitcnt lgkmcnt(13)
  v_mfma_f32_16x16x32_bf16 v[64:67], a[32:35], a[0:3], v[64:67]
  s_waitcnt lgkmcnt(11)
  v_mfma_f32_16x16x32_bf16 v[68:71], a[36:39], a[0:3], v[68:71]
  ds_read_b128 a[64:67], v5 offset:0
  s_waitcnt lgkmcnt(9)
  v_mfma_f32_16x16x32_bf16 v[72:75], a[0:3], a[40:43], v[72:75]
  s_waitcnt lgkmcnt(7)
  v_mfma_f32_16x16x32_bf16 v[76:79], a[0:3], a[44:47], v[76:79]
  ds_read_b64_tr_b16 a[96:97], v6 offset:24576
  v_mfma_f32_16x16x32_bf16 v[80:83], a[32:35], a[4:7], v[80:83]
  v_mfma_f32_16x16x32_bf16 v[84:87], a[36:39], a[4:7], v[84:87]
  ds_read_b64_tr_b16 a[98:99], v6 offset:25600
  v_mfma_f32_16x16x32_bf16 v[88:91], a[4:7], a[40:43], v[88:91]
  v_mfma_f32_16x16x32_bf16 v[92:95], a[4:7], a[44:47], v[92:95]
  ds_read_b64_tr_b16 a[100:101], v7 offset:24576
  s_waitcnt lgkmcnt(9)
  v_mfma_f32_16x16x32_bf16 v[96:99], a[32:35], a[8:11], v[96:99]
  v_mfma_f32_16x16x32_bf16 v[100:103], a[36:39], a[8:11], v[100:103]
  ds_read_b64_tr_b16 a[102:103], v7 offset:25600
  v_mfma_f32_16x16x32_bf16 v[104:107], a[8:11], a[40:43], v[104:107]
  v_mfma_f32_16x16x32_bf16 v[108:111], a[8:11], a[44:47], v[108:111]
  ds_read_b128 a[68:71], v5 offset:2048
  s_waitcnt lgkmcnt(10)
  v_mfma_f32_16x16x32_bf16 v[112:115], a[32:35], a[12:15], v[112:115]
  v_mfma_f32_16x16x32_bf16 v[116:119], a[36:39], a[12:15], v[116:119]
  ds_read_b64_tr_b16 a[104:105], v6 offset:40960
  v_mfma_f32_16x16x32_bf16 v[120:123], a[12:15], a[40:43], v[120:123]
  v_mfma_f32_16x16x32_bf16 v[124:127], a[12:15], a[44:47], v[124:127]
  ds_read_b64_tr_b16 a[106:107], v6 offset:41984
  s_waitcnt lgkmcnt(11)
  v_mfma_f32_16x16x32_bf16 v[128:131], a[32:35], a[16:19], v[128:131]
  v_mfma_f32_16x16x32_bf16 v[132:135], a[36:39], a[16:19], v[132:135]
  ds_read_b64_tr_b16 a[108:109], v7 offset:40960
  v_mfma_f32_16x16x32_bf16 v[136:139], a[16:19], a[40:43], v[136:139]
  v_mfma_f32_16x16x32_bf16 v[140:143], a[16:19], a[44:47], v[140:143]
  ds_read_b64_tr_b16 a[110:111], v7 offset:41984
  s_waitcnt lgkmcnt(12)
  v_mfma_f32_16x16x32_bf16 v[144:147], a[32:35], a[20:23], v[144:147]
  v_mfma_f32_16x16x32_bf16 v[148:151], a[36:39], a[20:23], v[148:151]
  ds_read_b128 a[72:75], v5 offset:4096
  v_mfma_f32_16x16x32_bf16 v[152:155], a[20:23], a[40:43], v[152:155]
  v_mfma_f32_16x16x32_bf16 v[156:159], a[20:23], a[44:47], v[156:159]
  ds_read_b128 a[76:79], v5 offset:6144
  s_waitcnt lgkmcnt(13)
  v_mfma_f32_16x16x32_bf16 v[160:163], a[32:35], a[24:27], v[160:163]
  v_mfma_f32_16x16x32_bf16 v[164:167], a[36:39], a[24:27], v[164:167]
  ds_read_b128 a[80:83], v5 offset:8192
  v_mfma_f32_16x16x32_bf16 v[168:171], a[24:27], a[40:43], v[168:171]
  v_mfma_f32_16x16x32_bf16 v[172:175], a[24:27], a[44:47], v[172:175]
  ds_read_b128 a[84:87], v5 offset:10240
  s_waitcnt lgkmcnt(14)
  v_mfma_f32_16x16x32_bf16 v[176:179], a[32:35], a[28:31], v[176:179]
  v_mfma_f32_16x16x32_bf16 v[180:183], a[36:39], a[28:31], v[180:183]
  ds_read_b128 a[88:91], v5 offset:12288
  v_mfma_f32_16x16x32_bf16 v[184:187], a[28:31], a[40:43], v[184:187]
  v_mfma_f32_16x16x32_bf16 v[188:191], a[28:31], a[44:47], v[188:191]
  ds_read_b128 a[92:95], v5 offset:14336
  s_waitcnt lgkmcnt(13)
  v_mfma_f32_16x16x32_bf16 v[64:67], a[96:99], a[64:67], v[64:67]
  s_waitcnt lgkmcnt(11)
  v_mfma_f32_16x16x32_bf16 v[68:71], a[100:103], a[64:67], v[68:71]
  s_waitcnt lgkmcnt(8)
  v_mfma_f32_16x16x32_bf16 v[72:75], a[64:67], a[104:107], v[72:75]
  s_waitcnt lgkmcnt(6)
  v_mfma_f32_16x16x32_bf16 v[76:79], a[64:67], a[108:111], v[76:79]
  v_mfma_f32_16x16x32_bf16 v[80:83], a[96:99], a[68:71], v[80:83]
  v_mfma_f32_16x16x32_bf16 v[84:87], a[100:103], a[68:71], v[84:87]
  v_mfma_f32_16x16x32_bf16 v[88:91], a[68:71], a[104:107], v[88:91]
  v_mfma_f32_16x16x32_bf16 v[92:95], a[68:71], a[108:111], v[92:95]
  s_waitcnt lgkmcnt(5)
  v_mfma_f32_16x16x32_bf16 v[96:99], a[96:99], a[72:75], v[96:99]
  v_mfma_f32_16x16x32_bf16 v[100:103], a[100:103], a[72:75], v[100:103]
  v_mfma_f32_16x16x32_bf16 v[104:107], a[72:75], a[104:107], v[104:107]
  v_mfma_f32_16x16x32_bf16 v[108:111], a[72:75], a[108:111], v[108:111]
  s_waitcnt lgkmcnt(4)
  v_mfma_f32_16x16x32_bf16 v[112:115], a[96:99], a[76:79], v[112:115]
  v_mfma_f32_16x16x32_bf16 v[116:119], a[100:103], a[76:79], v[116:119]
  v_mfma_f32_16x16x32_bf16 v[120:123], a[76:79], a[104:107], v[120:123]
  v_mfma_f32_16x16x32_bf16 v[124:127], a[76:79], a[108:111], v[124:127]
  s_waitcnt lgkmcnt(3)
  v_mfma_f32_16x16x32_bf16 v[128:131], a[96:99], a[80:83], v[128:131]
  v_mfma_f32_16x16x32_bf16 v[132:135], a[100:103], a[80:83], v[132:135]
  v_mfma_f32_16x16x32_bf16 v[136:139], a[80:83], a[104:107], v[136:139]
  v_mfma_f32_16x16x32_bf16 v[140:143], a[80:83], a[108:111], v[140:143]
  s_waitcnt lgkmcnt(2)
  v_mfma_f32_16x16x32_bf16 v[144:147], a[96:99], a[84:87], v[144:147]
  v_mfma_f32_16x16x32_bf16 v[148:151], a[100:103], a[84:87], v[148:151]
  v_mfma_f32_16x16x32_bf16 v[152:155], a[84:87], a[104:107], v[152:155]
  v_mfma_f32_16x16x32_bf16 v[156:159], a[84:87], a[108:111], v[156:159]
  s_waitcnt lgkmcnt(1)
  v_mfma_f32_16x16x32_bf16 v[160:163], a[96:99], a[88:91], v[160:163]
  v_mfma_f32_16x16x32_bf16 v[164:167], a[100:103], a[88:91], v[164:167]
  v_mfma_f32_16x16x32_bf16 v[168:171], a[88:91], a[104:107], v[168:171]
  v_mfma_f32_16x16x32_bf16 v[172:175], a[88:91], a[108:111], v[172:175]
  s_waitcnt lgkmcnt(0)
  v_mfma_f32_16x16x32_bf16 v[176:179], a[96:99], a[92:95], v[176:179]
  v_mfma_f32_16x16x32_bf16 v[180:183], a[100:103], a[92:95], v[180:183]
  v_mfma_f32_16x16x32_bf16 v[184:187], a[92:95], a[104:107], v[184:187]
  v_mfma_f32_16x16x32_bf16 v[188:191], a[92:95], a[108:111], v[188:191]
  s_add_u32 s47, s47, 1
  s_cmp_lt_u32 s47, 9
  s_cbranch_scc1 GAKV_KL
  s_lshl_b32 s37, s34, 7
  s_add_u32 s37, s37, s35
  s_lshl_b32 s37, s37, 2
  s_add_u32 s37, s37, s32
  s_lshl_b32 s37, s37, 11
  v_cvt_pk_bf16_f32 v12, v64, v65
  v_cvt_pk_bf16_f32 v13, v66, v67
  v_cvt_pk_bf16_f32 v14, v68, v69
  v_cvt_pk_bf16_f32 v15, v70, v71
  s_add_u32 s38, s37, 0
  buffer_store_dwordx4 v[12:15], v8, s[24:27], s38 offen offset:0 sc1
  v_cvt_pk_bf16_f32 v16, v80, v81
  v_cvt_pk_bf16_f32 v17, v82, v83
  v_cvt_pk_bf16_f32 v18, v84, v85
  v_cvt_pk_bf16_f32 v19, v86, v87
  s_add_u32 s38, s37, 0
  buffer_store_dwordx4 v[16:19], v8, s[24:27], s38 offen offset:1024 sc1
  v_cvt_pk_bf16_f32 v28, v72, v73
  v_cvt_pk_bf16_f32 v29, v74, v75
  v_cvt_pk_bf16_f32 v30, v88, v89
  v_cvt_pk_bf16_f32 v31, v90, v91
  s_add_u32 s38, s37, 16777216
  buffer_store_dwordx4 v[28:31], v8, s[24:27], s38 offen offset:0 sc1
  v_cvt_pk_bf16_f32 v32, v76, v77
  v_cvt_pk_bf16_f32 v33, v78, v79
  v_cvt_pk_bf16_f32 v34, v92, v93
  v_cvt_pk_bf16_f32 v35, v94, v95
  s_add_u32 s38, s37, 16777216
  buffer_store_dwordx4 v[32:35], v8, s[24:27], s38 offen offset:1024 sc1
  v_cvt_pk_bf16_f32 v20, v96, v97
  v_cvt_pk_bf16_f32 v21, v98, v99
  v_cvt_pk_bf16_f32 v22, v100, v101
  v_cvt_pk_bf16_f32 v23, v102, v103
  s_add_u32 s38, s37, 262144
  buffer_store_dwordx4 v[20:23], v8, s[24:27], s38 offen offset:0 sc1
  v_cvt_pk_bf16_f32 v24, v112, v113
  v_cvt_pk_bf16_f32 v25, v114, v115
  v_cvt_pk_bf16_f32 v26, v116, v117
  v_cvt_pk_bf16_f32 v27, v118, v119
  s_add_u32 s38, s37, 262144
  buffer_store_dwordx4 v[24:27], v8, s[24:27], s38 offen offset:1024 sc1
  v_cvt_pk_bf16_f32 v28, v104, v105
  v_cvt_pk_bf16_f32 v29, v106, v107
  v_cvt_pk_bf16_f32 v30, v120, v121
  v_cvt_pk_bf16_f32 v31, v122, v123
  s_add_u32 s38, s37, 17039360
  buffer_store_dwordx4 v[28:31], v8, s[24:27], s38 offen offset:0 sc1
  v_cvt_pk_bf16_f32 v32, v108, v109
  v_cvt_pk_bf16_f32 v33, v110, v111
  v_cvt_pk_bf16_f32 v34, v124, v125
  v_cvt_pk_bf16_f32 v35, v126, v127
  s_add_u32 s38, s37, 17039360
  buffer_store_dwordx4 v[32:35], v8, s[24:27], s38 offen offset:1024 sc1
  v_cvt_pk_bf16_f32 v12, v128, v129
  v_cvt_pk_bf16_f32 v13, v130, v131
  v_cvt_pk_bf16_f32 v14, v132, v133
  v_cvt_pk_bf16_f32 v15, v134, v135
  s_add_u32 s38, s37, 524288
  buffer_store_dwordx4 v[12:15], v8, s[24:27], s38 offen offset:0 sc1
  v_cvt_pk_bf16_f32 v16, v144, v145
  v_cvt_pk_bf16_f32 v17, v146, v147
  v_cvt_pk_bf16_f32 v18, v148, v149
  v_cvt_pk_bf16_f32 v19, v150, v151
  s_add_u32 s38, s37, 524288
  buffer_store_dwordx4 v[16:19], v8, s[24:27], s38 offen offset:1024 sc1
  v_cvt_pk_bf16_f32 v28, v136, v137
  v_cvt_pk_bf16_f32 v29, v138, v139
  v_cvt_pk_bf16_f32 v30, v152, v153
  v_cvt_pk_bf16_f32 v31, v154, v155
  s_add_u32 s38, s37, 17301504
  buffer_store_dwordx4 v[28:31], v8, s[24:27], s38 offen offset:0 sc1
  v_cvt_pk_bf16_f32 v32, v140, v141
  v_cvt_pk_bf16_f32 v33, v142, v143
  v_cvt_pk_bf16_f32 v34, v156, v157
  v_cvt_pk_bf16_f32 v35, v158, v159
  s_add_u32 s38, s37, 17301504
  buffer_store_dwordx4 v[32:35], v8, s[24:27], s38 offen offset:1024 sc1
  v_cvt_pk_bf16_f32 v20, v160, v161
  v_cvt_pk_bf16_f32 v21, v162, v163
  v_cvt_pk_bf16_f32 v22, v164, v165
  v_cvt_pk_bf16_f32 v23, v166, v167
  s_add_u32 s38, s37, 786432
  buffer_store_dwordx4 v[20:23], v8, s[24:27], s38 offen offset:0 sc1
  v_cvt_pk_bf16_f32 v24, v176, v177
  v_cvt_pk_bf16_f32 v25, v178, v179
  v_cvt_pk_bf16_f32 v26, v180, v181
  v_cvt_pk_bf16_f32 v27, v182, v183
  s_add_u32 s38, s37, 786432
  buffer_store_dwordx4 v[24:27], v8, s[24:27], s38 offen offset:1024 sc1
  v_cvt_pk_bf16_f32 v28, v168, v169
  v_cvt_pk_bf16_f32 v29, v170, v171
  v_cvt_pk_bf16_f32 v30, v184, v185
  v_cvt_pk_bf16_f32 v31, v186, v187
  s_add_u32 s38, s37, 17563648
  buffer_store_dwordx4 v[28:31], v8, s[24:27], s38 offen offset:0 sc1
  v_cvt_pk_bf16_f32 v32, v172, v173
  v_cvt_pk_bf16_f32 v33, v174, v175
  v_cvt_pk_bf16_f32 v34, v188, v189
  v_cvt_pk_bf16_f32 v35, v190, v191
  s_add_u32 s38, s37, 17563648
  buffer_store_dwordx4 v[32:35], v8, s[24:27], s38 offen offset:1024 sc1
  s_waitcnt vmcnt(0)
  s_barrier
  s_cmp_eq_u32 s32, 0
  s_cbranch_scc0 GAKV_SIG_31
  s_lshl_b32 s37, s34, 2
  s_add_u32 s37, s37, 0
  v_mov_b32 v12, s37
  v_mov_b32 v13, 1
  s_mov_b64 exec, 1
  buffer_atomic_add v13, v12, s[28:31], 0 offen sc1
  s_mov_b64 exec, -1
GAKV_SIG_31:
  s_add_u32 s33, s33, s94
  s_lshl_b32 s92, s93, 4
  s_cmp_lt_u32 s33, s92
  s_cbranch_scc1 L_UNITKV
  s_mov_b32 s33, s98
L_UNITQ:
  s_mul_i32 s34, s33, 13108
  s_lshr_b32 s34, s34, 16
  s_lshr_b32 s92, s33, 2
  s_cmp_eq_u32 s93, 4
  s_cselect_b32 s34, s92, s34
  s_mul_i32 s92, s34, s93
  s_sub_u32 s92, s33, s92
  s_lshl_b32 s91, s92, 1
  s_add_u32 s91, s91, s34
  s_mul_i32 s90, s91, 7282
  s_lshr_b32 s90, s90, 16
  s_mul_i32 s90, s90, 9
  s_sub_u32 s48, s91, s90
  s_mul_i32 s92, s92, 7
  s_add_u32 s92, s92, s96
  s_sub_u32 s35, s92, 1
  s_lshl_b32 s45, s34, 7
  s_lshl_b32 s37, s32, 5
  s_add_u32 s45, s45, s37
  s_mul_i32 s45, s45, 1152
  s_lshl_b32 s46, s32, 17
  s_lshl_b32 s37, s35, 8
  s_add_u32 s46, s46, s37
  s_lshl_b32 s36, s48, 6
  s_mov_b32 s44, 0
  s_barrier
  s_lshl_b32 s37, s32, 12
  s_add_u32 s37, s37, s44
  s_lshl_b32 s38, s36, 1
  s_add_u32 s38, s38, s45
  s_add_u32 m0, s37, 0
  s_nop 0
  buffer_load_dwordx4 v1, s[8:11], s38 offen lds
  s_add_u32 s38, s38, 9216
  s_add_u32 m0, s37, 1024
  s_nop 0
  buffer_load_dwordx4 v1, s[8:11], s38 offen lds
  s_add_u32 s38, s38, 9216
  s_add_u32 m0, s37, 2048
  s_nop 0
  buffer_load_dwordx4 v1, s[8:11], s38 offen lds
  s_add_u32 s38, s38, 9216
  s_add_u32 m0, s37, 3072
  s_nop 0
  buffer_load_dwordx4 v1, s[8:11], s38 offen lds
  s_lshl_b32 s38, s36, 13
  s_add_u32 s38, s38, s46
  s_add_u32 m0, s37, 16384
  s_nop 0
  buffer_load_dwordx4 v2, s[12:15], s38 offen lds
  s_add_u32 s38, s38, 32768
  s_add_u32 m0, s37, 17408
  s_nop 0
  buffer_load_dwordx4 v2, s[12:15], s38 offen lds
  s_add_u32 s38, s38, 32768
  s_add_u32 m0, s37, 18432
  s_nop 0
  buffer_load_dwordx4 v3, s[12:15], s38 offen lds
  s_add_u32 s38, s38, 32768
  s_add_u32 m0, s37, 19456
  s_nop 0
  buffer_load_dwordx4 v3, s[12:15], s38 offen lds
  s_add_u32 s36, s36, 64
  s_cmp_ge_u32 s36, 576
  s_cselect_b32 s36, 0, s36
  s_mov_b32 s44, 65536
  s_waitcnt vmcnt(0)
  s_barrier
  s_lshl_b32 s37, s32, 12
  s_add_u32 s37, s37, s44
  s_lshl_b32 s38, s36, 1
  s_add_u32 s38, s38, s45
  s_add_u32 m0, s37, 0
  s_nop 0
  buffer_load_dwordx4 v1, s[8:11], s38 offen lds
  s_add_u32 s38, s38, 9216
  s_add_u32 m0, s37, 1024
  s_nop 0
  buffer_load_dwordx4 v1, s[8:11], s38 offen lds
  s_add_u32 s38, s38, 9216
  s_add_u32 m0, s37, 2048
  s_nop 0
  buffer_load_dwordx4 v1, s[8:11], s38 offen lds
  s_add_u32 s38, s38, 9216
  s_add_u32 m0, s37, 3072
  s_nop 0
  buffer_load_dwordx4 v1, s[8:11], s38 offen lds
  s_lshl_b32 s38, s36, 13
  s_add_u32 s38, s38, s46
  s_add_u32 m0, s37, 16384
  s_nop 0
  buffer_load_dwordx4 v2, s[12:15], s38 offen lds
  s_add_u32 s38, s38, 32768
  s_add_u32 m0, s37, 17408
  s_nop 0
  buffer_load_dwordx4 v2, s[12:15], s38 offen lds
  s_add_u32 s38, s38, 32768
  s_add_u32 m0, s37, 18432
  s_nop 0
  buffer_load_dwordx4 v3, s[12:15], s38 offen lds
  s_add_u32 s38, s38, 32768
  s_add_u32 m0, s37, 19456
  s_nop 0
  buffer_load_dwordx4 v3, s[12:15], s38 offen lds
  ds_read_b128 a[0:3], v4 offset:0
  ds_read_b64_tr_b16 a[32:33], v6 offset:16384
  ds_read_b64_tr_b16 a[34:35], v6 offset:17408
  ds_read_b64_tr_b16 a[36:37], v7 offset:16384
  ds_read_b64_tr_b16 a[38:39], v7 offset:17408
  ds_read_b128 a[4:7], v4 offset:2048
  ds_read_b128 a[8:11], v4 offset:4096
  ds_read_b128 a[12:15], v4 offset:6144
  ds_read_b128 a[16:19], v4 offset:8192
  ds_read_b128 a[20:23], v4 offset:10240
  ds_read_b128 a[24:27], v4 offset:12288
  ds_read_b128 a[28:31], v4 offset:14336
  s_waitcnt lgkmcnt(9)
  v_mfma_f32_16x16x32_bf16 v[64:67], a[32:35], a[0:3], 0
  ds_read_b128 a[64:67], v5 offset:0
  s_waitcnt lgkmcnt(8)
  v_mfma_f32_16x16x32_bf16 v[68:71], a[36:39], a[0:3], 0
  ds_read_b64_tr_b16 a[96:97], v6 offset:24576
  s_waitcnt lgkmcnt(8)
  v_mfma_f32_16x16x32_bf16 v[72:75], a[32:35], a[4:7], 0
  ds_read_b64_tr_b16 a[98:99], v6 offset:25600
  v_mfma_f32_16x16x32_bf16 v[76:79], a[36:39], a[4:7], 0
  ds_read_b64_tr_b16 a[100:101], v7 offset:24576
  s_waitcnt lgkmcnt(9)
  v_mfma_f32_16x16x32_bf16 v[80:83], a[32:35], a[8:11], 0
  ds_read_b64_tr_b16 a[102:103], v7 offset:25600
  v_mfma_f32_16x16x32_bf16 v[84:87], a[36:39], a[8:11], 0
  ds_read_b128 a[68:71], v5 offset:2048
  s_waitcnt lgkmcnt(10)
  v_mfma_f32_16x16x32_bf16 v[88:91], a[32:35], a[12:15], 0
  ds_read_b128 a[72:75], v5 offset:4096
  v_mfma_f32_16x16x32_bf16 v[92:95], a[36:39], a[12:15], 0
  ds_read_b128 a[76:79], v5 offset:6144
  s_waitcnt lgkmcnt(11)
  v_mfma_f32_16x16x32_bf16 v[96:99], a[32:35], a[16:19], 0
  ds_read_b128 a[80:83], v5 offset:8192
  v_mfma_f32_16x16x32_bf16 v[100:103], a[36:39], a[16:19], 0
  ds_read_b128 a[84:87], v5 offset:10240
  s_waitcnt lgkmcnt(12)
  v_mfma_f32_16x16x32_bf16 v[104:107], a[32:35], a[20:23], 0
  ds_read_b128 a[88:91], v5 offset:12288
  v_mfma_f32_16x16x32_bf16 v[108:111], a[36:39], a[20:23], 0
  ds_read_b128 a[92:95], v5 offset:14336
  s_waitcnt lgkmcnt(13)
  v_mfma_f32_16x16x32_bf16 v[112:115], a[32:35], a[24:27], 0
  v_mfma_f32_16x16x32_bf16 v[116:119], a[36:39], a[24:27], 0
  s_waitcnt lgkmcnt(12)
  v_mfma_f32_16x16x32_bf16 v[120:123], a[32:35], a[28:31], 0
  v_mfma_f32_16x16x32_bf16 v[124:127], a[36:39], a[28:31], 0
  s_waitcnt lgkmcnt(9)
  v_mfma_f32_16x16x32_bf16 v[64:67], a[96:99], a[64:67], v[64:67]
  s_waitcnt lgkmcnt(7)
  v_mfma_f32_16x16x32_bf16 v[68:71], a[100:103], a[64:67], v[68:71]
  s_waitcnt lgkmcnt(6)
  v_mfma_f32_16x16x32_bf16 v[72:75], a[96:99], a[68:71], v[72:75]
  v_mfma_f32_16x16x32_bf16 v[76:79], a[100:103], a[68:71], v[76:79]
  s_waitcnt lgkmcnt(5)
  v_mfma_f32_16x16x32_bf16 v[80:83], a[96:99], a[72:75], v[80:83]
  v_mfma_f32_16x16x32_bf16 v[84:87], a[100:103], a[72:75], v[84:87]
  s_waitcnt lgkmcnt(4)
  v_mfma_f32_16x16x32_bf16 v[88:91], a[96:99], a[76:79], v[88:91]
  v_mfma_f32_16x16x32_bf16 v[92:95], a[100:103], a[76:79], v[92:95]
  s_waitcnt lgkmcnt(3)
  v_mfma_f32_16x16x32_bf16 v[96:99], a[96:99], a[80:83], v[96:99]
  v_mfma_f32_16x16x32_bf16 v[100:103], a[100:103], a[80:83], v[100:103]
  s_waitcnt lgkmcnt(2)
  v_mfma_f32_16x16x32_bf16 v[104:107], a[96:99], a[84:87], v[104:107]
  v_mfma_f32_16x16x32_bf16 v[108:111], a[100:103], a[84:87], v[108:111]
  s_waitcnt lgkmcnt(1)
  v_mfma_f32_16x16x32_bf16 v[112:115], a[96:99], a[88:91], v[112:115]
  v_mfma_f32_16x16x32_bf16 v[116:119], a[100:103], a[88:91], v[116:119]
  s_waitcnt lgkmcnt(0)
  v_mfma_f32_16x16x32_bf16 v[120:123], a[96:99], a[92:95], v[120:123]
  v_mfma_f32_16x16x32_bf16 v[124:127], a[100:103], a[92:95], v[124:127]
  s_mov_b32 s47, 1
GAQ_KL:
  v_xor_b32 v4, 0x10000, v4
  v_xor_b32 v5, 0x10000, v5
  v_xor_b32 v6, 0x10000, v6
  v_xor_b32 v7, 0x10000, v7
  s_xor_b32 s44, s44, 65536
  s_add_u32 s36, s36, 64
  s_cmp_ge_u32 s36, 576
  s_cselect_b32 s36, 0, s36
  s_waitcnt vmcnt(0) lgkmcnt(0)
  s_barrier
  s_cmp_lt_u32 s47, 8
  s_cbranch_scc0 GAQ_NODMA
  s_lshl_b32 s37, s32, 12
  s_add_u32 s37, s37, s44
  s_lshl_b32 s38, s36, 1
  s_add_u32 s38, s38, s45
  s_add_u32 m0, s37, 0
  s_nop 0
  buffer_load_dwordx4 v1, s[8:11], s38 offen lds
  s_add_u32 s38, s38, 9216
  s_add_u32 m0, s37, 1024
  s_nop 0
  buffer_load_dwordx4 v1, s[8:11], s38 offen lds
  s_add_u32 s38, s38, 9216
  s_add_u32 m0, s37, 2048
  s_nop 0
  buffer_load_dwordx4 v1, s[8:11], s38 offen lds
  s_add_u32 s38, s38, 9216
  s_add_u32 m0, s37, 3072
  s_nop 0
  buffer_load_dwordx4 v1, s[8:11], s38 offen lds
  s_lshl_b32 s38, s36, 13
  s_add_u32 s38, s38, s46
  s_add_u32 m0, s37, 16384
  s_nop 0
  buffer_load_dwordx4 v2, s[12:15], s38 offen lds
  s_add_u32 s38, s38, 32768
  s_add_u32 m0, s37, 17408
  s_nop 0
  buffer_load_dwordx4 v2, s[12:15], s38 offen lds
  s_add_u32 s38, s38, 32768
  s_add_u32 m0, s37, 18432
  s_nop 0
  buffer_load_dwordx4 v3, s[12:15], s38 offen lds
  s_add_u32 s38, s38, 32768
  s_add_u32 m0, s37, 19456
  s_nop 0
  buffer_load_dwordx4 v3, s[12:15], s38 offen lds
GAQ_NODMA:
  ds_read_b128 a[0:3], v4 offset:0
  ds_read_b64_tr_b16 a[32:33], v6 offset:16384
  ds_read_b64_tr_b16 a[34:35], v6 offset:17408
  ds_read_b64_tr_b16 a[36:37], v7 offset:16384
  ds_read_b64_tr_b16 a[38:39], v7 offset:17408
  ds_read_b128 a[4:7], v4 offset:2048
  ds_read_b128 a[8:11], v4 offset:4096
  ds_read_b128 a[12:15], v4 offset:6144
  ds_read_b128 a[16:19], v4 offset:8192
  ds_read_b128 a[20:23], v4 offset:10240
  ds_read_b128 a[24:27], v4 offset:12288
  ds_read_b128 a[28:31], v4 offset:14336
  s_waitcnt lgkmcnt(9)
  v_mfma_f32_16x16x32_bf16 v[64:67], a[32:35], a[0:3], v[64:67]
  ds_read_b128 a[64:67], v5 offset:0
  s_waitcnt lgkmcnt(8)
  v_mfma_f32_16x16x32_bf16 v[68:71], a[36:39], a[0:3], v[68:71]
  ds_read_b64_tr_b16 a[96:97], v6 offset:24576
  s_waitcnt lgkmcnt(8)
  v_mfma_f32_16x16x32_bf16 v[72:75], a[32:35], a[4:7], v[72:75]
  ds_read_b64_tr_b16 a[98:99], v6 offset:25600
  v_mfma_f32_16x16x32_bf16 v[76:79], a[36:39], a[4:7], v[76:79]
  ds_read_b64_tr_b16 a[100:101], v7 offset:24576
  s_waitcnt lgkmcnt(9)
  v_mfma_f32_16x16x32_bf16 v[80:83], a[32:35], a[8:11], v[80:83]
  ds_read_b64_tr_b16 a[102:103], v7 offset:25600
  v_mfma_f32_16x16x32_bf16 v[84:87], a[36:39], a[8:11], v[84:87]
  ds_read_b128 a[68:71], v5 offset:2048
  s_waitcnt lgkmcnt(10)
  v_mfma_f32_16x16x32_bf16 v[88:91], a[32:35], a[12:15], v[88:91]
  ds_read_b128 a[72:75], v5 offset:4096
  v_mfma_f32_16x16x32_bf16 v[92:95], a[36:39], a[12:15], v[92:95]
  ds_read_b128 a[76:79], v5 offset:6144
  s_waitcnt lgkmcnt(11)
  v_mfma_f32_16x16x32_bf16 v[96:99], a[32:35], a[16:19], v[96:99]
  ds_read_b128 a[80:83], v5 offset:8192
  v_mfma_f32_16x16x32_bf16 v[100:103], a[36:39], a[16:19], v[100:103]
  ds_read_b128 a[84:87], v5 offset:10240
  s_waitcnt lgkmcnt(12)
  v_mfma_f32_16x16x32_bf16 v[104:107], a[32:35], a[20:23], v[104:107]
  ds_read_b128 a[88:91], v5 offset:12288
  v_mfma_f32_16x16x32_bf16 v[108:111], a[36:39], a[20:23], v[108:111]
  ds_read_b128 a[92:95], v5 offset:14336
  s_waitcnt lgkmcnt(13)
  v_mfma_f32_16x16x32_bf16 v[112:115], a[32:35], a[24:27], v[112:115]
  v_mfma_f32_16x16x32_bf16 v[116:119], a[36:39], a[24:27], v[116:119]
  s_waitcnt lgkmcnt(12)
  v_mfma_f32_16x16x32_bf16 v[120:123], a[32:35], a[28:31], v[120:123]
  v_mfma_f32_16x16x32_bf16 v[124:127], a[36:39], a[28:31], v[124:127]
  s_waitcnt lgkmcnt(9)
  v_mfma_f32_16x16x32_bf16 v[64:67], a[96:99], a[64:67], v[64:67]
  s_waitcnt lgkmcnt(7)
  v_mfma_f32_16x16x32_bf16 v[68:71], a[100:103], a[64:67], v[68:71]
  s_waitcnt lgkmcnt(6)
  v_mfma_f32_16x16x32_bf16 v[72:75], a[96:99], a[68:71], v[72:75]
  v_mfma_f32_16x16x32_bf16 v[76:79], a[100:103], a[68:71], v[76:79]
  s_waitcnt lgkmcnt(5)
  v_mfma_f32_16x16x32_bf16 v[80:83], a[96:99], a[72:75], v[80:83]
  v_mfma_f32_16x16x32_bf16 v[84:87], a[100:103], a[72:75], v[84:87]
  s_waitcnt lgkmcnt(4)
  v_mfma_f32_16x16x32_bf16 v[88:91], a[96:99], a[76:79], v[88:91]
  v_mfma_f32_16x16x32_bf16 v[92:95], a[100:103], a[76:79], v[92:95]
  s_waitcnt lgkmcnt(3)
  v_mfma_f32_16x16x32_bf16 v[96:99], a[96:99], a[80:83], v[96:99]
  v_mfma_f32_16x16x32_bf16 v[100:103], a[100:103], a[80:83], v[100:103]
  s_waitcnt lgkmcnt(2)
  v_mfma_f32_16x16x32_bf16 v[104:107], a[96:99], a[84:87], v[104:107]
  v_mfma_f32_16x16x32_bf16 v[108:111], a[100:103], a[84:87], v[108:111]
  s_waitcnt lgkmcnt(1)
  v_mfma_f32_16x16x32_bf16 v[112:115], a[96:99], a[88:91], v[112:115]
  v_mfma_f32_16x16x32_bf16 v[116:119], a[100:103], a[88:91], v[116:119]
  s_waitcnt lgkmcnt(0)
  v_mfma_f32_16x16x32_bf16 v[120:123], a[96:99], a[92:95], v[120:123]
  v_mfma_f32_16x16x32_bf16 v[124:127], a[100:103], a[92:95], v[124:127]
  s_add_u32 s47, s47, 1
  s_cmp_lt_u32 s47, 9
  s_cbranch_scc1 GAQ_KL
  s_lshl_b32 s37, s34, 7
  s_add_u32 s37, s37, s35
  s_lshl_b32 s37, s37, 2
  s_add_u32 s37, s37, s32
  s_lshl_b32 s37, s37, 11
  v_cvt_pk_bf16_f32 v12, v64, v65
  v_cvt_pk_bf16_f32 v13, v66, v67
  v_cvt_pk_bf16_f32 v14, v68, v69
  v_cvt_pk_bf16_f32 v15, v70, v71
  s_add_u32 s38, s37, 33554432
  buffer_store_dwordx4 v[12:15], v8, s[24:27], s38 offen offset:0 sc1
  v_cvt_pk_bf16_f32 v16, v72, v73
  v_cvt_pk_bf16_f32 v17, v74, v75
  v_cvt_pk_bf16_f32 v18, v76, v77
  v_cvt_pk_bf16_f32 v19, v78, v79
  s_add_u32 s38, s37, 33554432
  buffer_store_dwordx4 v[16:19], v8, s[24:27], s38 offen offset:1024 sc1
  v_cvt_pk_bf16_f32 v20, v80, v81
  v_cvt_pk_bf16_f32 v21, v82, v83
  v_cvt_pk_bf16_f32 v22, v84, v85
  v_cvt_pk_bf16_f32 v23, v86, v87
  s_add_u32 s38, s37, 33816576
  buffer_store_dwordx4 v[20:23], v8, s[24:27], s38 offen offset:0 sc1
  v_cvt_pk_bf16_f32 v24, v88, v89
  v_cvt_pk_bf16_f32 v25, v90, v91
  v_cvt_pk_bf16_f32 v26, v92, v93
  v_cvt_pk_bf16_f32 v27, v94, v95
  s_add_u32 s38, s37, 33816576
  buffer_store_dwordx4 v[24:27], v8, s[24:27], s38 offen offset:1024 sc1
  v_cvt_pk_bf16_f32 v12, v96, v97
  v_cvt_pk_bf16_f32 v13, v98, v99
  v_cvt_pk_bf16_f32 v14, v100, v101
  v_cvt_pk_bf16_f32 v15, v102, v103
  s_add_u32 s38, s37, 34078720
  buffer_store_dwordx4 v[12:15], v8, s[24:27], s38 offen offset:0 sc1
  v_cvt_pk_bf16_f32 v16, v104, v105
  v_cvt_pk_bf16_f32 v17, v106, v107
  v_cvt_pk_bf16_f32 v18, v108, v109
  v_cvt_pk_bf16_f32 v19, v110, v111
  s_add_u32 s38, s37, 34078720
  buffer_store_dwordx4 v[16:19], v8, s[24:27], s38 offen offset:1024 sc1
  v_cvt_pk_bf16_f32 v20, v112, v113
  v_cvt_pk_bf16_f32 v21, v114, v115
  v_cvt_pk_bf16_f32 v22, v116, v117
  v_cvt_pk_bf16_f32 v23, v118, v119
  s_add_u32 s38, s37, 34340864
  buffer_store_dwordx4 v[20:23], v8, s[24:27], s38 offen offset:0 sc1
  v_cvt_pk_bf16_f32 v24, v120, v121
  v_cvt_pk_bf16_f32 v25, v122, v123
  v_cvt_pk_bf16_f32 v26, v124, v125
  v_cvt_pk_bf16_f32 v27, v126, v127
  s_add_u32 s38, s37, 34340864
  buffer_store_dwordx4 v[24:27], v8, s[24:27], s38 offen offset:1024 sc1
  s_waitcnt vmcnt(0)
  s_barrier
  s_cmp_eq_u32 s32, 0
  s_cbranch_scc0 GAQ_SIG_32
  s_lshl_b32 s37, s34, 2
  s_add_u32 s37, s37, 128
  v_mov_b32 v12, s37
  v_mov_b32 v13, 1
  s_mov_b64 exec, 1
  buffer_atomic_add v13, v12, s[28:31], 0 offen sc1
  s_mov_b64 exec, -1
GAQ_SIG_32:
  s_add_u32 s33, s33, s94
  s_lshl_b32 s92, s93, 4
  s_cmp_lt_u32 s33, s92
  s_cbranch_scc1 L_UNITQ
  s_mov_b32 s97, s32
  s_sub_u32 s92, s96, 1
  s_lshl_b32 s92, s92, 5
  s_cmp_eq_u32 s96, 6
  s_cselect_b32 s92, 149, s92
  s_cmp_eq_u32 s96, 7
  s_cselect_b32 s92, 170, s92
  s_add_u32 s92, s92, s98
  s_mul_i32 s92, s92, 49152
  s_mul_i32 s91, s97, 12288
  s_add_u32 s92, s92, s91
  s_add_u32 s92, s92, 100663296
  v_mov_b32 v12, -1
  v_mov_b32 v13, -1
  v_mov_b32 v14, -1
  v_mov_b32 v15, -1
  buffer_store_dwordx4 v[12:15], v8, s[24:27], s92 offen offset:0 sc1
  buffer_store_dwordx4 v[12:15], v8, s[24:27], s92 offen offset:1024 sc1
  buffer_store_dwordx4 v[12:15], v8, s[24:27], s92 offen offset:2048 sc1
  buffer_store_dwordx4 v[12:15], v8, s[24:27], s92 offen offset:3072 sc1
  s_add_u32 s92, s92, 4096
  buffer_store_dwordx4 v[12:15], v8, s[24:27], s92 offen offset:0 sc1
  buffer_store_dwordx4 v[12:15], v8, s[24:27], s92 offen offset:1024 sc1
  buffer_store_dwordx4 v[12:15], v8, s[24:27], s92 offen offset:2048 sc1
  buffer_store_dwordx4 v[12:15], v8, s[24:27], s92 offen offset:3072 sc1
  s_add_u32 s92, s92, 4096
  buffer_store_dwordx4 v[12:15], v8, s[24:27], s92 offen offset:0 sc1
  buffer_store_dwordx4 v[12:15], v8, s[24:27], s92 offen offset:1024 sc1
  buffer_store_dwordx4 v[12:15], v8, s[24:27], s92 offen offset:2048 sc1
  buffer_store_dwordx4 v[12:15], v8, s[24:27], s92 offen offset:3072 sc1
  s_add_u32 s92, s92, 4096
  s_waitcnt vmcnt(0)
  s_barrier
  s_cmp_eq_u32 s97, 0
  s_cbranch_scc0 SLI_33
  v_mov_b32 v12, 80
  v_mov_b32 v13, 1
  s_mov_b64 exec, 1
  buffer_atomic_add v13, v12, s[28:31], 0 offen sc1
  s_mov_b64 exec, -1
SLI_33:
  v_lshrrev_b32 v0, 4, v8
  s_cmp_le_u32 s96, 6
  s_cbranch_scc0 L_MISC7
  s_cmp_lt_u32 s98, 16
  s_cbranch_scc1 L_W4
  s_sub_u32 s99, s96, 1
  s_lshl_b32 s99, s99, 4
  s_add_u32 s99, s99, s98
  s_sub_u32 s99, s99, 16
  s_cmp_eq_u32 s96, 6
  s_cbranch_scc0 L_ROLE
  s_add_u32 s99, s98, 53
  s_branch L_ROLE
L_MISC7:
  s_add_u32 s99, s98, 74
L_ROLE:
L_W3:
  s_cmp_lt_u32 s99, 48
  s_cbranch_scc0 L_SPL
  s_lshl_b32 s95, s97, 6
  v_add_u32 v0, s95, v0
  s_load_dwordx2 s[8:9], s[70:71], 96
  s_waitcnt lgkmcnt(0)
  s_mov_b32 s10, 268435456
  s_mov_b32 s11, 0x00020000
  v_lshrrev_b32 v2, 6, v0
  s_nop 0
  v_readfirstlane_b32 s12, v2
  v_and_b32 v0, 63, v0
  v_lshlrev_b32 v1, 4, v0
  v_lshlrev_b32 v2, 3, v0
  s_mov_b32 s22, 0x3e0293ee
  s_mov_b32 s23, 0x3e0293ee
  s_mov_b32 s24, -1
  s_mov_b32 s25, 0
  s_mov_b32 s26, 0xfff0ffff
  s_mov_b32 s27, 0xf000ff00
  s_mov_b32 s28, 0xffe0fffe
  s_mov_b32 s29, 0xe000fe00
  s_mov_b32 s30, 0xffc0fffc
  s_mov_b32 s31, 0xc000fc00
  s_mov_b32 s32, 0xff80fff8
  s_mov_b32 s33, 0x8000f800
  s_load_dwordx2 s[44:45], s[70:71], 88
  s_waitcnt lgkmcnt(0)
  s_mov_b32 s46, 256
  s_mov_b32 s47, 0x00020000
  s_mov_b32 s48, 64
  s_mov_b32 s49, 0
  s_mov_b32 s50, 0
W3I_34:
  s_mov_b64 exec, 1
  buffer_load_dword v10, off, s[44:47], s48 sc1
  s_mov_b64 exec, -1
  s_waitcnt vmcnt(0)
  v_readfirstlane_b32 s51, v10
  s_lshr_b32 s51, s51, s49
  s_and_b32 s51, s51, 63
  s_add_u32 s50, s50, 1
  s_cmp_ge_u32 s50, 1000000
  s_cbranch_scc1 W3I_34x
  s_cmp_ge_u32 s51, 32
  s_cbranch_scc1 W3I_34x
  s_sleep 32
  s_branch W3I_34
W3I_34x:
L_W3U:
  s_cmp_lt_u32 s99, 512
  s_cbranch_scc0 L_END
  s_lshr_b32 s13, s99, 3
  s_and_b32 s14, s99, 7
  s_lshl_b32 s14, s14, 2
  s_add_u32 s14, s14, s12
  s_lshl_b32 s16, s13, 5
  s_add_u32 s16, s16, s14
  s_lshl_b32 s17, s16, 13
  s_lshl_b32 s18, s16, 12
  s_lshl_b32 s19, s16, 11
  s_add_u32 s18, s18, 67108864
  s_add_u32 s19, s19, 75497472
  s_lshr_b32 s48, s13, 2
  s_lshl_b32 s48, s48, 2
  s_add_u32 s48, s48, 128
  s_mov_b32 s49, 0
  s_mov_b32 s50, 0
W3Q_35:
  s_mov_b64 exec, 1
  buffer_load_dword v10, off, s[44:47], s48 sc1
  s_mov_b64 exec, -1
  s_waitcnt vmcnt(0)
  v_readfirstlane_b32 s51, v10
  s_lshr_b32 s51, s51, s49
  s_and_b32 s51, s51, 65535
  s_add_u32 s50, s50, 1
  s_cmp_ge_u32 s50, 1000000
  s_cbranch_scc1 W3Q_35x
  s_cmp_ge_u32 s51, 32
  s_cbranch_scc1 W3Q_35x
  s_sleep 32
  s_branch W3Q_35
W3Q_35x:
  s_add_u32 s20, s17, 33554432
  buffer_load_dwordx4 v[8:11], v1, s[8:11], s20 offen offset:0 sc1
  buffer_load_dwordx4 v[12:15], v1, s[8:11], s20 offen offset:1024 sc1
  buffer_load_dwordx4 v[16:19], v1, s[8:11], s20 offen offset:2048 sc1
  buffer_load_dwordx4 v[20:23], v1, s[8:11], s20 offen offset:3072 sc1
  s_add_u32 s20, s17, 33558528
  buffer_load_dwordx4 v[24:27], v1, s[8:11], s20 offen offset:0 sc1
  buffer_load_dwordx4 v[28:31], v1, s[8:11], s20 offen offset:1024 sc1
  buffer_load_dwordx4 v[32:35], v1, s[8:11], s20 offen offset:2048 sc1
  buffer_load_dwordx4 v[36:39], v1, s[8:11], s20 offen offset:3072 sc1
  s_add_u32 s20, s17, 0
  buffer_load_dwordx4 v[40:43], v1, s[8:11], s20 offen offset:0 sc1
  buffer_load_dwordx4 v[44:47], v1, s[8:11], s20 offen offset:1024 sc1
  buffer_load_dwordx4 v[48:51], v1, s[8:11], s20 offen offset:2048 sc1
  buffer_load_dwordx4 v[52:55], v1, s[8:11], s20 offen offset:3072 sc1
  s_add_u32 s20, s17, 4096
  buffer_load_dwordx4 v[56:59], v1, s[8:11], s20 offen offset:0 sc1
  buffer_load_dwordx4 v[60:63], v1, s[8:11], s20 offen offset:1024 sc1
  buffer_load_dwordx4 v[64:67], v1, s[8:11], s20 offen offset:2048 sc1
  buffer_load_dwordx4 v[68:71], v1, s[8:11], s20 offen offset:3072 sc1
  s_add_u32 s20, s17, 16777216
  buffer_load_dwordx4 v[88:91], v1, s[8:11], s20 offen offset:0 sc1
  buffer_load_dwordx4 v[92:95], v1, s[8:11], s20 offen offset:1024 sc1
  buffer_load_dwordx4 v[96:99], v1, s[8:11], s20 offen offset:2048 sc1
  buffer_load_dwordx4 v[100:103], v1, s[8:11], s20 offen offset:3072 sc1
  s_add_u32 s20, s17, 16781312
  buffer_load_dwordx4 v[104:107], v1, s[8:11], s20 offen offset:0 sc1
  buffer_load_dwordx4 v[108:111], v1, s[8:11], s20 offen offset:1024 sc1
  buffer_load_dwordx4 v[112:115], v1, s[8:11], s20 offen offset:2048 sc1
  buffer_load_dwordx4 v[116:119], v1, s[8:11], s20 offen offset:3072 sc1
  s_lshl_b32 s48, s14, 9
  s_add_u32 s48, s48, 80510980
  s_lshl_b32 s52, s13, 2
  s_add_u32 s48, s48, s52
  s_mov_b32 s49, 0
  s_cmp_ge_u32 s13, 60
  s_cbranch_scc1 W3L_36
  s_mov_b32 s50, 0
W3W_37:
  s_mov_b64 exec, 1
  buffer_load_dword v214, off, s[8:11], s48 sc1
  s_mov_b64 exec, -1
  s_waitcnt vmcnt(0)
  v_readfirstlane_b32 s51, v214
  s_lshr_b32 s51, s51, s49
  s_and_b32 s51, s51, 65535
  s_add_u32 s50, s50, 1
  s_cmp_ge_u32 s50, 1000000
  s_cbranch_scc1 W3W_37x
  s_cmp_ge_u32 s51, 1
  s_cbranch_scc1 W3W_37x
  s_sleep 48
  s_branch W3W_37
W3W_37x:
  s_branch W3L_36x
W3L_36:
  s_mov_b32 s50, 0
W3V_38:
  s_mov_b64 exec, 1
  buffer_load_dword v214, off, s[8:11], s48 sc1
  s_mov_b64 exec, -1
  s_waitcnt vmcnt(0)
  v_readfirstlane_b32 s51, v214
  s_lshr_b32 s51, s51, s49
  s_and_b32 s51, s51, 65535
  s_add_u32 s50, s50, 1
  s_cmp_ge_u32 s50, 1000000
  s_cbranch_scc1 W3V_38x
  s_cmp_ge_u32 s51, 1
  s_cbranch_scc1 W3V_38x
  s_sleep 4
  s_branch W3V_38
W3V_38x:
W3L_36x:
  buffer_load_dwordx4 v[72:75], v1, s[8:11], s18 offen offset:0 sc1
  buffer_load_dwordx4 v[76:79], v1, s[8:11], s18 offen offset:1024 sc1
  buffer_load_dwordx4 v[80:83], v1, s[8:11], s18 offen offset:2048 sc1
  buffer_load_dwordx4 v[84:87], v1, s[8:11], s18 offen offset:3072 sc1
  buffer_load_dwordx2 v[120:121], v2, s[8:11], s19 offen offset:0 sc1
  buffer_load_dwordx2 v[122:123], v2, s[8:11], s19 offen offset:512 sc1
  buffer_load_dwordx2 v[124:125], v2, s[8:11], s19 offen offset:1024 sc1
  buffer_load_dwordx2 v[126:127], v2, s[8:11], s19 offen offset:1536 sc1
  v_mfma_f32_16x16x32_bf16 v[132:135], v[40:43], v[8:11], 0
  v_mfma_f32_16x16x32_bf16 v[132:135], v[48:51], v[16:19], v[132:135]
  v_mfma_f32_16x16x32_bf16 v[132:135], v[56:59], v[24:27], v[132:135]
  v_mfma_f32_16x16x32_bf16 v[132:135], v[64:67], v[32:35], v[132:135]
  v_mfma_f32_16x16x32_bf16 v[140:143], v[40:43], v[12:15], 0
  v_mfma_f32_16x16x32_bf16 v[140:143], v[48:51], v[20:23], v[140:143]
  v_mfma_f32_16x16x32_bf16 v[140:143], v[56:59], v[28:31], v[140:143]
  v_mfma_f32_16x16x32_bf16 v[140:143], v[64:67], v[36:39], v[140:143]
  v_mfma_f32_16x16x32_bf16 v[144:147], v[44:47], v[12:15], 0
  v_mfma_f32_16x16x32_bf16 v[144:147], v[52:55], v[20:23], v[144:147]
  v_mfma_f32_16x16x32_bf16 v[144:147], v[60:63], v[28:31], v[144:147]
  v_mfma_f32_16x16x32_bf16 v[144:147], v[68:71], v[36:39], v[144:147]
  s_waitcnt vmcnt(7)
  v_mfma_f32_16x16x32_bf16 v[128:131], v[72:75], v[8:11], 0
  s_waitcnt vmcnt(6)
  v_mfma_f32_16x16x32_bf16 v[128:131], v[76:79], v[16:19], v[128:131]
  s_waitcnt vmcnt(5)
  v_mfma_f32_16x16x32_bf16 v[128:131], v[80:83], v[24:27], v[128:131]
  s_waitcnt vmcnt(4)
  v_mfma_f32_16x16x32_bf16 v[128:131], v[84:87], v[32:35], v[128:131]
  v_mfma_f32_16x16x32_bf16 v[136:139], v[72:75], v[12:15], 0
  v_mfma_f32_16x16x32_bf16 v[136:139], v[76:79], v[20:23], v[136:139]
  v_mfma_f32_16x16x32_bf16 v[136:139], v[80:83], v[28:31], v[136:139]
  v_mfma_f32_16x16x32_bf16 v[136:139], v[84:87], v[36:39], v[136:139]
  s_waitcnt vmcnt(3)
  v_cndmask_b32 v180, 0, v120, s[24:25]
  v_cndmask_b32 v182, v120, 0, s[24:25]
  v_cndmask_b32 v181, 0, v121, s[24:25]
  v_cndmask_b32 v183, v121, 0, s[24:25]
  s_waitcnt vmcnt(2)
  v_cndmask_b32 v184, 0, v122, s[24:25]
  v_cndmask_b32 v186, v122, 0, s[24:25]
  v_cndmask_b32 v185, 0, v123, s[24:25]
  v_cndmask_b32 v187, v123, 0, s[24:25]
  s_waitcnt vmcnt(1)
  v_cndmask_b32 v188, 0, v124, s[24:25]
  v_cndmask_b32 v190, v124, 0, s[24:25]
  v_cndmask_b32 v189, 0, v125, s[24:25]
  v_cndmask_b32 v191, v125, 0, s[24:25]
  s_waitcnt vmcnt(0)
  v_cndmask_b32 v192, 0, v126, s[24:25]
  v_cndmask_b32 v194, v126, 0, s[24:25]
  v_cndmask_b32 v193, 0, v127, s[24:25]
  v_cndmask_b32 v195, v127, 0, s[24:25]
  v_mov_b32 v208, 0xff800000
  v_cndmask_b32 v132, v208, v132, s[26:27]
  v_cndmask_b32 v144, v208, v144, s[26:27]
  v_cndmask_b32 v133, v208, v133, s[28:29]
  v_cndmask_b32 v145, v208, v145, s[28:29]
  v_cndmask_b32 v134, v208, v134, s[30:31]
  v_cndmask_b32 v146, v208, v146, s[30:31]
  v_cndmask_b32 v135, v208, v135, s[32:33]
  v_cndmask_b32 v147, v208, v147, s[32:33]
  v_max3_f32 v210, v128, v129, v130
  v_max3_f32 v210, v210, v131, v132
  v_max3_f32 v210, v210, v133, v134
  v_max_f32 v210, v210, v135
  v_mov_b32 v211, v210
  s_nop 1
  v_permlane16_swap_b32 v210, v211
  v_max_f32 v210, v210, v211
  v_mov_b32 v211, v210
  s_nop 1
  v_permlane32_swap_b32 v210, v211
  v_max_f32 v210, v210, v211
  v_mul_f32 v210, s22, v210
  v_pk_fma_f32 v[128:129], v[128:129], s[22:23], v[210:211] op_sel_hi:[1,0,0] neg_lo:[0,0,1] neg_hi:[0,0,1]
  v_pk_fma_f32 v[130:131], v[130:131], s[22:23], v[210:211] op_sel_hi:[1,0,0] neg_lo:[0,0,1] neg_hi:[0,0,1]
  v_pk_fma_f32 v[132:133], v[132:133], s[22:23], v[210:211] op_sel_hi:[1,0,0] neg_lo:[0,0,1] neg_hi:[0,0,1]
  v_pk_fma_f32 v[134:135], v[134:135], s[22:23], v[210:211] op_sel_hi:[1,0,0] neg_lo:[0,0,1] neg_hi:[0,0,1]
  v_exp_f32 v128, v128
  v_exp_f32 v129, v129
  v_exp_f32 v130, v130
  v_exp_f32 v131, v131
  v_exp_f32 v132, v132
  v_exp_f32 v133, v133
  v_exp_f32 v134, v134
  v_exp_f32 v135, v135
  v_add_f32 v210, v128, v129
  v_add_f32 v211, v130, v131
  v_add_f32 v210, v210, v211
  v_mul_f32 v210, 0.5, v210
  v_add_f32 v210, v210, v132
  v_add_f32 v210, v210, v133
  v_add_f32 v210, v210, v134
  v_add_f32 v210, v210, v135
  v_mov_b32 v211, v210
  s_nop 1
  v_permlane16_swap_b32 v210, v211
  v_add_f32 v210, v210, v211
  v_mov_b32 v211, v210
  s_nop 1
  v_permlane32_swap_b32 v210, v211
  v_add_f32 v210, v210, v211
  v_rcp_f32 v213, v210
  v_cvt_pk_bf16_f32 v196, v132, v133
  v_cvt_pk_bf16_f32 v197, v134, v135
  v_mov_b32 v198, 0
  v_mov_b32 v199, 0
  v_cvt_pk_bf16_f32 v204, v128, v129
  v_cvt_pk_bf16_f32 v205, v130, v131
  v_mfma_f32_16x16x32_bf16 v[148:151], v[88:91], v[196:199], 0
  v_mfma_f32_16x16x32_bf16 v[152:155], v[92:95], v[196:199], 0
  v_mfma_f32_16x16x32_bf16 v[156:159], v[96:99], v[196:199], 0
  v_mfma_f32_16x16x32_bf16 v[160:163], v[100:103], v[196:199], 0
  v_mfma_f32_16x16x32_bf16 v[164:167], v[104:107], v[196:199], 0
  v_mfma_f32_16x16x32_bf16 v[168:171], v[108:111], v[196:199], 0
  v_mfma_f32_16x16x32_bf16 v[172:175], v[112:115], v[196:199], 0
  v_mfma_f32_16x16x32_bf16 v[176:179], v[116:119], v[196:199], 0
  v_mfma_f32_16x16x16_bf16 v[148:151], v[180:181], v[204:205], v[148:151]
  v_mfma_f32_16x16x16_bf16 v[152:155], v[182:183], v[204:205], v[152:155]
  v_mfma_f32_16x16x16_bf16 v[156:159], v[184:185], v[204:205], v[156:159]
  v_mfma_f32_16x16x16_bf16 v[160:163], v[186:187], v[204:205], v[160:163]
  v_mfma_f32_16x16x16_bf16 v[164:167], v[188:189], v[204:205], v[164:167]
  v_mfma_f32_16x16x16_bf16 v[168:171], v[190:191], v[204:205], v[168:171]
  v_mfma_f32_16x16x16_bf16 v[172:175], v[192:193], v[204:205], v[172:175]
  v_mfma_f32_16x16x16_bf16 v[176:179], v[194:195], v[204:205], v[176:179]
  s_lshl_b32 s20, s13, 1
  s_add_u32 s20, s20, 0
  s_lshl_b32 s20, s20, 7
  s_lshl_b32 s21, s14, 2
  s_add_u32 s20, s20, s21
  s_lshl_b32 s20, s20, 10
  s_add_u32 s20, s20, 50331648
  v_pk_mul_f32 v[148:149], v[148:149], v[212:213] op_sel:[0,1] op_sel_hi:[1,1]
  v_pk_mul_f32 v[150:151], v[150:151], v[212:213] op_sel:[0,1] op_sel_hi:[1,1]
  v_pk_mul_f32 v[152:153], v[152:153], v[212:213] op_sel:[0,1] op_sel_hi:[1,1]
  v_pk_mul_f32 v[154:155], v[154:155], v[212:213] op_sel:[0,1] op_sel_hi:[1,1]
  v_cvt_pk_bf16_f32 v148, v148, v149
  v_cvt_pk_bf16_f32 v149, v150, v151
  v_cvt_pk_bf16_f32 v150, v152, v153
  v_cvt_pk_bf16_f32 v151, v154, v155
  buffer_store_dwordx4 v[148:151], v1, s[8:11], s20 offen offset:0 sc1
  v_pk_mul_f32 v[156:157], v[156:157], v[212:213] op_sel:[0,1] op_sel_hi:[1,1]
  v_pk_mul_f32 v[158:159], v[158:159], v[212:213] op_sel:[0,1] op_sel_hi:[1,1]
  v_pk_mul_f32 v[160:161], v[160:161], v[212:213] op_sel:[0,1] op_sel_hi:[1,1]
  v_pk_mul_f32 v[162:163], v[162:163], v[212:213] op_sel:[0,1] op_sel_hi:[1,1]
  v_cvt_pk_bf16_f32 v156, v156, v157
  v_cvt_pk_bf16_f32 v157, v158, v159
  v_cvt_pk_bf16_f32 v158, v160, v161
  v_cvt_pk_bf16_f32 v159, v162, v163
  buffer_store_dwordx4 v[156:159], v1, s[8:11], s20 offen offset:1024 sc1
  v_pk_mul_f32 v[164:165], v[164:165], v[212:213] op_sel:[0,1] op_sel_hi:[1,1]
  v_pk_mul_f32 v[166:167], v[166:167], v[212:213] op_sel:[0,1] op_sel_hi:[1,1]
  v_pk_mul_f32 v[168:169], v[168:169], v[212:213] op_sel:[0,1] op_sel_hi:[1,1]
  v_pk_mul_f32 v[170:171], v[170:171], v[212:213] op_sel:[0,1] op_sel_hi:[1,1]
  v_cvt_pk_bf16_f32 v164, v164, v165
  v_cvt_pk_bf16_f32 v165, v166, v167
  v_cvt_pk_bf16_f32 v166, v168, v169
  v_cvt_pk_bf16_f32 v167, v170, v171
  buffer_store_dwordx4 v[164:167], v1, s[8:11], s20 offen offset:2048 sc1
  v_pk_mul_f32 v[172:173], v[172:173], v[212:213] op_sel:[0,1] op_sel_hi:[1,1]
  v_pk_mul_f32 v[174:175], v[174:175], v[212:213] op_sel:[0,1] op_sel_hi:[1,1]
  v_pk_mul_f32 v[176:177], v[176:177], v[212:213] op_sel:[0,1] op_sel_hi:[1,1]
  v_pk_mul_f32 v[178:179], v[178:179], v[212:213] op_sel:[0,1] op_sel_hi:[1,1]
  v_cvt_pk_bf16_f32 v172, v172, v173
  v_cvt_pk_bf16_f32 v173, v174, v175
  v_cvt_pk_bf16_f32 v174, v176, v177
  v_cvt_pk_bf16_f32 v175, v178, v179
  buffer_store_dwordx4 v[172:175], v1, s[8:11], s20 offen offset:3072 sc1
  v_max3_f32 v210, v136, v137, v138
  v_max3_f32 v210, v210, v139, v140
  v_max3_f32 v210, v210, v141, v142
  v_max3_f32 v210, v210, v143, v144
  v_max3_f32 v210, v210, v145, v146
  v_max_f32 v210, v210, v147
  v_mov_b32 v211, v210
  s_nop 1
  v_permlane16_swap_b32 v210, v211
  v_max_f32 v210, v210, v211
  v_mov_b32 v211, v210
  s_nop 1
  v_permlane32_swap_b32 v210, v211
  v_max_f32 v210, v210, v211
  v_mul_f32 v210, s22, v210
  v_pk_fma_f32 v[136:137], v[136:137], s[22:23], v[210:211] op_sel_hi:[1,0,0] neg_lo:[0,0,1] neg_hi:[0,0,1]
  v_pk_fma_f32 v[138:139], v[138:139], s[22:23], v[210:211] op_sel_hi:[1,0,0] neg_lo:[0,0,1] neg_hi:[0,0,1]
  v_pk_fma_f32 v[140:141], v[140:141], s[22:23], v[210:211] op_sel_hi:[1,0,0] neg_lo:[0,0,1] neg_hi:[0,0,1]
  v_pk_fma_f32 v[142:143], v[142:143], s[22:23], v[210:211] op_sel_hi:[1,0,0] neg_lo:[0,0,1] neg_hi:[0,0,1]
  v_pk_fma_f32 v[144:145], v[144:145], s[22:23], v[210:211] op_sel_hi:[1,0,0] neg_lo:[0,0,1] neg_hi:[0,0,1]
  v_pk_fma_f32 v[146:147], v[146:147], s[22:23], v[210:211] op_sel_hi:[1,0,0] neg_lo:[0,0,1] neg_hi:[0,0,1]
  v_exp_f32 v136, v136
  v_exp_f32 v137, v137
  v_exp_f32 v138, v138
  v_exp_f32 v139, v139
  v_exp_f32 v140, v140
  v_exp_f32 v141, v141
  v_exp_f32 v142, v142
  v_exp_f32 v143, v143
  v_exp_f32 v144, v144
  v_exp_f32 v145, v145
  v_exp_f32 v146, v146
  v_exp_f32 v147, v147
  v_add_f32 v210, v136, v137
  v_add_f32 v211, v138, v139
  v_add_f32 v210, v210, v211
  v_mul_f32 v210, 0.5, v210
  v_add_f32 v210, v210, v140
  v_add_f32 v210, v210, v141
  v_add_f32 v210, v210, v142
  v_add_f32 v210, v210, v143
  v_add_f32 v210, v210, v144
  v_add_f32 v210, v210, v145
  v_add_f32 v210, v210, v146
  v_add_f32 v210, v210, v147
  v_mov_b32 v211, v210
  s_nop 1
  v_permlane16_swap_b32 v210, v211
  v_add_f32 v210, v210, v211
  v_mov_b32 v211, v210
  s_nop 1
  v_permlane32_swap_b32 v210, v211
  v_add_f32 v210, v210, v211
  v_rcp_f32 v213, v210
  v_cvt_pk_bf16_f32 v200, v140, v141
  v_cvt_pk_bf16_f32 v201, v142, v143
  v_cvt_pk_bf16_f32 v202, v144, v145
  v_cvt_pk_bf16_f32 v203, v146, v147
  v_cvt_pk_bf16_f32 v206, v136, v137
  v_cvt_pk_bf16_f32 v207, v138, v139
  v_mfma_f32_16x16x32_bf16 v[148:151], v[88:91], v[200:203], 0
  v_mfma_f32_16x16x32_bf16 v[152:155], v[92:95], v[200:203], 0
  v_mfma_f32_16x16x32_bf16 v[156:159], v[96:99], v[200:203], 0
  v_mfma_f32_16x16x32_bf16 v[160:163], v[100:103], v[200:203], 0
  v_mfma_f32_16x16x32_bf16 v[164:167], v[104:107], v[200:203], 0
  v_mfma_f32_16x16x32_bf16 v[168:171], v[108:111], v[200:203], 0
  v_mfma_f32_16x16x32_bf16 v[172:175], v[112:115], v[200:203], 0
  v_mfma_f32_16x16x32_bf16 v[176:179], v[116:119], v[200:203], 0
  v_mfma_f32_16x16x16_bf16 v[148:151], v[180:181], v[206:207], v[148:151]
  v_mfma_f32_16x16x16_bf16 v[152:155], v[182:183], v[206:207], v[152:155]
  v_mfma_f32_16x16x16_bf16 v[156:159], v[184:185], v[206:207], v[156:159]
  v_mfma_f32_16x16x16_bf16 v[160:163], v[186:187], v[206:207], v[160:163]
  v_mfma_f32_16x16x16_bf16 v[164:167], v[188:189], v[206:207], v[164:167]
  v_mfma_f32_16x16x16_bf16 v[168:171], v[190:191], v[206:207], v[168:171]
  v_mfma_f32_16x16x16_bf16 v[172:175], v[192:193], v[206:207], v[172:175]
  v_mfma_f32_16x16x16_bf16 v[176:179], v[194:195], v[206:207], v[176:179]
  s_lshl_b32 s20, s13, 1
  s_add_u32 s20, s20, 1
  s_lshl_b32 s20, s20, 7
  s_lshl_b32 s21, s14, 2
  s_add_u32 s20, s20, s21
  s_lshl_b32 s20, s20, 10
  s_add_u32 s20, s20, 50331648
  v_pk_mul_f32 v[148:149], v[148:149], v[212:213] op_sel:[0,1] op_sel_hi:[1,1]
  v_pk_mul_f32 v[150:151], v[150:151], v[212:213] op_sel:[0,1] op_sel_hi:[1,1]
  v_pk_mul_f32 v[152:153], v[152:153], v[212:213] op_sel:[0,1] op_sel_hi:[1,1]
  v_pk_mul_f32 v[154:155], v[154:155], v[212:213] op_sel:[0,1] op_sel_hi:[1,1]
  v_cvt_pk_bf16_f32 v148, v148, v149
  v_cvt_pk_bf16_f32 v149, v150, v151
  v_cvt_pk_bf16_f32 v150, v152, v153
  v_cvt_pk_bf16_f32 v151, v154, v155
  buffer_store_dwordx4 v[148:151], v1, s[8:11], s20 offen offset:0 sc1
  v_pk_mul_f32 v[156:157], v[156:157], v[212:213] op_sel:[0,1] op_sel_hi:[1,1]
  v_pk_mul_f32 v[158:159], v[158:159], v[212:213] op_sel:[0,1] op_sel_hi:[1,1]
  v_pk_mul_f32 v[160:161], v[160:161], v[212:213] op_sel:[0,1] op_sel_hi:[1,1]
  v_pk_mul_f32 v[162:163], v[162:163], v[212:213] op_sel:[0,1] op_sel_hi:[1,1]
  v_cvt_pk_bf16_f32 v156, v156, v157
  v_cvt_pk_bf16_f32 v157, v158, v159
  v_cvt_pk_bf16_f32 v158, v160, v161
  v_cvt_pk_bf16_f32 v159, v162, v163
  buffer_store_dwordx4 v[156:159], v1, s[8:11], s20 offen offset:1024 sc1
  v_pk_mul_f32 v[164:165], v[164:165], v[212:213] op_sel:[0,1] op_sel_hi:[1,1]
  v_pk_mul_f32 v[166:167], v[166:167], v[212:213] op_sel:[0,1] op_sel_hi:[1,1]
  v_pk_mul_f32 v[168:169], v[168:169], v[212:213] op_sel:[0,1] op_sel_hi:[1,1]
  v_pk_mul_f32 v[170:171], v[170:171], v[212:213] op_sel:[0,1] op_sel_hi:[1,1]
  v_cvt_pk_bf16_f32 v164, v164, v165
  v_cvt_pk_bf16_f32 v165, v166, v167
  v_cvt_pk_bf16_f32 v166, v168, v169
  v_cvt_pk_bf16_f32 v167, v170, v171
  buffer_store_dwordx4 v[164:167], v1, s[8:11], s20 offen offset:2048 sc1
  v_pk_mul_f32 v[172:173], v[172:173], v[212:213] op_sel:[0,1] op_sel_hi:[1,1]
  v_pk_mul_f32 v[174:175], v[174:175], v[212:213] op_sel:[0,1] op_sel_hi:[1,1]
  v_pk_mul_f32 v[176:177], v[176:177], v[212:213] op_sel:[0,1] op_sel_hi:[1,1]
  v_pk_mul_f32 v[178:179], v[178:179], v[212:213] op_sel:[0,1] op_sel_hi:[1,1]
  v_cvt_pk_bf16_f32 v172, v172, v173
  v_cvt_pk_bf16_f32 v173, v174, v175
  v_cvt_pk_bf16_f32 v174, v176, v177
  v_cvt_pk_bf16_f32 v175, v178, v179
  buffer_store_dwordx4 v[172:175], v1, s[8:11], s20 offen offset:3072 sc1
  s_waitcnt vmcnt(0)
  s_barrier
  s_cmp_eq_u32 s12, 0
  s_cbranch_scc0 W3S_39
  s_lshr_b32 s48, s13, 1
  s_lshl_b32 s48, s48, 7
  s_add_u32 s48, s48, 80486400
  v_mov_b32 v10, s48
  v_mov_b32 v11, 1
  s_mov_b64 exec, 1
  buffer_atomic_add v11, v10, s[8:11], 0 offen sc1
  s_mov_b64 exec, -1
W3S_39:
  s_add_u32 s99, s99, 48
  s_branch L_W3U
L_W4:
  s_lshl_b32 s95, s97, 6
  v_add_u32 v0, s95, v0
  s_load_dwordx2 s[8:9], s[70:71], 96
  s_load_dwordx2 s[12:13], s[70:71], 40
  s_load_dwordx2 s[16:17], s[70:71], 80
  s_waitcnt lgkmcnt(0)
  s_mov_b32 s10, 268435456
  s_mov_b32 s11, 0x00020000
  s_mov_b32 s14, 4718592
  s_mov_b32 s15, 0x00020000
  s_mov_b32 s18, 4718592
  s_mov_b32 s19, 0x00020000
  v_lshrrev_b32 v10, 6, v0
  s_nop 0
  v_readfirstlane_b32 s20, v10
  v_and_b32 v0, 63, v0
  v_lshlrev_b32 v1, 4, v0
  v_add_u32 v10, 0, v0
  v_mul_u32_u24 v11, 43691, v10
  v_lshrrev_b32 v11, 19, v11
  v_mul_u32_u24 v12, 12, v11
  v_sub_u32 v12, v10, v12
  v_mul_u32_u24 v11, 1152, v11
  v_lshlrev_b32 v12, 4, v12
  v_add_u32 v2, v11, v12
  v_add_u32 v10, 64, v0
  v_mul_u32_u24 v11, 43691, v10
  v_lshrrev_b32 v11, 19, v11
  v_mul_u32_u24 v12, 12, v11
  v_sub_u32 v12, v10, v12
  v_mul_u32_u24 v11, 1152, v11
  v_lshlrev_b32 v12, 4, v12
  v_add_u32 v3, v11, v12
  v_add_u32 v10, 128, v0
  v_mul_u32_u24 v11, 43691, v10
  v_lshrrev_b32 v11, 19, v11
  v_mul_u32_u24 v12, 12, v11
  v_sub_u32 v12, v10, v12
  v_mul_u32_u24 v11, 1152, v11
  v_lshlrev_b32 v12, 4, v12
  v_add_u32 v4, v11, v12
  s_and_b32 s24, s20, 1
  s_lshl_b32 s24, s24, 11
  v_add_u32 v5, s24, v1
  v_lshrrev_b32 v10, 4, v0
  v_bfe_u32 v11, v0, 2, 2
  v_and_b32 v12, 3, v0
  v_lshlrev_b32 v10, 2, v10
  v_add_u32 v10, v10, v11
  v_mul_u32_u24 v10, 192, v10
  v_lshlrev_b32 v12, 3, v12
  v_add_u32 v10, v10, v12
  s_lshr_b32 s24, s20, 1
  s_mul_i32 s24, s24, 96
  s_add_u32 s24, s24, 16384
  v_add_u32 v6, s24, v10
  v_and_b32 v10, 15, v0
  v_mul_u32_u24 v10, 2304, v10
  v_lshrrev_b32 v11, 4, v0
  v_lshlrev_b32 v11, 3, v11
  v_add_u32 v7, v10, v11
  s_load_dwordx2 s[44:45], s[70:71], 88
  s_waitcnt lgkmcnt(0)
  s_mov_b32 s46, 256
  s_mov_b32 s47, 0x00020000
  s_mov_b32 s48, 64
  s_mov_b32 s49, 0
  s_mov_b32 s50, 0
W4I_40:
  s_mov_b64 exec, 1
  buffer_load_dword v10, off, s[44:47], s48 sc1
  s_mov_b64 exec, -1
  s_waitcnt vmcnt(0)
  v_readfirstlane_b32 s51, v10
  s_lshr_b32 s51, s51, s49
  s_and_b32 s51, s51, 63
  s_add_u32 s50, s50, 1
  s_cmp_ge_u32 s50, 1000000
  s_cbranch_scc1 W4I_40x
  s_cmp_ge_u32 s51, 32
  s_cbranch_scc1 W4I_40x
  s_sleep 32
  s_branch W4I_40
W4I_40x:
  s_mov_b32 s21, s98
  s_sub_u32 s22, s96, 1
L_W4U:
  s_cmp_lt_u32 s21, 24
  s_cbranch_scc0 L_W4DONE
  s_lshl_b32 s48, s21, 7
  s_add_u32 s48, s48, 80486400
  s_mov_b32 s49, 0
  s_cmp_eq_u32 s20, 0
  s_cbranch_scc0 W4W_41x
  s_mov_b32 s50, 0
W4W_41:
  s_mov_b64 exec, 1
  buffer_load_dword v10, off, s[8:11], s48 sc1
  s_mov_b64 exec, -1
  s_waitcnt vmcnt(0)
  v_readfirstlane_b32 s51, v10
  s_lshr_b32 s51, s51, s49
  s_and_b32 s51, s51, 65535
  s_add_u32 s50, s50, 1
  s_cmp_ge_u32 s50, 1000000
  s_cbranch_scc1 W4W_41x
  s_cmp_ge_u32 s51, 16
  s_cbranch_scc1 W4W_41x
  s_sleep 32
  s_branch W4W_41
W4W_41x:
  s_barrier
  buffer_inv sc1
  s_waitcnt vmcnt(0)
  s_lshl_b32 s33, s21, 9
  s_add_u32 s33, s33, s20
  s_lshl_b32 s33, s33, 10
  s_add_u32 s33, s33, 50331648
  s_mul_i32 s34, s20, 36864
  s_mul_i32 s24, s22, 192
  s_add_u32 s34, s34, s24
  s_mov_b32 s32, 0
  s_barrier
  s_lshl_b32 s24, s20, 12
  s_add_u32 s24, s24, s32
  s_mov_b32 s25, s33
  s_add_u32 m0, s24, 0
  s_nop 0
  buffer_load_dwordx4 v1, s[8:11], s25 offen lds
  s_add_u32 s25, s25, 131072
  s_add_u32 m0, s24, 1024
  s_nop 0
  buffer_load_dwordx4 v1, s[8:11], s25 offen lds
  s_add_u32 s25, s25, 131072
  s_add_u32 m0, s24, 2048
  s_nop 0
  buffer_load_dwordx4 v1, s[8:11], s25 offen lds
  s_add_u32 s25, s25, 131072
  s_add_u32 m0, s24, 3072
  s_nop 0
  buffer_load_dwordx4 v1, s[8:11], s25 offen lds
  s_mul_i32 s24, s20, 6144
  s_add_u32 s24, s24, s32
  s_add_u32 s24, s24, 16384
  s_mov_b32 s25, s34
  s_add_u32 m0, s24, 0
  s_nop 0
  buffer_load_dwordx4 v2, s[12:15], s25 offen lds
  s_add_u32 m0, s24, 1024
  s_nop 0
  buffer_load_dwordx4 v3, s[12:15], s25 offen lds
  s_add_u32 m0, s24, 2048
  s_nop 0
  buffer_load_dwordx4 v4, s[12:15], s25 offen lds
  s_add_u32 s25, s25, 18432
  s_add_u32 m0, s24, 3072
  s_nop 0
  buffer_load_dwordx4 v2, s[12:15], s25 offen lds
  s_add_u32 m0, s24, 4096
  s_nop 0
  buffer_load_dwordx4 v3, s[12:15], s25 offen lds
  s_add_u32 m0, s24, 5120
  s_nop 0
  buffer_load_dwordx4 v4, s[12:15], s25 offen lds
  s_add_u32 s33, s33, 4096
  s_add_u32 s34, s34, 147456
  s_mov_b32 s32, 40960
  s_waitcnt vmcnt(0)
  s_barrier
  s_lshl_b32 s24, s20, 12
  s_add_u32 s24, s24, s32
  s_mov_b32 s25, s33
  s_add_u32 m0, s24, 0
  s_nop 0
  buffer_load_dwordx4 v1, s[8:11], s25 offen lds
  s_add_u32 s25, s25, 131072
  s_add_u32 m0, s24, 1024
  s_nop 0
  buffer_load_dwordx4 v1, s[8:11], s25 offen lds
  s_add_u32 s25, s25, 131072
  s_add_u32 m0, s24, 2048
  s_nop 0
  buffer_load_dwordx4 v1, s[8:11], s25 offen lds
  s_add_u32 s25, s25, 131072
  s_add_u32 m0, s24, 3072
  s_nop 0
  buffer_load_dwordx4 v1, s[8:11], s25 offen lds
  s_mul_i32 s24, s20, 6144
  s_add_u32 s24, s24, s32
  s_add_u32 s24, s24, 16384
  s_mov_b32 s25, s34
  s_add_u32 m0, s24, 0
  s_nop 0
  buffer_load_dwordx4 v2, s[12:15], s25 offen lds
  s_add_u32 m0, s24, 1024
  s_nop 0
  buffer_load_dwordx4 v3, s[12:15], s25 offen lds
  s_add_u32 m0, s24, 2048
  s_nop 0
  buffer_load_dwordx4 v4, s[12:15], s25 offen lds
  s_add_u32 s25, s25, 18432
  s_add_u32 m0, s24, 3072
  s_nop 0
  buffer_load_dwordx4 v2, s[12:15], s25 offen lds
  s_add_u32 m0, s24, 4096
  s_nop 0
  buffer_load_dwordx4 v3, s[12:15], s25 offen lds
  s_add_u32 m0, s24, 5120
  s_nop 0
  buffer_load_dwordx4 v4, s[12:15], s25 offen lds
  s_add_u32 s33, s33, 4096
  s_add_u32 s34, s34, 147456
  ds_read_b128 v[48:51], v5 offset:0
  ds_read_b128 v[52:55], v5 offset:1024
  ds_read_b64_tr_b16 v[56:57], v6 offset:0
  ds_read_b64_tr_b16 v[58:59], v6 offset:3072
  ds_read_b64_tr_b16 v[60:61], v6 offset:32
  ds_read_b64_tr_b16 v[62:63], v6 offset:3104
  ds_read_b64_tr_b16 v[64:65], v6 offset:64
  ds_read_b64_tr_b16 v[66:67], v6 offset:3136
  s_waitcnt lgkmcnt(4)
  v_mfma_f32_16x16x32_bf16 v[16:19], v[56:59], v[48:51], 0
  ds_read_b128 v[68:71], v5 offset:4096
  ds_read_b128 v[72:75], v5 offset:5120
  s_waitcnt lgkmcnt(4)
  v_mfma_f32_16x16x32_bf16 v[20:23], v[60:63], v[48:51], 0
  ds_read_b64_tr_b16 v[76:77], v6 offset:6144
  ds_read_b64_tr_b16 v[78:79], v6 offset:9216
  s_waitcnt lgkmcnt(4)
  v_mfma_f32_16x16x32_bf16 v[24:27], v[64:67], v[48:51], 0
  ds_read_b64_tr_b16 v[80:81], v6 offset:6176
  ds_read_b64_tr_b16 v[82:83], v6 offset:9248
  v_mfma_f32_16x16x32_bf16 v[28:31], v[56:59], v[52:55], 0
  ds_read_b64_tr_b16 v[84:85], v6 offset:6208
  ds_read_b64_tr_b16 v[86:87], v6 offset:9280
  v_mfma_f32_16x16x32_bf16 v[32:35], v[60:63], v[52:55], 0
  v_mfma_f32_16x16x32_bf16 v[36:39], v[64:67], v[52:55], 0
  s_waitcnt lgkmcnt(4)
  v_mfma_f32_16x16x32_bf16 v[16:19], v[76:79], v[68:71], v[16:19]
  ds_read_b128 v[48:51], v5 offset:8192
  ds_read_b128 v[52:55], v5 offset:9216
  s_waitcnt lgkmcnt(4)
  v_mfma_f32_16x16x32_bf16 v[20:23], v[80:83], v[68:71], v[20:23]
  ds_read_b64_tr_b16 v[56:57], v6 offset:12288
  ds_read_b64_tr_b16 v[58:59], v6 offset:15360
  s_waitcnt lgkmcnt(4)
  v_mfma_f32_16x16x32_bf16 v[24:27], v[84:87], v[68:71], v[24:27]
  ds_read_b64_tr_b16 v[60:61], v6 offset:12320
  ds_read_b64_tr_b16 v[62:63], v6 offset:15392
  v_mfma_f32_16x16x32_bf16 v[28:31], v[76:79], v[72:75], v[28:31]
  ds_read_b64_tr_b16 v[64:65], v6 offset:12352
  ds_read_b64_tr_b16 v[66:67], v6 offset:15424
  v_mfma_f32_16x16x32_bf16 v[32:35], v[80:83], v[72:75], v[32:35]
  v_mfma_f32_16x16x32_bf16 v[36:39], v[84:87], v[72:75], v[36:39]
  s_waitcnt lgkmcnt(4)
  v_mfma_f32_16x16x32_bf16 v[16:19], v[56:59], v[48:51], v[16:19]
  ds_read_b128 v[68:71], v5 offset:12288
  ds_read_b128 v[72:75], v5 offset:13312
  s_waitcnt lgkmcnt(4)
  v_mfma_f32_16x16x32_bf16 v[20:23], v[60:63], v[48:51], v[20:23]
  ds_read_b64_tr_b16 v[76:77], v6 offset:18432
  ds_read_b64_tr_b16 v[78:79], v6 offset:21504
  s_waitcnt lgkmcnt(4)
  v_mfma_f32_16x16x32_bf16 v[24:27], v[64:67], v[48:51], v[24:27]
  ds_read_b64_tr_b16 v[80:81], v6 offset:18464
  ds_read_b64_tr_b16 v[82:83], v6 offset:21536
  v_mfma_f32_16x16x32_bf16 v[28:31], v[56:59], v[52:55], v[28:31]
  ds_read_b64_tr_b16 v[84:85], v6 offset:18496
  ds_read_b64_tr_b16 v[86:87], v6 offset:21568
  v_mfma_f32_16x16x32_bf16 v[32:35], v[60:63], v[52:55], v[32:35]
  v_mfma_f32_16x16x32_bf16 v[36:39], v[64:67], v[52:55], v[36:39]
  s_waitcnt lgkmcnt(4)
  v_mfma_f32_16x16x32_bf16 v[16:19], v[76:79], v[68:71], v[16:19]
  s_waitcnt lgkmcnt(2)
  v_mfma_f32_16x16x32_bf16 v[20:23], v[80:83], v[68:71], v[20:23]
  s_waitcnt lgkmcnt(0)
  v_mfma_f32_16x16x32_bf16 v[24:27], v[84:87], v[68:71], v[24:27]
  v_mfma_f32_16x16x32_bf16 v[28:31], v[76:79], v[72:75], v[28:31]
  v_mfma_f32_16x16x32_bf16 v[32:35], v[80:83], v[72:75], v[32:35]
  v_mfma_f32_16x16x32_bf16 v[36:39], v[84:87], v[72:75], v[36:39]
  s_mov_b32 s35, 1
  s_mov_b32 s36, 40960
W4_KL:
  v_add_u32 v5, s36, v5
  v_add_u32 v6, s36, v6
  s_sub_u32 s36, 0, s36
  s_sub_u32 s32, 40960, s32
  s_waitcnt vmcnt(0) lgkmcnt(0)
  s_barrier
  s_cmp_lt_u32 s35, 31
  s_cbranch_scc0 W4_NODMA
  s_lshl_b32 s24, s20, 12
  s_add_u32 s24, s24, s32
  s_mov_b32 s25, s33
  s_add_u32 m0, s24, 0
  s_nop 0
  buffer_load_dwordx4 v1, s[8:11], s25 offen lds
  s_add_u32 s25, s25, 131072
  s_add_u32 m0, s24, 1024
  s_nop 0
  buffer_load_dwordx4 v1, s[8:11], s25 offen lds
  s_add_u32 s25, s25, 131072
  s_add_u32 m0, s24, 2048
  s_nop 0
  buffer_load_dwordx4 v1, s[8:11], s25 offen lds
  s_add_u32 s25, s25, 131072
  s_add_u32 m0, s24, 3072
  s_nop 0
  buffer_load_dwordx4 v1, s[8:11], s25 offen lds
  s_mul_i32 s24, s20, 6144
  s_add_u32 s24, s24, s32
  s_add_u32 s24, s24, 16384
  s_mov_b32 s25, s34
  s_add_u32 m0, s24, 0
  s_nop 0
  buffer_load_dwordx4 v2, s[12:15], s25 offen lds
  s_add_u32 m0, s24, 1024
  s_nop 0
  buffer_load_dwordx4 v3, s[12:15], s25 offen lds
  s_add_u32 m0, s24, 2048
  s_nop 0
  buffer_load_dwordx4 v4, s[12:15], s25 offen lds
  s_add_u32 s25, s25, 18432
  s_add_u32 m0, s24, 3072
  s_nop 0
  buffer_load_dwordx4 v2, s[12:15], s25 offen lds
  s_add_u32 m0, s24, 4096
  s_nop 0
  buffer_load_dwordx4 v3, s[12:15], s25 offen lds
  s_add_u32 m0, s24, 5120
  s_nop 0
  buffer_load_dwordx4 v4, s[12:15], s25 offen lds
  s_add_u32 s33, s33, 4096
  s_add_u32 s34, s34, 147456
W4_NODMA:
  ds_read_b128 v[48:51], v5 offset:0
  ds_read_b128 v[52:55], v5 offset:1024
  ds_read_b64_tr_b16 v[56:57], v6 offset:0
  ds_read_b64_tr_b16 v[58:59], v6 offset:3072
  ds_read_b64_tr_b16 v[60:61], v6 offset:32
  ds_read_b64_tr_b16 v[62:63], v6 offset:3104
  ds_read_b64_tr_b16 v[64:65], v6 offset:64
  ds_read_b64_tr_b16 v[66:67], v6 offset:3136
  s_waitcnt lgkmcnt(4)
  v_mfma_f32_16x16x32_bf16 v[16:19], v[56:59], v[48:51], v[16:19]
  ds_read_b128 v[68:71], v5 offset:4096
  ds_read_b128 v[72:75], v5 offset:5120
  s_waitcnt lgkmcnt(4)
  v_mfma_f32_16x16x32_bf16 v[20:23], v[60:63], v[48:51], v[20:23]
  ds_read_b64_tr_b16 v[76:77], v6 offset:6144
  ds_read_b64_tr_b16 v[78:79], v6 offset:9216
  s_waitcnt lgkmcnt(4)
  v_mfma_f32_16x16x32_bf16 v[24:27], v[64:67], v[48:51], v[24:27]
  ds_read_b64_tr_b16 v[80:81], v6 offset:6176
  ds_read_b64_tr_b16 v[82:83], v6 offset:9248
  v_mfma_f32_16x16x32_bf16 v[28:31], v[56:59], v[52:55], v[28:31]
  ds_read_b64_tr_b16 v[84:85], v6 offset:6208
  ds_read_b64_tr_b16 v[86:87], v6 offset:9280
  v_mfma_f32_16x16x32_bf16 v[32:35], v[60:63], v[52:55], v[32:35]
  v_mfma_f32_16x16x32_bf16 v[36:39], v[64:67], v[52:55], v[36:39]
  s_waitcnt lgkmcnt(4)
  v_mfma_f32_16x16x32_bf16 v[16:19], v[76:79], v[68:71], v[16:19]
  ds_read_b128 v[48:51], v5 offset:8192
  ds_read_b128 v[52:55], v5 offset:9216
  s_waitcnt lgkmcnt(4)
  v_mfma_f32_16x16x32_bf16 v[20:23], v[80:83], v[68:71], v[20:23]
  ds_read_b64_tr_b16 v[56:57], v6 offset:12288
  ds_read_b64_tr_b16 v[58:59], v6 offset:15360
  s_waitcnt lgkmcnt(4)
  v_mfma_f32_16x16x32_bf16 v[24:27], v[84:87], v[68:71], v[24:27]
  ds_read_b64_tr_b16 v[60:61], v6 offset:12320
  ds_read_b64_tr_b16 v[62:63], v6 offset:15392
  v_mfma_f32_16x16x32_bf16 v[28:31], v[76:79], v[72:75], v[28:31]
  ds_read_b64_tr_b16 v[64:65], v6 offset:12352
  ds_read_b64_tr_b16 v[66:67], v6 offset:15424
  v_mfma_f32_16x16x32_bf16 v[32:35], v[80:83], v[72:75], v[32:35]
  v_mfma_f32_16x16x32_bf16 v[36:39], v[84:87], v[72:75], v[36:39]
  s_waitcnt lgkmcnt(4)
  v_mfma_f32_16x16x32_bf16 v[16:19], v[56:59], v[48:51], v[16:19]
  ds_read_b128 v[68:71], v5 offset:12288
  ds_read_b128 v[72:75], v5 offset:13312
  s_waitcnt lgkmcnt(4)
  v_mfma_f32_16x16x32_bf16 v[20:23], v[60:63], v[48:51], v[20:23]
  ds_read_b64_tr_b16 v[76:77], v6 offset:18432
  ds_read_b64_tr_b16 v[78:79], v6 offset:21504
  s_waitcnt lgkmcnt(4)
  v_mfma_f32_16x16x32_bf16 v[24:27], v[64:67], v[48:51], v[24:27]
  ds_read_b64_tr_b16 v[80:81], v6 offset:18464
  ds_read_b64_tr_b16 v[82:83], v6 offset:21536
  v_mfma_f32_16x16x32_bf16 v[28:31], v[56:59], v[52:55], v[28:31]
  ds_read_b64_tr_b16 v[84:85], v6 offset:18496
  ds_read_b64_tr_b16 v[86:87], v6 offset:21568
  v_mfma_f32_16x16x32_bf16 v[32:35], v[60:63], v[52:55], v[32:35]
  v_mfma_f32_16x16x32_bf16 v[36:39], v[64:67], v[52:55], v[36:39]
  s_waitcnt lgkmcnt(4)
  v_mfma_f32_16x16x32_bf16 v[16:19], v[76:79], v[68:71], v[16:19]
  s_waitcnt lgkmcnt(2)
  v_mfma_f32_16x16x32_bf16 v[20:23], v[80:83], v[68:71], v[20:23]
  s_waitcnt lgkmcnt(0)
  v_mfma_f32_16x16x32_bf16 v[24:27], v[84:87], v[68:71], v[24:27]
  v_mfma_f32_16x16x32_bf16 v[28:31], v[76:79], v[72:75], v[28:31]
  v_mfma_f32_16x16x32_bf16 v[32:35], v[80:83], v[72:75], v[32:35]
  v_mfma_f32_16x16x32_bf16 v[36:39], v[84:87], v[72:75], v[36:39]
  s_add_u32 s35, s35, 1
  s_cmp_lt_u32 s35, 32
  s_cbranch_scc1 W4_KL
  v_subrev_u32 v5, 40960, v5
  v_subrev_u32 v6, 40960, v6
  s_lshl_b32 s24, s21, 6
  s_and_b32 s25, s20, 1
  s_lshl_b32 s25, s25, 5
  s_add_u32 s24, s24, s25
  s_mul_i32 s24, s24, 2304
  s_mul_i32 s25, s22, 192
  s_add_u32 s24, s24, s25
  s_lshr_b32 s25, s20, 1
  s_mul_i32 s25, s25, 96
  s_add_u32 s24, s24, s25
  v_cvt_pk_bf16_f32 v16, v16, v17
  v_cvt_pk_bf16_f32 v17, v18, v19
  buffer_store_dwordx2 v[16:17], v7, s[16:19], s24 offen offset:0
  v_cvt_pk_bf16_f32 v20, v20, v21
  v_cvt_pk_bf16_f32 v21, v22, v23
  buffer_store_dwordx2 v[20:21], v7, s[16:19], s24 offen offset:32
  v_cvt_pk_bf16_f32 v24, v24, v25
  v_cvt_pk_bf16_f32 v25, v26, v27
  buffer_store_dwordx2 v[24:25], v7, s[16:19], s24 offen offset:64
  s_add_u32 s24, s24, 36864
  v_cvt_pk_bf16_f32 v28, v28, v29
  v_cvt_pk_bf16_f32 v29, v30, v31
  buffer_store_dwordx2 v[28:29], v7, s[16:19], s24 offen offset:0
  v_cvt_pk_bf16_f32 v32, v32, v33
  v_cvt_pk_bf16_f32 v33, v34, v35
  buffer_store_dwordx2 v[32:33], v7, s[16:19], s24 offen offset:32
  v_cvt_pk_bf16_f32 v36, v36, v37
  v_cvt_pk_bf16_f32 v37, v38, v39
  buffer_store_dwordx2 v[36:37], v7, s[16:19], s24 offen offset:64
  s_add_u32 s21, s21, 16
  s_branch L_W4U
L_W4DONE:
  s_cmp_ge_u32 s98, 8
  s_cbranch_scc0 L_END
  s_sub_u32 s99, s96, 1
  s_lshl_b32 s99, s99, 3
  s_add_u32 s99, s99, s98
  s_sub_u32 s99, s99, 8
L_SPL:
  v_mbcnt_lo_u32_b32 v0, -1, 0
  v_mbcnt_hi_u32_b32 v0, -1, v0
  s_lshl_b32 s95, s97, 6
  v_add_u32 v0, s95, v0
  s_load_dwordx2 s[8:9], s[70:71], 96
  s_load_dwordx2 s[12:13], s[70:71], 40
  s_load_dwordx2 s[16:17], s[70:71], 80
  s_waitcnt lgkmcnt(0)
  s_mov_b32 s10, 268435456
  s_mov_b32 s11, 0x00020000
  s_mov_b32 s14, 4718592
  s_mov_b32 s15, 0x00020000
  s_mov_b32 s18, 4718592
  s_mov_b32 s19, 0x00020000
  v_lshrrev_b32 v10, 6, v0
  s_nop 0
  v_readfirstlane_b32 s20, v10
  v_and_b32 v0, 63, v0
  v_lshlrev_b32 v1, 4, v0
  v_add_u32 v10, 0, v0
  v_mul_u32_u24 v11, 43691, v10
  v_lshrrev_b32 v11, 19, v11
  v_mul_u32_u24 v12, 12, v11
  v_sub_u32 v12, v10, v12
  v_mul_u32_u24 v11, 1152, v11
  v_lshlrev_b32 v12, 4, v12
  v_add_u32 v2, v11, v12
  v_add_u32 v10, 64, v0
  v_mul_u32_u24 v11, 43691, v10
  v_lshrrev_b32 v11, 19, v11
  v_mul_u32_u24 v12, 12, v11
  v_sub_u32 v12, v10, v12
  v_mul_u32_u24 v11, 1152, v11
  v_lshlrev_b32 v12, 4, v12
  v_add_u32 v3, v11, v12
  v_add_u32 v10, 128, v0
  v_mul_u32_u24 v11, 43691, v10
  v_lshrrev_b32 v11, 19, v11
  v_mul_u32_u24 v12, 12, v11
  v_sub_u32 v12, v10, v12
  v_mul_u32_u24 v11, 1152, v11
  v_lshlrev_b32 v12, 4, v12
  v_add_u32 v4, v11, v12
  s_and_b32 s24, s20, 1
  s_lshl_b32 s24, s24, 11
  v_add_u32 v5, s24, v1
  v_lshrrev_b32 v10, 4, v0
  v_bfe_u32 v11, v0, 2, 2
  v_and_b32 v12, 3, v0
  v_lshlrev_b32 v10, 2, v10
  v_add_u32 v10, v10, v11
  v_mul_u32_u24 v10, 192, v10
  v_lshlrev_b32 v12, 3, v12
  v_add_u32 v10, v10, v12
  s_lshr_b32 s24, s20, 1
  s_mul_i32 s24, s24, 96
  s_add_u32 s24, s24, 16384
  v_add_u32 v6, s24, v10
  v_and_b32 v10, 15, v0
  v_mul_u32_u24 v10, 2304, v10
  v_lshrrev_b32 v11, 4, v0
  v_lshlrev_b32 v11, 3, v11
  v_add_u32 v7, v10, v11
  s_load_dwordx2 s[44:45], s[70:71], 88
  s_waitcnt lgkmcnt(0)
  s_mov_b32 s46, 256
  s_mov_b32 s47, 0x00020000
  s_mov_b32 s48, 64
  s_mov_b32 s49, 0
  s_mov_b32 s50, 0
SPI_42:
  s_mov_b64 exec, 1
  buffer_load_dword v10, off, s[44:47], s48 sc1
  s_mov_b64 exec, -1
  s_waitcnt vmcnt(0)
  v_readfirstlane_b32 s51, v10
  s_lshr_b32 s51, s51, s49
  s_and_b32 s51, s51, 63
  s_add_u32 s50, s50, 1
  s_cmp_ge_u32 s50, 1000000
  s_cbranch_scc1 SPI_42x
  s_cmp_ge_u32 s51, 32
  s_cbranch_scc1 SPI_42x
  s_sleep 32
  s_branch SPI_42
SPI_42x:
  s_mov_b32 s48, 80
  s_mov_b32 s49, 0
  s_mov_b32 s50, 0
SPJ_43:
  s_mov_b64 exec, 1
  buffer_load_dword v10, off, s[44:47], s48 sc1
  s_mov_b64 exec, -1
  s_waitcnt vmcnt(0)
  v_readfirstlane_b32 s51, v10
  s_lshr_b32 s51, s51, s49
  s_and_b32 s51, s51, 65535
  s_add_u32 s50, s50, 1
  s_cmp_ge_u32 s50, 1000000
  s_cbranch_scc1 SPJ_43x
  s_cmp_ge_u32 s51, 192
  s_cbranch_scc1 SPJ_43x
  s_sleep 32
  s_branch SPJ_43
SPJ_43x:
L_SPU:
  s_cmp_lt_u32 s99, 384
  s_cbranch_scc0 L_END
  s_mul_i32 s48, s99, 1366
  s_lshr_b32 s48, s48, 16
  s_mul_i32 s49, s48, 48
  s_sub_u32 s49, s99, s49
  s_lshr_b32 s22, s49, 3
  s_and_b32 s41, s49, 7
  s_mul_i32 s42, s48, 6
  s_add_u32 s42, s42, s22
  s_add_u32 s21, s48, 24
  s_lshl_b32 s33, s21, 9
  s_add_u32 s33, s33, s20
  s_lshl_b32 s33, s33, 10
  s_add_u32 s33, s33, 50331648
  s_mul_i32 s24, s41, 16384
  s_add_u32 s33, s33, s24
  s_mul_i32 s34, s20, 36864
  s_mul_i32 s24, s22, 192
  s_add_u32 s34, s34, s24
  s_mul_i32 s24, s41, 589824
  s_add_u32 s34, s34, s24
  s_barrier
  s_mul_i32 s24, s20, 6144
  s_add_u32 s24, s24, 16384
  s_mov_b32 s25, s34
  s_add_u32 m0, s24, 0
  s_nop 0
  buffer_load_dwordx4 v2, s[12:15], s25 offen lds
  s_add_u32 m0, s24, 1024
  s_nop 0
  buffer_load_dwordx4 v3, s[12:15], s25 offen lds
  s_add_u32 m0, s24, 2048
  s_nop 0
  buffer_load_dwordx4 v4, s[12:15], s25 offen lds
  s_add_u32 s25, s25, 18432
  s_add_u32 m0, s24, 3072
  s_nop 0
  buffer_load_dwordx4 v2, s[12:15], s25 offen lds
  s_add_u32 m0, s24, 4096
  s_nop 0
  buffer_load_dwordx4 v3, s[12:15], s25 offen lds
  s_add_u32 m0, s24, 5120
  s_nop 0
  buffer_load_dwordx4 v4, s[12:15], s25 offen lds
  s_add_u32 s34, s34, 147456
  s_mov_b32 s25, s34
  s_add_u32 m0, s24, 40960
  s_nop 0
  buffer_load_dwordx4 v2, s[12:15], s25 offen lds
  s_add_u32 m0, s24, 41984
  s_nop 0
  buffer_load_dwordx4 v3, s[12:15], s25 offen lds
  s_add_u32 m0, s24, 43008
  s_nop 0
  buffer_load_dwordx4 v4, s[12:15], s25 offen lds
  s_add_u32 s25, s25, 18432
  s_add_u32 m0, s24, 44032
  s_nop 0
  buffer_load_dwordx4 v2, s[12:15], s25 offen lds
  s_add_u32 m0, s24, 45056
  s_nop 0
  buffer_load_dwordx4 v3, s[12:15], s25 offen lds
  s_add_u32 m0, s24, 46080
  s_nop 0
  buffer_load_dwordx4 v4, s[12:15], s25 offen lds
  s_add_u32 s34, s34, 147456
  s_mov_b32 s25, s34
  s_add_u32 m0, s24, 81920
  s_nop 0
  buffer_load_dwordx4 v2, s[12:15], s25 offen lds
  s_add_u32 m0, s24, 82944
  s_nop 0
  buffer_load_dwordx4 v3, s[12:15], s25 offen lds
  s_add_u32 m0, s24, 83968
  s_nop 0
  buffer_load_dwordx4 v4, s[12:15], s25 offen lds
  s_add_u32 s25, s25, 18432
  s_add_u32 m0, s24, 84992
  s_nop 0
  buffer_load_dwordx4 v2, s[12:15], s25 offen lds
  s_add_u32 m0, s24, 86016
  s_nop 0
  buffer_load_dwordx4 v3, s[12:15], s25 offen lds
  s_add_u32 m0, s24, 87040
  s_nop 0
  buffer_load_dwordx4 v4, s[12:15], s25 offen lds
  s_add_u32 s34, s34, 147456
  s_mov_b32 s25, s34
  s_add_u32 m0, s24, 122880
  s_nop 0
  buffer_load_dwordx4 v2, s[12:15], s25 offen lds
  s_add_u32 m0, s24, 123904
  s_nop 0
  buffer_load_dwordx4 v3, s[12:15], s25 offen lds
  s_add_u32 m0, s24, 124928
  s_nop 0
  buffer_load_dwordx4 v4, s[12:15], s25 offen lds
  s_add_u32 s25, s25, 18432
  s_add_u32 m0, s24, 125952
  s_nop 0
  buffer_load_dwordx4 v2, s[12:15], s25 offen lds
  s_add_u32 m0, s24, 126976
  s_nop 0
  buffer_load_dwordx4 v3, s[12:15], s25 offen lds
  s_add_u32 m0, s24, 128000
  s_nop 0
  buffer_load_dwordx4 v4, s[12:15], s25 offen lds
  s_add_u32 s34, s34, 147456
  s_lshl_b32 s48, s21, 7
  s_add_u32 s48, s48, 80486400
  s_mov_b32 s49, 0
  s_cmp_ge_u32 s21, 30
  s_cbranch_scc1 SPL_44
  s_cmp_eq_u32 s20, 0
  s_cbranch_scc0 SPW_45x
  s_mov_b32 s50, 0
SPW_45:
  s_mov_b64 exec, 1
  buffer_load_dword v10, off, s[8:11], s48 sc1
  s_mov_b64 exec, -1
  s_waitcnt vmcnt(0)
  v_readfirstlane_b32 s51, v10
  s_lshr_b32 s51, s51, s49
  s_and_b32 s51, s51, 65535
  s_add_u32 s50, s50, 1
  s_cmp_ge_u32 s50, 1000000
  s_cbranch_scc1 SPW_45x
  s_cmp_ge_u32 s51, 16
  s_cbranch_scc1 SPW_45x
  s_sleep 48
  s_branch SPW_45
SPW_45x:
  s_barrier
  s_branch SPL_44x
SPL_44:
  s_cmp_eq_u32 s20, 0
  s_cbranch_scc0 SPV_46x
  s_mov_b32 s50, 0
SPV_46:
  s_mov_b64 exec, 1
  buffer_load_dword v10, off, s[8:11], s48 sc1
  s_mov_b64 exec, -1
  s_waitcnt vmcnt(0)
  v_readfirstlane_b32 s51, v10
  s_lshr_b32 s51, s51, s49
  s_and_b32 s51, s51, 65535
  s_add_u32 s50, s50, 1
  s_cmp_ge_u32 s50, 1000000
  s_cbranch_scc1 SPV_46x
  s_cmp_ge_u32 s51, 16
  s_cbranch_scc1 SPV_46x
  s_sleep 4
  s_branch SPV_46
SPV_46x:
  s_barrier
SPL_44x:
  s_lshl_b32 s24, s20, 12
  v_add_u32 v12, s24, v1
  s_mov_b32 s25, s33
  buffer_load_dwordx4 v[128:131], v1, s[8:11], s25 offen sc1
  s_add_u32 s25, s25, 131072
  buffer_load_dwordx4 v[132:135], v1, s[8:11], s25 offen sc1
  s_add_u32 s25, s25, 131072
  buffer_load_dwordx4 v[136:139], v1, s[8:11], s25 offen sc1
  s_add_u32 s25, s25, 131072
  buffer_load_dwordx4 v[140:143], v1, s[8:11], s25 offen sc1
  s_add_u32 s33, s33, 4096
  s_mov_b32 s25, s33
  buffer_load_dwordx4 v[144:147], v1, s[8:11], s25 offen sc1
  s_add_u32 s25, s25, 131072
  buffer_load_dwordx4 v[148:151], v1, s[8:11], s25 offen sc1
  s_add_u32 s25, s25, 131072
  buffer_load_dwordx4 v[152:155], v1, s[8:11], s25 offen sc1
  s_add_u32 s25, s25, 131072
  buffer_load_dwordx4 v[156:159], v1, s[8:11], s25 offen sc1
  s_add_u32 s33, s33, 4096
  s_mov_b32 s25, s33
  buffer_load_dwordx4 v[160:163], v1, s[8:11], s25 offen sc1
  s_add_u32 s25, s25, 131072
  buffer_load_dwordx4 v[164:167], v1, s[8:11], s25 offen sc1
  s_add_u32 s25, s25, 131072
  buffer_load_dwordx4 v[168:171], v1, s[8:11], s25 offen sc1
  s_add_u32 s25, s25, 131072
  buffer_load_dwordx4 v[172:175], v1, s[8:11], s25 offen sc1
  s_add_u32 s33, s33, 4096
  s_mov_b32 s25, s33
  buffer_load_dwordx4 v[176:179], v1, s[8:11], s25 offen sc1
  s_add_u32 s25, s25, 131072
  buffer_load_dwordx4 v[180:183], v1, s[8:11], s25 offen sc1
  s_add_u32 s25, s25, 131072
  buffer_load_dwordx4 v[184:187], v1, s[8:11], s25 offen sc1
  s_add_u32 s25, s25, 131072
  buffer_load_dwordx4 v[188:191], v1, s[8:11], s25 offen sc1
  s_add_u32 s33, s33, 4096
  s_waitcnt vmcnt(15)
  ds_write_b128 v12, v[128:131] offset:0
  s_waitcnt vmcnt(14)
  ds_write_b128 v12, v[132:135] offset:1024
  s_waitcnt vmcnt(13)
  ds_write_b128 v12, v[136:139] offset:2048
  s_waitcnt vmcnt(12)
  ds_write_b128 v12, v[140:143] offset:3072
  s_waitcnt lgkmcnt(0)
  s_barrier
  ds_read_b128 v[48:51], v5 offset:0
  ds_read_b128 v[52:55], v5 offset:1024
  ds_read_b64_tr_b16 v[56:57], v6 offset:0
  ds_read_b64_tr_b16 v[58:59], v6 offset:3072
  ds_read_b64_tr_b16 v[60:61], v6 offset:32
  ds_read_b64_tr_b16 v[62:63], v6 offset:3104
  ds_read_b64_tr_b16 v[64:65], v6 offset:64
  ds_read_b64_tr_b16 v[66:67], v6 offset:3136
  s_waitcnt lgkmcnt(4)
  v_mfma_f32_16x16x32_bf16 v[16:19], v[56:59], v[48:51], 0
  ds_read_b128 v[68:71], v5 offset:4096
  ds_read_b128 v[72:75], v5 offset:5120
  s_waitcnt lgkmcnt(4)
  v_mfma_f32_16x16x32_bf16 v[20:23], v[60:63], v[48:51], 0
  ds_read_b64_tr_b16 v[76:77], v6 offset:6144
  ds_read_b64_tr_b16 v[78:79], v6 offset:9216
  s_waitcnt lgkmcnt(4)
  v_mfma_f32_16x16x32_bf16 v[24:27], v[64:67], v[48:51], 0
  ds_read_b64_tr_b16 v[80:81], v6 offset:6176
  ds_read_b64_tr_b16 v[82:83], v6 offset:9248
  v_mfma_f32_16x16x32_bf16 v[28:31], v[56:59], v[52:55], 0
  ds_read_b64_tr_b16 v[84:85], v6 offset:6208
  ds_read_b64_tr_b16 v[86:87], v6 offset:9280
  v_mfma_f32_16x16x32_bf16 v[32:35], v[60:63], v[52:55], 0
  v_mfma_f32_16x16x32_bf16 v[36:39], v[64:67], v[52:55], 0
  s_waitcnt lgkmcnt(4)
  v_mfma_f32_16x16x32_bf16 v[16:19], v[76:79], v[68:71], v[16:19]
  ds_read_b128 v[48:51], v5 offset:8192
  ds_read_b128 v[52:55], v5 offset:9216
  s_waitcnt lgkmcnt(4)
  v_mfma_f32_16x16x32_bf16 v[20:23], v[80:83], v[68:71], v[20:23]
  ds_read_b64_tr_b16 v[56:57], v6 offset:12288
  ds_read_b64_tr_b16 v[58:59], v6 offset:15360
  s_waitcnt lgkmcnt(4)
  v_mfma_f32_16x16x32_bf16 v[24:27], v[84:87], v[68:71], v[24:27]
  ds_read_b64_tr_b16 v[60:61], v6 offset:12320
  ds_read_b64_tr_b16 v[62:63], v6 offset:15392
  v_mfma_f32_16x16x32_bf16 v[28:31], v[76:79], v[72:75], v[28:31]
  ds_read_b64_tr_b16 v[64:65], v6 offset:12352
  ds_read_b64_tr_b16 v[66:67], v6 offset:15424
  v_mfma_f32_16x16x32_bf16 v[32:35], v[80:83], v[72:75], v[32:35]
  v_mfma_f32_16x16x32_bf16 v[36:39], v[84:87], v[72:75], v[36:39]
  s_waitcnt lgkmcnt(4)
  v_mfma_f32_16x16x32_bf16 v[16:19], v[56:59], v[48:51], v[16:19]
  ds_read_b128 v[68:71], v5 offset:12288
  ds_read_b128 v[72:75], v5 offset:13312
  s_waitcnt lgkmcnt(4)
  v_mfma_f32_16x16x32_bf16 v[20:23], v[60:63], v[48:51], v[20:23]
  ds_read_b64_tr_b16 v[76:77], v6 offset:18432
  ds_read_b64_tr_b16 v[78:79], v6 offset:21504
  s_waitcnt lgkmcnt(4)
  v_mfma_f32_16x16x32_bf16 v[24:27], v[64:67], v[48:51], v[24:27]
  ds_read_b64_tr_b16 v[80:81], v6 offset:18464
  ds_read_b64_tr_b16 v[82:83], v6 offset:21536
  v_mfma_f32_16x16x32_bf16 v[28:31], v[56:59], v[52:55], v[28:31]
  ds_read_b64_tr_b16 v[84:85], v6 offset:18496
  ds_read_b64_tr_b16 v[86:87], v6 offset:21568
  v_mfma_f32_16x16x32_bf16 v[32:35], v[60:63], v[52:55], v[32:35]
  v_mfma_f32_16x16x32_bf16 v[36:39], v[64:67], v[52:55], v[36:39]
  s_waitcnt lgkmcnt(4)
  v_mfma_f32_16x16x32_bf16 v[16:19], v[76:79], v[68:71], v[16:19]
  s_waitcnt lgkmcnt(2)
  v_mfma_f32_16x16x32_bf16 v[20:23], v[80:83], v[68:71], v[20:23]
  s_waitcnt lgkmcnt(0)
  v_mfma_f32_16x16x32_bf16 v[24:27], v[84:87], v[68:71], v[24:27]
  v_mfma_f32_16x16x32_bf16 v[28:31], v[76:79], v[72:75], v[28:31]
  v_mfma_f32_16x16x32_bf16 v[32:35], v[80:83], v[72:75], v[32:35]
  v_mfma_f32_16x16x32_bf16 v[36:39], v[84:87], v[72:75], v[36:39]
  v_add_u32 v5, 40960, v5
  v_add_u32 v6, 40960, v6
  v_add_u32 v12, 40960, v12
  s_waitcnt vmcnt(11)
  ds_write_b128 v12, v[144:147] offset:0
  s_waitcnt vmcnt(10)
  ds_write_b128 v12, v[148:151] offset:1024
  s_waitcnt vmcnt(9)
  ds_write_b128 v12, v[152:155] offset:2048
  s_waitcnt vmcnt(8)
  ds_write_b128 v12, v[156:159] offset:3072
  s_waitcnt lgkmcnt(0)
  s_barrier
  ds_read_b128 v[48:51], v5 offset:0
  ds_read_b128 v[52:55], v5 offset:1024
  ds_read_b64_tr_b16 v[56:57], v6 offset:0
  ds_read_b64_tr_b16 v[58:59], v6 offset:3072
  ds_read_b64_tr_b16 v[60:61], v6 offset:32
  ds_read_b64_tr_b16 v[62:63], v6 offset:3104
  ds_read_b64_tr_b16 v[64:65], v6 offset:64
  ds_read_b64_tr_b16 v[66:67], v6 offset:3136
  s_waitcnt lgkmcnt(4)
  v_mfma_f32_16x16x32_bf16 v[16:19], v[56:59], v[48:51], v[16:19]
  ds_read_b128 v[68:71], v5 offset:4096
  ds_read_b128 v[72:75], v5 offset:5120
  s_waitcnt lgkmcnt(4)
  v_mfma_f32_16x16x32_bf16 v[20:23], v[60:63], v[48:51], v[20:23]
  ds_read_b64_tr_b16 v[76:77], v6 offset:6144
  ds_read_b64_tr_b16 v[78:79], v6 offset:9216
  s_waitcnt lgkmcnt(4)
  v_mfma_f32_16x16x32_bf16 v[24:27], v[64:67], v[48:51], v[24:27]
  ds_read_b64_tr_b16 v[80:81], v6 offset:6176
  ds_read_b64_tr_b16 v[82:83], v6 offset:9248
  v_mfma_f32_16x16x32_bf16 v[28:31], v[56:59], v[52:55], v[28:31]
  ds_read_b64_tr_b16 v[84:85], v6 offset:6208
  ds_read_b64_tr_b16 v[86:87], v6 offset:9280
  v_mfma_f32_16x16x32_bf16 v[32:35], v[60:63], v[52:55], v[32:35]
  v_mfma_f32_16x16x32_bf16 v[36:39], v[64:67], v[52:55], v[36:39]
  s_waitcnt lgkmcnt(4)
  v_mfma_f32_16x16x32_bf16 v[16:19], v[76:79], v[68:71], v[16:19]
  ds_read_b128 v[48:51], v5 offset:8192
  ds_read_b128 v[52:55], v5 offset:9216
  s_waitcnt lgkmcnt(4)
  v_mfma_f32_16x16x32_bf16 v[20:23], v[80:83], v[68:71], v[20:23]
  ds_read_b64_tr_b16 v[56:57], v6 offset:12288
  ds_read_b64_tr_b16 v[58:59], v6 offset:15360
  s_waitcnt lgkmcnt(4)
  v_mfma_f32_16x16x32_bf16 v[24:27], v[84:87], v[68:71], v[24:27]
  ds_read_b64_tr_b16 v[60:61], v6 offset:12320
  ds_read_b64_tr_b16 v[62:63], v6 offset:15392
  v_mfma_f32_16x16x32_bf16 v[28:31], v[76:79], v[72:75], v[28:31]
  ds_read_b64_tr_b16 v[64:65], v6 offset:12352
  ds_read_b64_tr_b16 v[66:67], v6 offset:15424
  v_mfma_f32_16x16x32_bf16 v[32:35], v[80:83], v[72:75], v[32:35]
  v_mfma_f32_16x16x32_bf16 v[36:39], v[84:87], v[72:75], v[36:39]
  s_waitcnt lgkmcnt(4)
  v_mfma_f32_16x16x32_bf16 v[16:19], v[56:59], v[48:51], v[16:19]
  ds_read_b128 v[68:71], v5 offset:12288
  ds_read_b128 v[72:75], v5 offset:13312
  s_waitcnt lgkmcnt(4)
  v_mfma_f32_16x16x32_bf16 v[20:23], v[60:63], v[48:51], v[20:23]
  ds_read_b64_tr_b16 v[76:77], v6 offset:18432
  ds_read_b64_tr_b16 v[78:79], v6 offset:21504
  s_waitcnt lgkmcnt(4)
  v_mfma_f32_16x16x32_bf16 v[24:27], v[64:67], v[48:51], v[24:27]
  ds_read_b64_tr_b16 v[80:81], v6 offset:18464
  ds_read_b64_tr_b16 v[82:83], v6 offset:21536
  v_mfma_f32_16x16x32_bf16 v[28:31], v[56:59], v[52:55], v[28:31]
  ds_read_b64_tr_b16 v[84:85], v6 offset:18496
  ds_read_b64_tr_b16 v[86:87], v6 offset:21568
  v_mfma_f32_16x16x32_bf16 v[32:35], v[60:63], v[52:55], v[32:35]
  v_mfma_f32_16x16x32_bf16 v[36:39], v[64:67], v[52:55], v[36:39]
  s_waitcnt lgkmcnt(4)
  v_mfma_f32_16x16x32_bf16 v[16:19], v[76:79], v[68:71], v[16:19]
  s_waitcnt lgkmcnt(2)
  v_mfma_f32_16x16x32_bf16 v[20:23], v[80:83], v[68:71], v[20:23]
  s_waitcnt lgkmcnt(0)
  v_mfma_f32_16x16x32_bf16 v[24:27], v[84:87], v[68:71], v[24:27]
  v_mfma_f32_16x16x32_bf16 v[28:31], v[76:79], v[72:75], v[28:31]
  v_mfma_f32_16x16x32_bf16 v[32:35], v[80:83], v[72:75], v[32:35]
  v_mfma_f32_16x16x32_bf16 v[36:39], v[84:87], v[72:75], v[36:39]
  v_add_u32 v5, 40960, v5
  v_add_u32 v6, 40960, v6
  v_add_u32 v12, 40960, v12
  s_waitcnt vmcnt(7)
  ds_write_b128 v12, v[160:163] offset:0
  s_waitcnt vmcnt(6)
  ds_write_b128 v12, v[164:167] offset:1024
  s_waitcnt vmcnt(5)
  ds_write_b128 v12, v[168:171] offset:2048
  s_waitcnt vmcnt(4)
  ds_write_b128 v12, v[172:175] offset:3072
  s_waitcnt lgkmcnt(0)
  s_barrier
  ds_read_b128 v[48:51], v5 offset:0
  ds_read_b128 v[52:55], v5 offset:1024
  ds_read_b64_tr_b16 v[56:57], v6 offset:0
  ds_read_b64_tr_b16 v[58:59], v6 offset:3072
  ds_read_b64_tr_b16 v[60:61], v6 offset:32
  ds_read_b64_tr_b16 v[62:63], v6 offset:3104
  ds_read_b64_tr_b16 v[64:65], v6 offset:64
  ds_read_b64_tr_b16 v[66:67], v6 offset:3136
  s_waitcnt lgkmcnt(4)
  v_mfma_f32_16x16x32_bf16 v[16:19], v[56:59], v[48:51], v[16:19]
  ds_read_b128 v[68:71], v5 offset:4096
  ds_read_b128 v[72:75], v5 offset:5120
  s_waitcnt lgkmcnt(4)
  v_mfma_f32_16x16x32_bf16 v[20:23], v[60:63], v[48:51], v[20:23]
  ds_read_b64_tr_b16 v[76:77], v6 offset:6144
  ds_read_b64_tr_b16 v[78:79], v6 offset:9216
  s_waitcnt lgkmcnt(4)
  v_mfma_f32_16x16x32_bf16 v[24:27], v[64:67], v[48:51], v[24:27]
  ds_read_b64_tr_b16 v[80:81], v6 offset:6176
  ds_read_b64_tr_b16 v[82:83], v6 offset:9248
  v_mfma_f32_16x16x32_bf16 v[28:31], v[56:59], v[52:55], v[28:31]
  ds_read_b64_tr_b16 v[84:85], v6 offset:6208
  ds_read_b64_tr_b16 v[86:87], v6 offset:9280
  v_mfma_f32_16x16x32_bf16 v[32:35], v[60:63], v[52:55], v[32:35]
  v_mfma_f32_16x16x32_bf16 v[36:39], v[64:67], v[52:55], v[36:39]
  s_waitcnt lgkmcnt(4)
  v_mfma_f32_16x16x32_bf16 v[16:19], v[76:79], v[68:71], v[16:19]
  ds_read_b128 v[48:51], v5 offset:8192
  ds_read_b128 v[52:55], v5 offset:9216
  s_waitcnt lgkmcnt(4)
  v_mfma_f32_16x16x32_bf16 v[20:23], v[80:83], v[68:71], v[20:23]
  ds_read_b64_tr_b16 v[56:57], v6 offset:12288
  ds_read_b64_tr_b16 v[58:59], v6 offset:15360
  s_waitcnt lgkmcnt(4)
  v_mfma_f32_16x16x32_bf16 v[24:27], v[84:87], v[68:71], v[24:27]
  ds_read_b64_tr_b16 v[60:61], v6 offset:12320
  ds_read_b64_tr_b16 v[62:63], v6 offset:15392
  v_mfma_f32_16x16x32_bf16 v[28:31], v[76:79], v[72:75], v[28:31]
  ds_read_b64_tr_b16 v[64:65], v6 offset:12352
  ds_read_b64_tr_b16 v[66:67], v6 offset:15424
  v_mfma_f32_16x16x32_bf16 v[32:35], v[80:83], v[72:75], v[32:35]
  v_mfma_f32_16x16x32_bf16 v[36:39], v[84:87], v[72:75], v[36:39]
  s_waitcnt lgkmcnt(4)
  v_mfma_f32_16x16x32_bf16 v[16:19], v[56:59], v[48:51], v[16:19]
  ds_read_b128 v[68:71], v5 offset:12288
  ds_read_b128 v[72:75], v5 offset:13312
  s_waitcnt lgkmcnt(4)
  v_mfma_f32_16x16x32_bf16 v[20:23], v[60:63], v[48:51], v[20:23]
  ds_read_b64_tr_b16 v[76:77], v6 offset:18432
  ds_read_b64_tr_b16 v[78:79], v6 offset:21504
  s_waitcnt lgkmcnt(4)
  v_mfma_f32_16x16x32_bf16 v[24:27], v[64:67], v[48:51], v[24:27]
  ds_read_b64_tr_b16 v[80:81], v6 offset:18464
  ds_read_b64_tr_b16 v[82:83], v6 offset:21536
  v_mfma_f32_16x16x32_bf16 v[28:31], v[56:59], v[52:55], v[28:31]
  ds_read_b64_tr_b16 v[84:85], v6 offset:18496
  ds_read_b64_tr_b16 v[86:87], v6 offset:21568
  v_mfma_f32_16x16x32_bf16 v[32:35], v[60:63], v[52:55], v[32:35]
  v_mfma_f32_16x16x32_bf16 v[36:39], v[64:67], v[52:55], v[36:39]
  s_waitcnt lgkmcnt(4)
  v_mfma_f32_16x16x32_bf16 v[16:19], v[76:79], v[68:71], v[16:19]
  s_waitcnt lgkmcnt(2)
  v_mfma_f32_16x16x32_bf16 v[20:23], v[80:83], v[68:71], v[20:23]
  s_waitcnt lgkmcnt(0)
  v_mfma_f32_16x16x32_bf16 v[24:27], v[84:87], v[68:71], v[24:27]
  v_mfma_f32_16x16x32_bf16 v[28:31], v[76:79], v[72:75], v[28:31]
  v_mfma_f32_16x16x32_bf16 v[32:35], v[80:83], v[72:75], v[32:35]
  v_mfma_f32_16x16x32_bf16 v[36:39], v[84:87], v[72:75], v[36:39]
  v_add_u32 v5, 40960, v5
  v_add_u32 v6, 40960, v6
  v_add_u32 v12, 40960, v12
  s_waitcnt vmcnt(3)
  ds_write_b128 v12, v[176:179] offset:0
  s_waitcnt vmcnt(2)
  ds_write_b128 v12, v[180:183] offset:1024
  s_waitcnt vmcnt(1)
  ds_write_b128 v12, v[184:187] offset:2048
  s_waitcnt vmcnt(0)
  ds_write_b128 v12, v[188:191] offset:3072
  s_waitcnt lgkmcnt(0)
  s_barrier
  ds_read_b128 v[48:51], v5 offset:0
  ds_read_b128 v[52:55], v5 offset:1024
  ds_read_b64_tr_b16 v[56:57], v6 offset:0
  ds_read_b64_tr_b16 v[58:59], v6 offset:3072
  ds_read_b64_tr_b16 v[60:61], v6 offset:32
  ds_read_b64_tr_b16 v[62:63], v6 offset:3104
  ds_read_b64_tr_b16 v[64:65], v6 offset:64
  ds_read_b64_tr_b16 v[66:67], v6 offset:3136
  s_waitcnt lgkmcnt(4)
  v_mfma_f32_16x16x32_bf16 v[16:19], v[56:59], v[48:51], v[16:19]
  ds_read_b128 v[68:71], v5 offset:4096
  ds_read_b128 v[72:75], v5 offset:5120
  s_waitcnt lgkmcnt(4)
  v_mfma_f32_16x16x32_bf16 v[20:23], v[60:63], v[48:51], v[20:23]
  ds_read_b64_tr_b16 v[76:77], v6 offset:6144
  ds_read_b64_tr_b16 v[78:79], v6 offset:9216
  s_waitcnt lgkmcnt(4)
  v_mfma_f32_16x16x32_bf16 v[24:27], v[64:67], v[48:51], v[24:27]
  ds_read_b64_tr_b16 v[80:81], v6 offset:6176
  ds_read_b64_tr_b16 v[82:83], v6 offset:9248
  v_mfma_f32_16x16x32_bf16 v[28:31], v[56:59], v[52:55], v[28:31]
  ds_read_b64_tr_b16 v[84:85], v6 offset:6208
  ds_read_b64_tr_b16 v[86:87], v6 offset:9280
  v_mfma_f32_16x16x32_bf16 v[32:35], v[60:63], v[52:55], v[32:35]
  v_mfma_f32_16x16x32_bf16 v[36:39], v[64:67], v[52:55], v[36:39]
  s_waitcnt lgkmcnt(4)
  v_mfma_f32_16x16x32_bf16 v[16:19], v[76:79], v[68:71], v[16:19]
  ds_read_b128 v[48:51], v5 offset:8192
  ds_read_b128 v[52:55], v5 offset:9216
  s_waitcnt lgkmcnt(4)
  v_mfma_f32_16x16x32_bf16 v[20:23], v[80:83], v[68:71], v[20:23]
  ds_read_b64_tr_b16 v[56:57], v6 offset:12288
  ds_read_b64_tr_b16 v[58:59], v6 offset:15360
  s_waitcnt lgkmcnt(4)
  v_mfma_f32_16x16x32_bf16 v[24:27], v[84:87], v[68:71], v[24:27]
  ds_read_b64_tr_b16 v[60:61], v6 offset:12320
  ds_read_b64_tr_b16 v[62:63], v6 offset:15392
  v_mfma_f32_16x16x32_bf16 v[28:31], v[76:79], v[72:75], v[28:31]
  ds_read_b64_tr_b16 v[64:65], v6 offset:12352
  ds_read_b64_tr_b16 v[66:67], v6 offset:15424
  v_mfma_f32_16x16x32_bf16 v[32:35], v[80:83], v[72:75], v[32:35]
  v_mfma_f32_16x16x32_bf16 v[36:39], v[84:87], v[72:75], v[36:39]
  s_waitcnt lgkmcnt(4)
  v_mfma_f32_16x16x32_bf16 v[16:19], v[56:59], v[48:51], v[16:19]
  ds_read_b128 v[68:71], v5 offset:12288
  ds_read_b128 v[72:75], v5 offset:13312
  s_waitcnt lgkmcnt(4)
  v_mfma_f32_16x16x32_bf16 v[20:23], v[60:63], v[48:51], v[20:23]
  ds_read_b64_tr_b16 v[76:77], v6 offset:18432
  ds_read_b64_tr_b16 v[78:79], v6 offset:21504
  s_waitcnt lgkmcnt(4)
  v_mfma_f32_16x16x32_bf16 v[24:27], v[64:67], v[48:51], v[24:27]
  ds_read_b64_tr_b16 v[80:81], v6 offset:18464
  ds_read_b64_tr_b16 v[82:83], v6 offset:21536
  v_mfma_f32_16x16x32_bf16 v[28:31], v[56:59], v[52:55], v[28:31]
  ds_read_b64_tr_b16 v[84:85], v6 offset:18496
  ds_read_b64_tr_b16 v[86:87], v6 offset:21568
  v_mfma_f32_16x16x32_bf16 v[32:35], v[60:63], v[52:55], v[32:35]
  v_mfma_f32_16x16x32_bf16 v[36:39], v[64:67], v[52:55], v[36:39]
  s_waitcnt lgkmcnt(4)
  v_mfma_f32_16x16x32_bf16 v[16:19], v[76:79], v[68:71], v[16:19]
  s_waitcnt lgkmcnt(2)
  v_mfma_f32_16x16x32_bf16 v[20:23], v[80:83], v[68:71], v[20:23]
  s_waitcnt lgkmcnt(0)
  v_mfma_f32_16x16x32_bf16 v[24:27], v[84:87], v[68:71], v[24:27]
  v_mfma_f32_16x16x32_bf16 v[28:31], v[76:79], v[72:75], v[28:31]
  v_mfma_f32_16x16x32_bf16 v[32:35], v[80:83], v[72:75], v[32:35]
  v_mfma_f32_16x16x32_bf16 v[36:39], v[84:87], v[72:75], v[36:39]
  v_subrev_u32 v5, 122880, v5
  v_subrev_u32 v6, 122880, v6
  s_mul_i32 s24, s42, 8
  s_add_u32 s24, s24, s41
  s_lshl_b32 s24, s24, 2
  s_add_u32 s24, s24, s20
  s_mul_i32 s24, s24, 6144
  s_add_u32 s24, s24, 100663296
  s_add_u32 s25, s24, 4096
  v_min_u32 v16, 0xfffffffe, v16
  v_min_u32 v17, 0xfffffffe, v17
  v_min_u32 v18, 0xfffffffe, v18
  v_min_u32 v19, 0xfffffffe, v19
  buffer_store_dwordx4 v[16:19], v1, s[8:11], s24 offen offset:0 sc1
  v_min_u32 v20, 0xfffffffe, v20
  v_min_u32 v21, 0xfffffffe, v21
  v_min_u32 v22, 0xfffffffe, v22
  v_min_u32 v23, 0xfffffffe, v23
  buffer_store_dwordx4 v[20:23], v1, s[8:11], s24 offen offset:1024 sc1
  v_min_u32 v24, 0xfffffffe, v24
  v_min_u32 v25, 0xfffffffe, v25
  v_min_u32 v26, 0xfffffffe, v26
  v_min_u32 v27, 0xfffffffe, v27
  buffer_store_dwordx4 v[24:27], v1, s[8:11], s24 offen offset:2048 sc1
  v_min_u32 v28, 0xfffffffe, v28
  v_min_u32 v29, 0xfffffffe, v29
  v_min_u32 v30, 0xfffffffe, v30
  v_min_u32 v31, 0xfffffffe, v31
  buffer_store_dwordx4 v[28:31], v1, s[8:11], s24 offen offset:3072 sc1
  v_min_u32 v32, 0xfffffffe, v32
  v_min_u32 v33, 0xfffffffe, v33
  v_min_u32 v34, 0xfffffffe, v34
  v_min_u32 v35, 0xfffffffe, v35
  buffer_store_dwordx4 v[32:35], v1, s[8:11], s25 offen offset:0 sc1
  v_min_u32 v36, 0xfffffffe, v36
  v_min_u32 v37, 0xfffffffe, v37
  v_min_u32 v38, 0xfffffffe, v38
  v_min_u32 v39, 0xfffffffe, v39
  buffer_store_dwordx4 v[36:39], v1, s[8:11], s25 offen offset:1024 sc1
  s_cmp_lt_u32 s20, 3
  s_cbranch_scc0 SP_END
  s_mul_i32 s24, s41, 3
  s_add_u32 s24, s24, s20
  s_mul_i32 s25, s24, 10923
  s_lshr_b32 s25, s25, 16
  s_mul_i32 s26, s25, 6
  s_sub_u32 s26, s24, s26
  s_mul_i32 s27, s42, 32
  s_add_u32 s27, s27, s25
  s_mul_i32 s27, s27, 6144
  s_lshl_b32 s29, s26, 10
  s_add_u32 s27, s27, s29
  s_add_u32 s27, s27, 100663296
  s_mov_b32 s24, 0
  s_mov_b32 s28, s27
SP_P_47:
  s_mov_b32 s27, s28
  buffer_load_dwordx4 v[64:67], v1, s[8:11], s27 offen sc1
  s_add_u32 s27, s27, 24576
  buffer_load_dwordx4 v[68:71], v1, s[8:11], s27 offen sc1
  s_add_u32 s27, s27, 24576
  buffer_load_dwordx4 v[72:75], v1, s[8:11], s27 offen sc1
  s_add_u32 s27, s27, 24576
  buffer_load_dwordx4 v[76:79], v1, s[8:11], s27 offen sc1
  s_add_u32 s27, s27, 24576
  buffer_load_dwordx4 v[80:83], v1, s[8:11], s27 offen sc1
  s_add_u32 s27, s27, 24576
  buffer_load_dwordx4 v[84:87], v1, s[8:11], s27 offen sc1
  s_add_u32 s27, s27, 24576
  buffer_load_dwordx4 v[88:91], v1, s[8:11], s27 offen sc1
  s_add_u32 s27, s27, 24576
  buffer_load_dwordx4 v[92:95], v1, s[8:11], s27 offen sc1
  s_waitcnt vmcnt(0)
  v_max3_u32 v10, v64, v65, v66
  v_max3_u32 v10, v10, v67, v68
  v_max3_u32 v10, v10, v69, v70
  v_max3_u32 v10, v10, v71, v72
  v_max3_u32 v10, v10, v73, v74
  v_max3_u32 v10, v10, v75, v76
  v_max3_u32 v10, v10, v77, v78
  v_max3_u32 v10, v10, v79, v80
  v_max3_u32 v10, v10, v81, v82
  v_max3_u32 v10, v10, v83, v84
  v_max3_u32 v10, v10, v85, v86
  v_max3_u32 v10, v10, v87, v88
  v_max3_u32 v10, v10, v89, v90
  v_max3_u32 v10, v10, v91, v92
  v_max3_u32 v10, v10, v93, v94
  v_max_u32 v10, v10, v95
  v_cmp_eq_u32 vcc, -1, v10
  s_cbranch_vccz SP_P_47x
  s_add_u32 s24, s24, 1
  s_cmp_ge_u32 s24, 200000
  s_cbranch_scc1 SP_P_47x
  s_sleep 2
  s_branch SP_P_47
SP_P_47x:
  s_lshl_b32 s27, s21, 6
  s_and_b32 s29, s25, 1
  s_lshl_b32 s29, s29, 5
  s_add_u32 s27, s27, s29
  s_cmp_ge_u32 s26, 3
  s_cselect_b32 s29, 16, 0
  s_add_u32 s27, s27, s29
  s_mul_i32 s27, s27, 2304
  s_cselect_b32 s29, 3, 0
  s_cmp_ge_u32 s26, 3
  s_cselect_b32 s29, 3, 0
  s_sub_u32 s26, s26, s29
  s_lshl_b32 s26, s26, 5
  s_add_u32 s27, s27, s26
  s_mul_i32 s29, s22, 192
  s_add_u32 s27, s27, s29
  s_lshr_b32 s25, s25, 1
  s_mul_i32 s25, s25, 96
  s_add_u32 s27, s27, s25
  v_pk_add_f32 v[64:65], v[64:65], v[68:69]
  v_pk_add_f32 v[66:67], v[66:67], v[70:71]
  v_pk_add_f32 v[64:65], v[64:65], v[72:73]
  v_pk_add_f32 v[66:67], v[66:67], v[74:75]
  v_pk_add_f32 v[64:65], v[64:65], v[76:77]
  v_pk_add_f32 v[66:67], v[66:67], v[78:79]
  v_pk_add_f32 v[64:65], v[64:65], v[80:81]
  v_pk_add_f32 v[66:67], v[66:67], v[82:83]
  v_pk_add_f32 v[64:65], v[64:65], v[84:85]
  v_pk_add_f32 v[66:67], v[66:67], v[86:87]
  v_pk_add_f32 v[64:65], v[64:65], v[88:89]
  v_pk_add_f32 v[66:67], v[66:67], v[90:91]
  v_pk_add_f32 v[64:65], v[64:65], v[92:93]
  v_pk_add_f32 v[66:67], v[66:67], v[94:95]
  v_cvt_pk_bf16_f32 v64, v64, v65
  v_cvt_pk_bf16_f32 v65, v66, v67
  buffer_store_dwordx2 v[64:65], v7, s[16:19], s27 offen
SP_END:
  s_add_u32 s99, s99, 128
  s_branch L_SPU
L_END:
L_END2:

  s_endpgm
.section .rodata,"a"
.p2align 6
.amdhsa_kernel concat_heads__memory_aug_recurrent_mem_tr__linear_attn_block__prompt_kernel
  .amdhsa_next_free_vgpr 512
  .amdhsa_next_free_sgpr 102
  .amdhsa_accum_offset 256
  .amdhsa_group_segment_fixed_size 0
  .amdhsa_kernarg_size 104
  .amdhsa_user_sgpr_count 2
  .amdhsa_user_sgpr_kernarg_segment_ptr 1
  .amdhsa_system_sgpr_workgroup_id_x 1
.end_amdhsa_kernel
```
